```python
import torch

def _softmax(x, axis=-1):
    return torch.softmax(x, dim=axis)
def _gelu(x):
    return torch.nn.functional.gelu(x, approximate="tanh")
def _silu(x):
    return torch.nn.functional.silu(x)
def _sigmoid(x):
    return torch.sigmoid(x)
def _layernorm(x, axis=-1, eps=1e-5):
    m = x.mean(dim=axis, keepdim=True)
    v = x.var(dim=axis, keepdim=True, unbiased=False)
    return (x - m) / torch.sqrt(v + eps)
def _scatter_add(tgt, idx, src, axis=0):
    return tgt.clone().index_add_(axis, idx, src)
def _segment_sum(src, seg, n):
    out = torch.zeros((n,) + src.shape[1:], dtype=src.dtype)
    return out.index_add_(0, seg, src)
def _pad(x, pw):
    flat = tuple(v for pair in reversed(pw) for v in pair)
    return torch.nn.functional.pad(x, flat)

kernel_name = 'standalone__gqa_block_cached__near_ridge'

def setup_inputs():

    _w = (lambda a: (lambda t: t.to(torch.bfloat16) if t.is_floating_point() else t)(torch.as_tensor(a)))
    B, Sq, D = 8, 224, 512
    Hq, Hkv, Sk, Dh = 32, 32, 512, 128
    assert Hq % Hkv == 0, (Hq, Hkv)
    return {
        "x": _w((lambda *s: torch.randn(*s, dtype=torch.bfloat16) * 0.8)(B, Sq, D)),
        "k_cache": _w((lambda *s: torch.randn(*s, dtype=torch.bfloat16) * 0.8)(B, Hkv, Sk, Dh)),
        "v_cache": _w((lambda *s: torch.randn(*s, dtype=torch.bfloat16) * 0.05)(B, Hkv, Sk, Dh)),
        "wq": _w((lambda *s: torch.randn(*s, dtype=torch.bfloat16) * 0.8)(D, Hq * Dh) * (D ** -0.5)),
        "wo": _w((lambda *s: torch.randn(*s, dtype=torch.bfloat16) * 0.05)(Hq * Dh, D) * ((Hq * Dh) ** -0.5)),
    }

def reference(x, k_cache, v_cache, wq, wo):
    B, Sq, D = x.shape
    Hq, Dh = 32, 128
    Hkv = k_cache.shape[1]
    rep = Hq // Hkv
    q = (lambda x, *d: x.permute(*d))((x @ wq).reshape(B, Sq, Hq, Dh), 0, 2, 1, 3)
    k = (lambda x, n, axis: torch.repeat_interleave(x, n, dim=axis))(k_cache, rep, axis=1)
    v = (lambda x, n, axis: torch.repeat_interleave(x, n, dim=axis))(v_cache, rep, axis=1)
    scores = torch.einsum("bhqd,bhkd->bhqk", q, k) * (Dh ** -0.5)
    p = _softmax(scores, axis=-1)
    o = torch.einsum("bhqk,bhkd->bhqd", p, v)
    return (lambda x, *d: x.permute(*d))(o, 0, 2, 1, 3).reshape(B, Sq, Hq * Dh) @ wo
```

```asm
; @launch grid=(256,1,1) block=(256,1,1) lds=163840
.amdgcn_target "amdgcn-amd-amdhsa--gfx950"
.text
.globl standalone__gqa_block_cached__near_ridge_kernel
.p2align 8
.type standalone__gqa_block_cached__near_ridge_kernel,@function
standalone__gqa_block_cached__near_ridge_kernel:
    s_cmp_ge_u32 s2, 256
    s_cbranch_scc1 L_end
    s_load_dwordx16 s[84:99], s[0:1], 0
    s_getpc_b64 s[4:5]
L_warm:
    s_lshr_b32 s46, s2, 3
    s_lshl_b32 s46, s46, 12
    v_lshrrev_b32 v70, 3, v0
    v_lshlrev_b32 v70, 7, v70
    v_add_u32 v70, s46, v70
    v_min_u32 v70, L_codeend-L_warm, v70
    global_load_dword v255, v70, s[4:5]
    v_lshrrev_b32 v64, 6, v0
    v_and_b32 v1, 63, v0
    v_readfirstlane_b32 s40, v64
    s_and_b32 s46, s2, 6
    s_bfe_u32 s47, s2, 0x10005
    s_add_u32 s42, s46, s47
    s_bfe_u32 s48, s2, 0x20003
    s_lshr_b32 s46, s2, 6
    s_lshl_b32 s46, s46, 2
    s_add_u32 s48, s48, s46
    s_and_b32 s46, s2, 1
    s_lshl_b32 s46, s46, 4
    s_add_u32 s43, s46, s48
    s_add_u32 s3, s47, s48
    s_and_b32 s3, s3, 1
    s_lshl_b32 s3, s3, 2
    s_lshr_b32 s3, 0x41, s3
    s_and_b32 s3, s3, 7
    s_lshl_b32 s64, s3, 7
    s_lshl_b32 s72, s3, 19
    s_and_b32 s41, s40, 1
    s_lshl_b32 s44, s40, 12
    s_mul_i32 s45, s40, 7168
    v_lshrrev_b32 v64, 3, v1
    v_and_b32 v65, 7, v1
    v_bfe_u32 v66, v1, 4, 1
    s_lshl_b32 s47, s41, 2
    v_lshlrev_b32 v68, 1, v66
    v_xor_b32 v68, v68, v65
    v_xor_b32 v68, s47, v68
    v_lshlrev_b32 v68, 4, v68
    s_lshl_b32 s46, s40, 3
    v_add_u32 v69, s46, v64
    v_lshl_add_u32 v70, v69, 13, v68
    v_add_u32 v96, 4096, v70
    v_add_u32 v97, 3200, v70
    v_add_u32 v98, 264192, v70
    v_add_u32 v99, 263296, v70
    s_mul_i32 s46, s40, 57344
    v_lshlrev_b32 v67, 10, v64
    v_add_u32 v67, s46, v67
    v_lshrrev_b32 v70, 1, v64
    v_xor_b32 v70, v70, v65
    v_xor_b32 v70, s47, v70
    v_lshl_add_u32 v100, v70, 4, v67
    v_xor_b32 v70, 64, v100
    v_add_u32 v101, 7168, v70
    v_add_u32 v102, 14336, v100
    v_add_u32 v103, 21504, v70
    v_add_u32 v104, 32768, v100
    v_add_u32 v105, 39936, v70
    v_add_u32 v106, 47104, v100
    s_mul_i32 s46, s42, 229376
    s_lshl_b32 s47, s43, 8
    s_sub_u32 s22, 4198400, s47
    s_mov_b32 s23, 0x20000
    s_mov_b32 s10, 229376
    s_mov_b32 s11, 0x20000
    s_waitcnt lgkmcnt(0)
    s_add_u32 s90, s90, s47
    s_addc_u32 s91, s91, 0
    s_sub_u32 s20, s90, 4096
    s_subb_u32 s21, s91, 0
    s_add_u32 s8, s84, s46
    s_addc_u32 s9, s85, 0
    s_add_u32 m0, s44, 131072
    s_nop 0
    buffer_load_dwordx4 v96, s[20:23], s72 offen offset:0 lds
    buffer_load_dwordx4 v97, s[20:23], s72 offen offset:1024 lds
    buffer_load_dwordx4 v98, s[20:23], s72 offen offset:2048 lds
    buffer_load_dwordx4 v99, s[20:23], s72 offen offset:3072 lds
    s_add_u32 m0, s45, 57344
    s_nop 0
    buffer_load_dwordx4 v100, s[8:11], s64 offen offset:0 lds
    buffer_load_dwordx4 v101, s[8:11], s64 offen offset:1024 lds
    buffer_load_dwordx4 v102, s[8:11], s64 offen offset:2048 lds
    buffer_load_dwordx4 v103, s[8:11], s64 offen offset:3072 lds
    s_add_u32 m0, s45, 61440
    s_nop 0
    buffer_load_dwordx4 v104, s[8:11], s64 offen offset:0 lds
    buffer_load_dwordx4 v105, s[8:11], s64 offen offset:1024 lds
    buffer_load_dwordx4 v106, s[8:11], s64 offen offset:2048 lds
    s_mov_b32 s24, s92
    s_mov_b32 s25, s93
    s_mov_b32 s26, 4194304
    s_mov_b32 s27, 0x20000
    s_mov_b32 s28, s98
    s_mov_b32 s29, s99
    s_mov_b32 s30, 41943040
    s_mov_b32 s31, 0x20000
    s_mov_b32 s32, s96
    s_mov_b32 s33, s97
    s_mov_b32 s34, 256
    s_mov_b32 s35, 0x20000
    s_lshl_b32 s46, s42, 5
    s_add_u32 s48, s46, s43
    s_lshl_b32 s46, s48, 17
    s_add_u32 s86, s86, s46
    s_addc_u32 s87, s87, 0
    s_sub_u32 s12, s86, 4096
    s_subb_u32 s13, s87, 0
    s_mov_b32 s14, 135168
    s_mov_b32 s15, 0x20000
    s_add_u32 s88, s88, s46
    s_addc_u32 s89, s89, 0
    s_sub_u32 s16, s88, 4096
    s_subb_u32 s17, s89, 0
    s_mov_b32 s18, 135168
    s_mov_b32 s19, 0x20000
    s_and_b32 s62, s2, 6
    s_lshr_b32 s46, s2, 7
    s_or_b32 s62, s62, s46
    s_bfe_u32 s60, s2, 0x10006
    s_lshl_b32 s60, s60, 1
    s_and_b32 s92, s2, 1
    s_or_b32 s60, s60, s92
    s_bfe_u32 s61, s2, 0x30003
    s_lshl_b32 s92, s92, 2
    s_add_u32 s92, s92, s40
    s_mul_i32 s46, s62, 229376
    s_add_u32 s36, s94, s46
    s_addc_u32 s37, s95, 0
    s_mov_b32 s38, 229376
    s_mov_b32 s39, 0x20000
    s_add_u32 s46, s3, 1
    s_and_b32 s46, s46, 7
    s_lshl_b32 s65, s46, 7
    s_lshl_b32 s73, s46, 19
    s_add_u32 s46, s3, 2
    s_and_b32 s46, s46, 7
    s_lshl_b32 s66, s46, 7
    s_lshl_b32 s74, s46, 19
    s_add_u32 s46, s3, 3
    s_and_b32 s46, s46, 7
    s_lshl_b32 s67, s46, 7
    s_lshl_b32 s75, s46, 19
    s_add_u32 s46, s3, 4
    s_and_b32 s46, s46, 7
    s_lshl_b32 s68, s46, 7
    s_lshl_b32 s76, s46, 19
    s_add_u32 s46, s3, 5
    s_and_b32 s46, s46, 7
    s_lshl_b32 s69, s46, 7
    s_lshl_b32 s77, s46, 19
    s_add_u32 s46, s3, 6
    s_and_b32 s46, s46, 7
    s_lshl_b32 s70, s46, 7
    s_lshl_b32 s78, s46, 19
    s_add_u32 s46, s3, 7
    s_and_b32 s46, s46, 7
    s_lshl_b32 s71, s46, 7
    s_lshl_b32 s79, s46, 19
    v_lshl_add_u32 v70, v69, 8, v68
    v_add_u32 v18, 4096, v70
    v_add_u32 v19, 3200, v70
    v_add_u32 v20, 10240, v70
    v_add_u32 v21, 9344, v70
    s_lshl_b32 s46, s40, 1
    v_xor_b32 v68, v66, v65
    v_xor_b32 v68, s46, v68
    v_lshlrev_b32 v68, 4, v68
    v_lshl_add_u32 v70, v69, 8, v68
    v_add_u32 v14, 4096, v70
    v_add_u32 v15, 3200, v70
    v_add_u32 v16, 10240, v70
    v_add_u32 v17, 9344, v70
    v_and_b32 v70, 6, v64
    v_xor_b32 v70, v70, v65
    v_lshlrev_b32 v70, 4, v70
    v_lshl_add_u32 v70, v64, 10, v70
    s_lshl_b32 s46, s92, 19
    s_lshl_b32 s47, s61, 7
    s_add_u32 s46, s46, s47
    v_add_u32 v44, s46, v70
    v_add_u32 v45, 7168, v44
    v_add_u32 v46, 14336, v44
    v_add_u32 v47, 21504, v44
    v_lshlrev_b32 v68, 4, v1
    s_mov_b32 s84, 0
    s_mov_b32 s85, 16384
    s_mov_b32 s86, 32768
    s_mov_b32 s87, 49152
    s_mov_b32 s88, 65536
    s_mov_b32 s89, 81920
    s_mov_b32 s90, 98304
    s_mov_b32 s91, 114688
    s_mov_b32 s54, 0
    s_mov_b32 s55, 4096
    s_mov_b32 s56, 8192
    s_mov_b32 s57, 12288
    s_mov_b32 s49, 0x3e0293ee
    s_mov_b32 s50, 0x27800000
    s_mov_b32 s51, 0x57800000
    v_add_u32 v27, s44, v68
    v_add_u32 v29, 98304, v27
    s_lshl_b32 s46, s42, 2
    s_add_u32 s46, s46, s40
    s_lshl_b32 s46, s46, 5
    s_add_u32 s46, s46, s43
    s_mul_i32 s47, s46, 14336
    s_add_u32 s47, s47, 1048576
    v_add_u32 v24, s47, v68
    s_lshl_b32 s46, s46, 7
    s_add_u32 s46, s46, 25165824
    v_and_b32 v69, 31, v1
    v_lshlrev_b32 v69, 2, v69
    v_add_u32 v26, s46, v69
    s_lshr_b32 s46, s2, 5
    s_lshl_b32 s46, s46, 3
    s_and_b32 s47, s2, 7
    s_or_b32 s47, s46, s47
    s_lshl_b32 s46, s47, 12
    s_add_u32 s46, s46, 25165824
    s_lshl_b32 s47, s47, 2
    s_and_b32 s48, s2, 24
    s_cselect_b32 s46, 41943040, s46
    s_cselect_b32 s48, 0x1000, s47
    v_lshl_add_u32 v28, v0, 4, s46
    s_lshl_b32 s46, s40, 11
    s_add_u32 s46, s46, 65536
    v_add_u32 v22, s46, v68
    v_xor_b32 v23, 0x800, v22
    v_mov_b32 v71, s48
    v_mov_b32 v25, 0x1000
    v_cmp_eq_u32 vcc, 0, v0
    s_nop 1
    v_cndmask_b32 v25, v25, v71, vcc
    v_and_b32 v64, 15, v1
    v_lshrrev_b32 v65, 4, v1
    v_lshrrev_b32 v66, 2, v64
    v_and_b32 v67, 3, v64
    v_and_b32 v71, 1, v65
    s_lshl_b32 s46, s41, 11
    s_xor_b32 s47, s46, 2048
    v_lshlrev_b32 v68, 12, v65
    v_lshl_add_u32 v68, v66, 7, v68
    v_lshl_add_u32 v68, v67, 3, v68
    v_add_u32 v68, 98304, v68
    v_lshrrev_b32 v69, 1, v66
    v_lshl_or_b32 v69, v71, 1, v69
    v_xor_b32 v70, 0, v69
    v_lshl_add_u32 v70, v70, 5, v68
    v_add_u32 v6, s46, v70
    v_add_u32 v10, s47, v70
    v_xor_b32 v70, 1, v69
    v_lshl_add_u32 v70, v70, 5, v68
    v_add_u32 v7, s46, v70
    v_add_u32 v11, s47, v70
    v_xor_b32 v70, 2, v69
    v_lshl_add_u32 v70, v70, 5, v68
    v_add_u32 v8, s46, v70
    v_add_u32 v12, s47, v70
    v_xor_b32 v70, 3, v69
    v_lshl_add_u32 v70, v70, 5, v68
    v_add_u32 v9, s46, v70
    v_add_u32 v13, s47, v70
    v_lshlrev_b32 v68, 12, v65
    v_lshl_add_u32 v68, v66, 7, v68
    v_lshlrev_b32 v69, 1, v69
    v_xor_b32 v69, v69, v67
    v_lshl_add_u32 v68, v69, 4, v68
    s_lshl_b32 s48, s41, 10
    s_add_u32 s4, s48, 98304
    v_add_u32 v112, s4, v68
    v_xor_b32 v113, 64, v112
    v_xor_b32 v114, 0x400, v112
    v_xor_b32 v115, 0x440, v112
    v_lshlrev_b32 v68, 12, v66
    v_lshl_add_u32 v68, v67, 7, v68
    v_lshrrev_b32 v69, 1, v64
    v_xor_b32 v69, v69, v65
    v_lshl_add_u32 v69, v69, 4, v68
    v_add_u32 v69, s48, v69
    v_xor_b32 v70, 64, v69
    v_add_u32 v2, s46, v69
    v_xor_b32 v48, 0x400, v2
    v_add_u32 v3, s46, v70
    v_xor_b32 v49, 0x400, v3
    v_add_u32 v4, s47, v69
    v_xor_b32 v50, 0x400, v4
    v_add_u32 v5, s47, v70
    v_xor_b32 v51, 0x400, v5
    v_lshrrev_b32 v69, 1, v64
    v_xor_b32 v69, v69, v65
    v_lshlrev_b32 v68, 7, v64
    v_lshl_add_u32 v69, v69, 4, v68
    s_mul_i32 s46, s40, 6144
    s_add_u32 s46, s46, 28672
    v_add_u32 v107, s46, v69
    v_xor_b32 v108, 64, v107
    s_lshr_b32 s47, s40, 1
    s_lshl_b32 s46, s47, 11
    s_add_u32 s46, s46, 53248
    v_add_u32 v109, s46, v69
    v_xor_b32 v110, 64, v109
    v_mov_b32 v69, 0x3f803f80
    v_cmp_eq_u32 vcc, 0, v67
    s_nop 1
    v_cndmask_b32 v69, 0, v69, vcc
    v_accvgpr_write_b32 a80, v69
    v_accvgpr_write_b32 a81, v69
    v_accvgpr_write_b32 a82, v69
    v_accvgpr_write_b32 a83, v69
    v_lshl_add_u32 v69, v65, 2, v66
    v_bfe_u32 v70, v69, 1, 2
    v_xor_b32 v70, s40, v70
    v_lshlrev_b32 v69, 7, v69
    v_lshl_add_u32 v69, v67, 3, v69
    v_add_u32 v69, s44, v69
    v_xor_b32 v68, 0, v70
    v_lshl_add_u32 v36, v68, 5, v69
    v_add_u32 v40, 0x10000, v36
    v_xor_b32 v68, 1, v70
    v_lshl_add_u32 v37, v68, 5, v69
    v_add_u32 v41, 0x10000, v37
    v_xor_b32 v68, 2, v70
    v_lshl_add_u32 v38, v68, 5, v69
    v_add_u32 v42, 0x10000, v38
    v_xor_b32 v68, 3, v70
    v_lshl_add_u32 v39, v68, 5, v69
    v_add_u32 v43, 0x10000, v39
    v_mov_b32 v30, s49
    s_mov_b64 exec, 0
    s_cmp_eq_u32 s40, 0
    s_cbranch_scc1 L_s0
    s_cmp_eq_u32 s40, 1
    s_cbranch_scc1 L_s1
    s_cmp_eq_u32 s40, 2
    s_cbranch_scc1 L_s2
    s_branch L_s3
L_back:
    s_mov_b64 exec, -1
    s_add_u32 m0, s44, 147456
    s_nop 0
    buffer_load_dwordx4 v96, s[20:23], s73 offen offset:0 lds
    buffer_load_dwordx4 v97, s[20:23], s73 offen offset:1024 lds
    buffer_load_dwordx4 v98, s[20:23], s73 offen offset:2048 lds
    buffer_load_dwordx4 v99, s[20:23], s73 offen offset:3072 lds
    s_add_u32 m0, s45, 86016
    s_nop 0
    buffer_load_dwordx4 v100, s[8:11], s65 offen offset:0 lds
    buffer_load_dwordx4 v101, s[8:11], s65 offen offset:1024 lds
    buffer_load_dwordx4 v102, s[8:11], s65 offen offset:2048 lds
    buffer_load_dwordx4 v103, s[8:11], s65 offen offset:3072 lds
    s_add_u32 m0, s45, 90112
    s_nop 0
    buffer_load_dwordx4 v104, s[8:11], s65 offen offset:0 lds
    buffer_load_dwordx4 v105, s[8:11], s65 offen offset:1024 lds
    buffer_load_dwordx4 v106, s[8:11], s65 offen offset:2048 lds
    s_bfe_u32 s46, s2, 0x20003
    s_bfe_u32 s47, s2, 0x10005
    s_xor_b32 s46, s46, s47
    s_cmp_eq_u32 s46, 0
    s_cbranch_scc1 L_var0
    s_cmp_eq_u32 s46, 1
    s_cbranch_scc1 L_var1
    s_cmp_eq_u32 s46, 2
    s_cbranch_scc1 L_var2
    s_branch L_var1
.p2align 12
L_var0:
    s_waitcnt vmcnt(11) lgkmcnt(0)
    s_barrier
    ds_read_b128 a[128:131], v109 offset:28672
    ds_read_b64_tr_b16 a[84:85], v112 offset:32768
    ds_read_b64_tr_b16 a[86:87], v112 offset:33280
    ds_read_b128 a[144:147], v110 offset:28672
    ds_read_b64_tr_b16 a[88:89], v112 offset:34816
    ds_read_b64_tr_b16 a[90:91], v112 offset:35328
    ds_read_b128 a[132:135], v108 offset:28672
    ds_read_b128 a[116:119], v107 offset:28672
    ds_read_b128 a[120:123], v107 offset:30720
    ds_read_b128 a[136:139], v108 offset:30720
    ds_read_b128 a[140:143], v108 offset:32768
    ds_read_b128 a[124:127], v107 offset:32768
    ds_read_b64_tr_b16 a[92:93], v112 offset:32776
    ds_read_b64_tr_b16 a[94:95], v112 offset:33288
    ds_read_b64_tr_b16 a[96:97], v112 offset:34824
    ds_read_b64_tr_b16 a[98:99], v112 offset:35336
    ds_read_b64_tr_b16 a[100:101], v113 offset:32768
    ds_read_b64_tr_b16 a[102:103], v113 offset:33280
    ds_read_b64_tr_b16 a[104:105], v113 offset:34816
    ds_read_b64_tr_b16 a[106:107], v113 offset:35328
    ds_read_b64_tr_b16 a[108:109], v113 offset:32776
    ds_read_b64_tr_b16 a[110:111], v113 offset:33288
    ds_read_b64_tr_b16 a[112:113], v113 offset:34824
    ds_read_b64_tr_b16 a[114:115], v113 offset:35336
    s_add_u32 m0, s44, 114688
    s_mul_i32 s5, s60, 458752
    buffer_load_dwordx4 v96, s[20:23], s74 offen offset:0 lds
    s_waitcnt lgkmcnt(15)
    v_mfma_f32_16x16x32_bf16 v[140:143], a[84:87], a[128:131], 0
    v_mfma_f32_16x16x32_bf16 v[140:143], a[88:91], a[144:147], v[140:143]
    v_mfma_f32_16x16x32_bf16 v[128:131], a[88:91], a[132:135], 0
    buffer_load_dwordx4 v97, s[20:23], s74 offen offset:1024 lds
    v_mfma_f32_16x16x32_bf16 v[128:131], a[84:87], a[116:119], v[128:131]
    s_waitcnt lgkmcnt(8)
    v_mfma_f32_16x16x32_bf16 v[132:135], a[84:87], a[120:123], 0
    v_mfma_f32_16x16x32_bf16 v[132:135], a[88:91], a[136:139], v[132:135]
    v_mfma_f32_16x16x32_bf16 v[136:139], a[88:91], a[140:143], 0
    ds_read_b64_tr_b16 a[88:89], v114 offset:34816
    ds_read_b64_tr_b16 a[90:91], v114 offset:35328
    v_mfma_f32_16x16x32_bf16 v[136:139], a[84:87], a[124:127], v[136:139]
    ds_read_b64_tr_b16 a[84:85], v114 offset:32768
    ds_read_b64_tr_b16 a[86:87], v114 offset:33280
    v_mfma_f32_16x16x32_bf16 v[156:159], a[92:95], a[128:131], 0
    buffer_load_dwordx4 v98, s[20:23], s74 offen offset:2048 lds
    v_mfma_f32_16x16x32_bf16 v[156:159], a[96:99], a[144:147], v[156:159]
    v_mfma_f32_16x16x32_bf16 v[144:147], a[96:99], a[132:135], 0
    v_mfma_f32_16x16x32_bf16 v[144:147], a[92:95], a[116:119], v[144:147]
    v_mfma_f32_16x16x32_bf16 v[148:151], a[92:95], a[120:123], 0
    buffer_load_dwordx4 v99, s[20:23], s74 offen offset:3072 lds
    v_mfma_f32_16x16x32_bf16 v[148:151], a[96:99], a[136:139], v[148:151]
    s_add_u32 m0, s45, 28672
    v_mfma_f32_16x16x32_bf16 v[152:155], a[96:99], a[140:143], 0
    s_waitcnt lgkmcnt(4)
    ds_read_b64_tr_b16 a[96:97], v114 offset:34824
    ds_read_b64_tr_b16 a[98:99], v114 offset:35336
    v_mfma_f32_16x16x32_bf16 v[152:155], a[92:95], a[124:127], v[152:155]
    ds_read_b64_tr_b16 a[92:93], v114 offset:32776
    ds_read_b64_tr_b16 a[94:95], v114 offset:33288
    v_mfma_f32_16x16x32_bf16 v[172:175], a[100:103], a[128:131], 0
    buffer_load_dwordx4 v100, s[8:11], s66 offen offset:0 lds
    v_mfma_f32_16x16x32_bf16 v[172:175], a[104:107], a[144:147], v[172:175]
    v_mfma_f32_16x16x32_bf16 v[160:163], a[104:107], a[132:135], 0
    v_mfma_f32_16x16x32_bf16 v[160:163], a[100:103], a[116:119], v[160:163]
    v_mfma_f32_16x16x32_bf16 v[164:167], a[100:103], a[120:123], 0
    buffer_load_dwordx4 v101, s[8:11], s66 offen offset:1024 lds
    v_mfma_f32_16x16x32_bf16 v[164:167], a[104:107], a[136:139], v[164:167]
    v_mfma_f32_16x16x32_bf16 v[168:171], a[104:107], a[140:143], 0
    ds_read_b64_tr_b16 a[104:105], v115 offset:34816
    ds_read_b64_tr_b16 a[106:107], v115 offset:35328
    v_mfma_f32_16x16x32_bf16 v[168:171], a[100:103], a[124:127], v[168:171]
    ds_read_b64_tr_b16 a[100:101], v115 offset:32768
    ds_read_b64_tr_b16 a[102:103], v115 offset:33280
    v_mfma_f32_16x16x32_bf16 v[188:191], a[108:111], a[128:131], 0
    buffer_load_dwordx4 v102, s[8:11], s66 offen offset:2048 lds
    v_mfma_f32_16x16x32_bf16 v[188:191], a[112:115], a[144:147], v[188:191]
    v_mfma_f32_16x16x32_bf16 v[176:179], a[112:115], a[132:135], 0
    v_mfma_f32_16x16x32_bf16 v[176:179], a[108:111], a[116:119], v[176:179]
    v_mfma_f32_16x16x32_bf16 v[180:183], a[108:111], a[120:123], 0
    buffer_load_dwordx4 v103, s[8:11], s66 offen offset:3072 lds
    v_mfma_f32_16x16x32_bf16 v[180:183], a[112:115], a[136:139], v[180:183]
    s_add_u32 m0, s45, 32768
    v_mfma_f32_16x16x32_bf16 v[184:187], a[112:115], a[140:143], 0
    s_waitcnt lgkmcnt(4)
    ds_read_b64_tr_b16 a[112:113], v115 offset:34824
    ds_read_b64_tr_b16 a[114:115], v115 offset:35336
    v_mfma_f32_16x16x32_bf16 v[184:187], a[108:111], a[124:127], v[184:187]
    ds_read_b64_tr_b16 a[108:109], v115 offset:32776
    ds_read_b64_tr_b16 a[110:111], v115 offset:33288
    v_mfma_f32_16x16x32_bf16 v[192:195], a[84:87], a[116:119], 0
    buffer_load_dwordx4 v104, s[8:11], s66 offen offset:0 lds
    v_mfma_f32_16x16x32_bf16 v[192:195], a[88:91], a[132:135], v[192:195]
    v_mfma_f32_16x16x32_bf16 v[196:199], a[88:91], a[136:139], 0
    v_mfma_f32_16x16x32_bf16 v[196:199], a[84:87], a[120:123], v[196:199]
    v_mfma_f32_16x16x32_bf16 v[200:203], a[84:87], a[124:127], 0
    buffer_load_dwordx4 v105, s[8:11], s66 offen offset:1024 lds
    v_mfma_f32_16x16x32_bf16 v[200:203], a[88:91], a[140:143], v[200:203]
    v_mfma_f32_16x16x32_bf16 v[208:211], a[92:95], a[116:119], 0
    v_mfma_f32_16x16x32_bf16 v[208:211], a[96:99], a[132:135], v[208:211]
    v_mfma_f32_16x16x32_bf16 v[212:215], a[96:99], a[136:139], 0
    buffer_load_dwordx4 v106, s[8:11], s66 offen offset:2048 lds
    v_mfma_f32_16x16x32_bf16 v[212:215], a[92:95], a[120:123], v[212:215]
    v_mfma_f32_16x16x32_bf16 v[216:219], a[92:95], a[124:127], 0
    s_waitcnt lgkmcnt(0)
    v_mfma_f32_16x16x32_bf16 v[216:219], a[96:99], a[140:143], v[216:219]
    v_mfma_f32_16x16x32_bf16 v[224:227], a[100:103], a[116:119], 0
    v_mfma_f32_16x16x32_bf16 v[224:227], a[104:107], a[132:135], v[224:227]
    v_mfma_f32_16x16x32_bf16 v[228:231], a[104:107], a[136:139], 0
    v_mfma_f32_16x16x32_bf16 v[228:231], a[100:103], a[120:123], v[228:231]
    v_mfma_f32_16x16x32_bf16 v[232:235], a[100:103], a[124:127], 0
    v_mfma_f32_16x16x32_bf16 v[232:235], a[104:107], a[140:143], v[232:235]
    v_mfma_f32_16x16x32_bf16 v[240:243], a[108:111], a[116:119], 0
    v_mfma_f32_16x16x32_bf16 v[240:243], a[112:115], a[132:135], v[240:243]
    v_mfma_f32_16x16x32_bf16 v[244:247], a[112:115], a[136:139], 0
    v_mfma_f32_16x16x32_bf16 v[244:247], a[108:111], a[120:123], v[244:247]
    v_mfma_f32_16x16x32_bf16 v[248:251], a[108:111], a[124:127], 0
    s_waitcnt vmcnt(11) lgkmcnt(0)
    s_barrier
    ds_read_b128 a[236:239], v109 offset:57344
    v_mfma_f32_16x16x32_bf16 v[248:251], a[112:115], a[140:143], v[248:251]
    s_add_u32 m0, s44, 131072
    ds_read_b64_tr_b16 a[84:85], v112 offset:49152
    ds_read_b64_tr_b16 a[86:87], v112 offset:49664
    ds_read_b128 a[252:255], v110 offset:57344
    ds_read_b64_tr_b16 a[88:89], v112 offset:51200
    ds_read_b64_tr_b16 a[90:91], v112 offset:51712
    ds_read_b128 a[240:243], v108 offset:57344
    ds_read_b128 a[224:227], v107 offset:57344
    ds_read_b128 a[228:231], v107 offset:59392
    ds_read_b128 a[244:247], v108 offset:59392
    ds_read_b128 a[248:251], v108 offset:61440
    ds_read_b128 a[232:235], v107 offset:61440
    ds_read_b64_tr_b16 a[92:93], v112 offset:49160
    ds_read_b64_tr_b16 a[94:95], v112 offset:49672
    ds_read_b64_tr_b16 a[96:97], v112 offset:51208
    ds_read_b64_tr_b16 a[98:99], v112 offset:51720
    ds_read_b64_tr_b16 a[100:101], v113 offset:49152
    ds_read_b64_tr_b16 a[102:103], v113 offset:49664
    ds_read_b64_tr_b16 a[104:105], v113 offset:51200
    ds_read_b64_tr_b16 a[106:107], v113 offset:51712
    buffer_load_dwordx4 v96, s[20:23], s75 offen offset:0 lds
    ds_read_b64_tr_b16 a[108:109], v113 offset:49160
    ds_read_b64_tr_b16 a[110:111], v113 offset:49672
    ds_read_b64_tr_b16 a[112:113], v113 offset:51208
    ds_read_b64_tr_b16 a[114:115], v113 offset:51720
    s_waitcnt lgkmcnt(15)
    v_mfma_f32_16x16x32_bf16 v[140:143], a[84:87], a[236:239], v[140:143]
    buffer_load_dwordx4 v97, s[20:23], s75 offen offset:1024 lds
    v_mfma_f32_16x16x32_bf16 v[140:143], a[88:91], a[252:255], v[140:143]
    v_mfma_f32_16x16x32_bf16 v[128:131], a[88:91], a[240:243], v[128:131]
    v_mfma_f32_16x16x32_bf16 v[128:131], a[84:87], a[224:227], v[128:131]
    s_waitcnt lgkmcnt(8)
    v_mfma_f32_16x16x32_bf16 v[132:135], a[84:87], a[228:231], v[132:135]
    buffer_load_dwordx4 v98, s[20:23], s75 offen offset:2048 lds
    v_mfma_f32_16x16x32_bf16 v[132:135], a[88:91], a[244:247], v[132:135]
    v_mfma_f32_16x16x32_bf16 v[136:139], a[88:91], a[248:251], v[136:139]
    ds_read_b64_tr_b16 a[88:89], v114 offset:51200
    ds_read_b64_tr_b16 a[90:91], v114 offset:51712
    v_mfma_f32_16x16x32_bf16 v[136:139], a[84:87], a[232:235], v[136:139]
    ds_read_b64_tr_b16 a[84:85], v114 offset:49152
    ds_read_b64_tr_b16 a[86:87], v114 offset:49664
    v_mfma_f32_16x16x32_bf16 v[156:159], a[92:95], a[236:239], v[156:159]
    buffer_load_dwordx4 v99, s[20:23], s75 offen offset:3072 lds
    v_mfma_f32_16x16x32_bf16 v[156:159], a[96:99], a[252:255], v[156:159]
    s_add_u32 m0, s45, 57344
    v_mfma_f32_16x16x32_bf16 v[144:147], a[96:99], a[240:243], v[144:147]
    v_mfma_f32_16x16x32_bf16 v[144:147], a[92:95], a[224:227], v[144:147]
    v_mfma_f32_16x16x32_bf16 v[148:151], a[92:95], a[228:231], v[148:151]
    buffer_load_dwordx4 v100, s[8:11], s67 offen offset:0 lds
    v_mfma_f32_16x16x32_bf16 v[148:151], a[96:99], a[244:247], v[148:151]
    v_mfma_f32_16x16x32_bf16 v[152:155], a[96:99], a[248:251], v[152:155]
    s_waitcnt lgkmcnt(4)
    ds_read_b64_tr_b16 a[96:97], v114 offset:51208
    ds_read_b64_tr_b16 a[98:99], v114 offset:51720
    v_mfma_f32_16x16x32_bf16 v[152:155], a[92:95], a[232:235], v[152:155]
    ds_read_b64_tr_b16 a[92:93], v114 offset:49160
    ds_read_b64_tr_b16 a[94:95], v114 offset:49672
    v_mfma_f32_16x16x32_bf16 v[172:175], a[100:103], a[236:239], v[172:175]
    buffer_load_dwordx4 v101, s[8:11], s67 offen offset:1024 lds
    v_mfma_f32_16x16x32_bf16 v[172:175], a[104:107], a[252:255], v[172:175]
    v_mfma_f32_16x16x32_bf16 v[160:163], a[104:107], a[240:243], v[160:163]
    v_mfma_f32_16x16x32_bf16 v[160:163], a[100:103], a[224:227], v[160:163]
    v_mfma_f32_16x16x32_bf16 v[164:167], a[100:103], a[228:231], v[164:167]
    buffer_load_dwordx4 v102, s[8:11], s67 offen offset:2048 lds
    v_mfma_f32_16x16x32_bf16 v[164:167], a[104:107], a[244:247], v[164:167]
    v_mfma_f32_16x16x32_bf16 v[168:171], a[104:107], a[248:251], v[168:171]
    ds_read_b64_tr_b16 a[104:105], v115 offset:51200
    ds_read_b64_tr_b16 a[106:107], v115 offset:51712
    v_mfma_f32_16x16x32_bf16 v[168:171], a[100:103], a[232:235], v[168:171]
    ds_read_b64_tr_b16 a[100:101], v115 offset:49152
    ds_read_b64_tr_b16 a[102:103], v115 offset:49664
    v_mfma_f32_16x16x32_bf16 v[188:191], a[108:111], a[236:239], v[188:191]
    buffer_load_dwordx4 v103, s[8:11], s67 offen offset:3072 lds
    v_mfma_f32_16x16x32_bf16 v[188:191], a[112:115], a[252:255], v[188:191]
    s_add_u32 m0, s45, 61440
    v_mfma_f32_16x16x32_bf16 v[176:179], a[112:115], a[240:243], v[176:179]
    v_mfma_f32_16x16x32_bf16 v[176:179], a[108:111], a[224:227], v[176:179]
    v_mfma_f32_16x16x32_bf16 v[180:183], a[108:111], a[228:231], v[180:183]
    buffer_load_dwordx4 v104, s[8:11], s67 offen offset:0 lds
    v_mfma_f32_16x16x32_bf16 v[180:183], a[112:115], a[244:247], v[180:183]
    v_mfma_f32_16x16x32_bf16 v[184:187], a[112:115], a[248:251], v[184:187]
    s_waitcnt lgkmcnt(4)
    ds_read_b64_tr_b16 a[112:113], v115 offset:51208
    ds_read_b64_tr_b16 a[114:115], v115 offset:51720
    v_mfma_f32_16x16x32_bf16 v[184:187], a[108:111], a[232:235], v[184:187]
    ds_read_b64_tr_b16 a[108:109], v115 offset:49160
    ds_read_b64_tr_b16 a[110:111], v115 offset:49672
    v_mfma_f32_16x16x32_bf16 v[192:195], a[84:87], a[224:227], v[192:195]
    buffer_load_dwordx4 v105, s[8:11], s67 offen offset:1024 lds
    v_mfma_f32_16x16x32_bf16 v[192:195], a[88:91], a[240:243], v[192:195]
    v_mfma_f32_16x16x32_bf16 v[196:199], a[88:91], a[244:247], v[196:199]
    v_mfma_f32_16x16x32_bf16 v[196:199], a[84:87], a[228:231], v[196:199]
    v_mfma_f32_16x16x32_bf16 v[200:203], a[84:87], a[232:235], v[200:203]
    buffer_load_dwordx4 v106, s[8:11], s67 offen offset:2048 lds
    v_mfma_f32_16x16x32_bf16 v[200:203], a[88:91], a[248:251], v[200:203]
    v_mfma_f32_16x16x32_bf16 v[208:211], a[92:95], a[224:227], v[208:211]
    v_mfma_f32_16x16x32_bf16 v[208:211], a[96:99], a[240:243], v[208:211]
    v_mfma_f32_16x16x32_bf16 v[212:215], a[96:99], a[244:247], v[212:215]
    v_mfma_f32_16x16x32_bf16 v[212:215], a[92:95], a[228:231], v[212:215]
    v_mfma_f32_16x16x32_bf16 v[216:219], a[92:95], a[232:235], v[216:219]
    s_waitcnt lgkmcnt(0)
    v_mfma_f32_16x16x32_bf16 v[216:219], a[96:99], a[248:251], v[216:219]
    v_mfma_f32_16x16x32_bf16 v[224:227], a[100:103], a[224:227], v[224:227]
    v_mfma_f32_16x16x32_bf16 v[224:227], a[104:107], a[240:243], v[224:227]
    v_mfma_f32_16x16x32_bf16 v[228:231], a[104:107], a[244:247], v[228:231]
    v_mfma_f32_16x16x32_bf16 v[228:231], a[100:103], a[228:231], v[228:231]
    v_mfma_f32_16x16x32_bf16 v[232:235], a[100:103], a[232:235], v[232:235]
    v_mfma_f32_16x16x32_bf16 v[232:235], a[104:107], a[248:251], v[232:235]
    v_mfma_f32_16x16x32_bf16 v[240:243], a[108:111], a[224:227], v[240:243]
    v_mfma_f32_16x16x32_bf16 v[240:243], a[112:115], a[240:243], v[240:243]
    v_mfma_f32_16x16x32_bf16 v[244:247], a[112:115], a[244:247], v[244:247]
    v_mfma_f32_16x16x32_bf16 v[244:247], a[108:111], a[228:231], v[244:247]
    v_mfma_f32_16x16x32_bf16 v[248:251], a[108:111], a[232:235], v[248:251]
    s_waitcnt vmcnt(11) lgkmcnt(0)
    s_barrier
    ds_read_b128 a[128:131], v109 offset:0
    v_mfma_f32_16x16x32_bf16 v[248:251], a[112:115], a[248:251], v[248:251]
    s_add_u32 m0, s44, 147456
    ds_read_b64_tr_b16 a[84:85], v112 offset:16384
    ds_read_b64_tr_b16 a[86:87], v112 offset:16896
    ds_read_b128 a[144:147], v110 offset:0
    ds_read_b64_tr_b16 a[88:89], v112 offset:18432
    ds_read_b64_tr_b16 a[90:91], v112 offset:18944
    ds_read_b128 a[132:135], v108 offset:0
    ds_read_b128 a[116:119], v107 offset:0
    ds_read_b128 a[120:123], v107 offset:2048
    ds_read_b128 a[136:139], v108 offset:2048
    ds_read_b128 a[140:143], v108 offset:4096
    ds_read_b128 a[124:127], v107 offset:4096
    ds_read_b64_tr_b16 a[92:93], v112 offset:16392
    ds_read_b64_tr_b16 a[94:95], v112 offset:16904
    ds_read_b64_tr_b16 a[96:97], v112 offset:18440
    ds_read_b64_tr_b16 a[98:99], v112 offset:18952
    buffer_load_dwordx4 v96, s[20:23], s76 offen offset:0 lds
    ds_read_b64_tr_b16 a[100:101], v113 offset:16384
    ds_read_b64_tr_b16 a[102:103], v113 offset:16896
    ds_read_b64_tr_b16 a[104:105], v113 offset:18432
    ds_read_b64_tr_b16 a[106:107], v113 offset:18944
    ds_read_b64_tr_b16 a[108:109], v113 offset:16392
    ds_read_b64_tr_b16 a[110:111], v113 offset:16904
    ds_read_b64_tr_b16 a[112:113], v113 offset:18440
    ds_read_b64_tr_b16 a[114:115], v113 offset:18952
    s_waitcnt lgkmcnt(15)
    v_mfma_f32_16x16x32_bf16 v[140:143], a[84:87], a[128:131], v[140:143]
    buffer_load_dwordx4 v97, s[20:23], s76 offen offset:1024 lds
    v_mfma_f32_16x16x32_bf16 v[140:143], a[88:91], a[144:147], v[140:143]
    v_mfma_f32_16x16x32_bf16 v[128:131], a[88:91], a[132:135], v[128:131]
    v_mfma_f32_16x16x32_bf16 v[128:131], a[84:87], a[116:119], v[128:131]
    s_waitcnt lgkmcnt(8)
    v_mfma_f32_16x16x32_bf16 v[132:135], a[84:87], a[120:123], v[132:135]
    buffer_load_dwordx4 v98, s[20:23], s76 offen offset:2048 lds
    v_mfma_f32_16x16x32_bf16 v[132:135], a[88:91], a[136:139], v[132:135]
    v_mfma_f32_16x16x32_bf16 v[136:139], a[88:91], a[140:143], v[136:139]
    ds_read_b64_tr_b16 a[88:89], v114 offset:18432
    ds_read_b64_tr_b16 a[90:91], v114 offset:18944
    v_mfma_f32_16x16x32_bf16 v[136:139], a[84:87], a[124:127], v[136:139]
    ds_read_b64_tr_b16 a[84:85], v114 offset:16384
    ds_read_b64_tr_b16 a[86:87], v114 offset:16896
    v_mfma_f32_16x16x32_bf16 v[156:159], a[92:95], a[128:131], v[156:159]
    buffer_load_dwordx4 v99, s[20:23], s76 offen offset:3072 lds
    v_mfma_f32_16x16x32_bf16 v[156:159], a[96:99], a[144:147], v[156:159]
    s_add_u32 m0, s45, 86016
    v_mfma_f32_16x16x32_bf16 v[144:147], a[96:99], a[132:135], v[144:147]
    v_mfma_f32_16x16x32_bf16 v[144:147], a[92:95], a[116:119], v[144:147]
    v_mfma_f32_16x16x32_bf16 v[148:151], a[92:95], a[120:123], v[148:151]
    buffer_load_dwordx4 v100, s[8:11], s68 offen offset:0 lds
    v_mfma_f32_16x16x32_bf16 v[148:151], a[96:99], a[136:139], v[148:151]
    v_mfma_f32_16x16x32_bf16 v[152:155], a[96:99], a[140:143], v[152:155]
    s_waitcnt lgkmcnt(4)
    ds_read_b64_tr_b16 a[96:97], v114 offset:18440
    ds_read_b64_tr_b16 a[98:99], v114 offset:18952
    v_mfma_f32_16x16x32_bf16 v[152:155], a[92:95], a[124:127], v[152:155]
    ds_read_b64_tr_b16 a[92:93], v114 offset:16392
    ds_read_b64_tr_b16 a[94:95], v114 offset:16904
    v_mfma_f32_16x16x32_bf16 v[172:175], a[100:103], a[128:131], v[172:175]
    buffer_load_dwordx4 v101, s[8:11], s68 offen offset:1024 lds
    v_mfma_f32_16x16x32_bf16 v[172:175], a[104:107], a[144:147], v[172:175]
    v_mfma_f32_16x16x32_bf16 v[160:163], a[104:107], a[132:135], v[160:163]
    v_mfma_f32_16x16x32_bf16 v[160:163], a[100:103], a[116:119], v[160:163]
    v_mfma_f32_16x16x32_bf16 v[164:167], a[100:103], a[120:123], v[164:167]
    buffer_load_dwordx4 v102, s[8:11], s68 offen offset:2048 lds
    v_mfma_f32_16x16x32_bf16 v[164:167], a[104:107], a[136:139], v[164:167]
    v_mfma_f32_16x16x32_bf16 v[168:171], a[104:107], a[140:143], v[168:171]
    ds_read_b64_tr_b16 a[104:105], v115 offset:18432
    ds_read_b64_tr_b16 a[106:107], v115 offset:18944
    v_mfma_f32_16x16x32_bf16 v[168:171], a[100:103], a[124:127], v[168:171]
    ds_read_b64_tr_b16 a[100:101], v115 offset:16384
    ds_read_b64_tr_b16 a[102:103], v115 offset:16896
    v_mfma_f32_16x16x32_bf16 v[188:191], a[108:111], a[128:131], v[188:191]
    buffer_load_dwordx4 v103, s[8:11], s68 offen offset:3072 lds
    v_mfma_f32_16x16x32_bf16 v[188:191], a[112:115], a[144:147], v[188:191]
    s_add_u32 m0, s45, 90112
    v_mfma_f32_16x16x32_bf16 v[176:179], a[112:115], a[132:135], v[176:179]
    v_mfma_f32_16x16x32_bf16 v[176:179], a[108:111], a[116:119], v[176:179]
    v_mfma_f32_16x16x32_bf16 v[180:183], a[108:111], a[120:123], v[180:183]
    buffer_load_dwordx4 v104, s[8:11], s68 offen offset:0 lds
    v_mfma_f32_16x16x32_bf16 v[180:183], a[112:115], a[136:139], v[180:183]
    v_mfma_f32_16x16x32_bf16 v[184:187], a[112:115], a[140:143], v[184:187]
    s_waitcnt lgkmcnt(4)
    ds_read_b64_tr_b16 a[112:113], v115 offset:18440
    ds_read_b64_tr_b16 a[114:115], v115 offset:18952
    v_mfma_f32_16x16x32_bf16 v[184:187], a[108:111], a[124:127], v[184:187]
    ds_read_b64_tr_b16 a[108:109], v115 offset:16392
    ds_read_b64_tr_b16 a[110:111], v115 offset:16904
    v_mfma_f32_16x16x32_bf16 v[192:195], a[84:87], a[116:119], v[192:195]
    buffer_load_dwordx4 v105, s[8:11], s68 offen offset:1024 lds
    v_mfma_f32_16x16x32_bf16 v[192:195], a[88:91], a[132:135], v[192:195]
    v_mfma_f32_16x16x32_bf16 v[196:199], a[88:91], a[136:139], v[196:199]
    v_mfma_f32_16x16x32_bf16 v[196:199], a[84:87], a[120:123], v[196:199]
    v_mfma_f32_16x16x32_bf16 v[200:203], a[84:87], a[124:127], v[200:203]
    buffer_load_dwordx4 v106, s[8:11], s68 offen offset:2048 lds
    v_mfma_f32_16x16x32_bf16 v[200:203], a[88:91], a[140:143], v[200:203]
    s_add_u32 m0, s44, 0
    v_mfma_f32_16x16x32_bf16 v[208:211], a[92:95], a[116:119], v[208:211]
    v_mfma_f32_16x16x32_bf16 v[208:211], a[96:99], a[132:135], v[208:211]
    v_mfma_f32_16x16x32_bf16 v[212:215], a[96:99], a[136:139], v[212:215]
    buffer_load_dwordx4 v14, s[12:15], s84 offen offset:0 nt lds
    v_mfma_f32_16x16x32_bf16 v[212:215], a[92:95], a[120:123], v[212:215]
    v_mfma_f32_16x16x32_bf16 v[216:219], a[92:95], a[124:127], v[216:219]
    s_waitcnt lgkmcnt(0)
    v_mfma_f32_16x16x32_bf16 v[216:219], a[96:99], a[140:143], v[216:219]
    v_mfma_f32_16x16x32_bf16 v[224:227], a[100:103], a[116:119], v[224:227]
    buffer_load_dwordx4 v15, s[12:15], s84 offen offset:1024 nt lds
    v_mfma_f32_16x16x32_bf16 v[224:227], a[104:107], a[132:135], v[224:227]
    v_mfma_f32_16x16x32_bf16 v[228:231], a[104:107], a[136:139], v[228:231]
    v_mfma_f32_16x16x32_bf16 v[228:231], a[100:103], a[120:123], v[228:231]
    v_mfma_f32_16x16x32_bf16 v[232:235], a[100:103], a[124:127], v[232:235]
    buffer_load_dwordx4 v16, s[12:15], s84 offen offset:2048 nt lds
    v_mfma_f32_16x16x32_bf16 v[232:235], a[104:107], a[140:143], v[232:235]
    v_mfma_f32_16x16x32_bf16 v[240:243], a[108:111], a[116:119], v[240:243]
    v_mfma_f32_16x16x32_bf16 v[240:243], a[112:115], a[132:135], v[240:243]
    v_mfma_f32_16x16x32_bf16 v[244:247], a[112:115], a[136:139], v[244:247]
    buffer_load_dwordx4 v17, s[12:15], s84 offen offset:3072 nt lds
    v_mfma_f32_16x16x32_bf16 v[244:247], a[108:111], a[120:123], v[244:247]
    v_mfma_f32_16x16x32_bf16 v[248:251], a[108:111], a[124:127], v[248:251]
    s_waitcnt vmcnt(15) lgkmcnt(0)
    s_barrier
    ds_read_b128 a[236:239], v109 offset:28672
    v_mfma_f32_16x16x32_bf16 v[248:251], a[112:115], a[140:143], v[248:251]
    s_add_u32 m0, s44, 114688
    ds_read_b64_tr_b16 a[84:85], v112 offset:32768
    ds_read_b64_tr_b16 a[86:87], v112 offset:33280
    ds_read_b128 a[252:255], v110 offset:28672
    ds_read_b64_tr_b16 a[88:89], v112 offset:34816
    ds_read_b64_tr_b16 a[90:91], v112 offset:35328
    ds_read_b128 a[240:243], v108 offset:28672
    ds_read_b128 a[224:227], v107 offset:28672
    ds_read_b128 a[228:231], v107 offset:30720
    ds_read_b128 a[244:247], v108 offset:30720
    ds_read_b128 a[248:251], v108 offset:32768
    buffer_load_dwordx4 a[148:151], v18, s[16:19], s84 offen offset:0 nt
    ds_read_b128 a[232:235], v107 offset:32768
    ds_read_b64_tr_b16 a[92:93], v112 offset:32776
    ds_read_b64_tr_b16 a[94:95], v112 offset:33288
    ds_read_b64_tr_b16 a[96:97], v112 offset:34824
    ds_read_b64_tr_b16 a[98:99], v112 offset:35336
    ds_read_b64_tr_b16 a[100:101], v113 offset:32768
    ds_read_b64_tr_b16 a[102:103], v113 offset:33280
    ds_read_b64_tr_b16 a[104:105], v113 offset:34816
    ds_read_b64_tr_b16 a[106:107], v113 offset:35328
    ds_read_b64_tr_b16 a[108:109], v113 offset:32776
    ds_read_b64_tr_b16 a[110:111], v113 offset:33288
    ds_read_b64_tr_b16 a[112:113], v113 offset:34824
    buffer_load_dwordx4 a[152:155], v19, s[16:19], s84 offen offset:1024 nt
    ds_read_b64_tr_b16 a[114:115], v113 offset:35336
    s_waitcnt lgkmcnt(15)
    v_mfma_f32_16x16x32_bf16 v[140:143], a[84:87], a[236:239], v[140:143]
    v_mfma_f32_16x16x32_bf16 v[140:143], a[88:91], a[252:255], v[140:143]
    buffer_load_dwordx4 a[156:159], v20, s[16:19], s84 offen offset:2048 nt
    v_mfma_f32_16x16x32_bf16 v[128:131], a[88:91], a[240:243], v[128:131]
    v_mfma_f32_16x16x32_bf16 v[128:131], a[84:87], a[224:227], v[128:131]
    s_waitcnt lgkmcnt(10)
    v_mfma_f32_16x16x32_bf16 v[132:135], a[84:87], a[228:231], v[132:135]
    v_mfma_f32_16x16x32_bf16 v[132:135], a[88:91], a[244:247], v[132:135]
    buffer_load_dwordx4 a[160:163], v21, s[16:19], s84 offen offset:3072 nt
    v_mfma_f32_16x16x32_bf16 v[136:139], a[88:91], a[248:251], v[136:139]
    ds_read_b64_tr_b16 a[88:89], v114 offset:34816
    ds_read_b64_tr_b16 a[90:91], v114 offset:35328
    v_mfma_f32_16x16x32_bf16 v[136:139], a[84:87], a[232:235], v[136:139]
    s_waitcnt lgkmcnt(2)
    ds_read_b64_tr_b16 a[84:85], v114 offset:32768
    ds_read_b64_tr_b16 a[86:87], v114 offset:33280
    v_mfma_f32_16x16x32_bf16 v[156:159], a[92:95], a[236:239], v[156:159]
    v_mfma_f32_16x16x32_bf16 v[156:159], a[96:99], a[252:255], v[156:159]
    v_mfma_f32_16x16x32_bf16 v[144:147], a[96:99], a[240:243], v[144:147]
    v_mfma_f32_16x16x32_bf16 v[144:147], a[92:95], a[224:227], v[144:147]
    v_mfma_f32_16x16x32_bf16 v[148:151], a[92:95], a[228:231], v[148:151]
    v_mfma_f32_16x16x32_bf16 v[148:151], a[96:99], a[244:247], v[148:151]
    v_mfma_f32_16x16x32_bf16 v[152:155], a[96:99], a[248:251], v[152:155]
    ds_read_b64_tr_b16 a[96:97], v114 offset:34824
    ds_read_b64_tr_b16 a[98:99], v114 offset:35336
    v_mfma_f32_16x16x32_bf16 v[152:155], a[92:95], a[232:235], v[152:155]
    ds_read_b64_tr_b16 a[92:93], v114 offset:32776
    ds_read_b64_tr_b16 a[94:95], v114 offset:33288
    v_mfma_f32_16x16x32_bf16 v[172:175], a[100:103], a[236:239], v[172:175]
    v_mfma_f32_16x16x32_bf16 v[172:175], a[104:107], a[252:255], v[172:175]
    v_mfma_f32_16x16x32_bf16 v[160:163], a[104:107], a[240:243], v[160:163]
    v_mfma_f32_16x16x32_bf16 v[160:163], a[100:103], a[224:227], v[160:163]
    v_mfma_f32_16x16x32_bf16 v[164:167], a[100:103], a[228:231], v[164:167]
    v_mfma_f32_16x16x32_bf16 v[164:167], a[104:107], a[244:247], v[164:167]
    v_mfma_f32_16x16x32_bf16 v[168:171], a[104:107], a[248:251], v[168:171]
    ds_read_b64_tr_b16 a[104:105], v115 offset:34816
    ds_read_b64_tr_b16 a[106:107], v115 offset:35328
    v_mfma_f32_16x16x32_bf16 v[168:171], a[100:103], a[232:235], v[168:171]
    ds_read_b64_tr_b16 a[100:101], v115 offset:32768
    ds_read_b64_tr_b16 a[102:103], v115 offset:33280
    v_mfma_f32_16x16x32_bf16 v[188:191], a[108:111], a[236:239], v[188:191]
    v_mfma_f32_16x16x32_bf16 v[188:191], a[112:115], a[252:255], v[188:191]
    v_mfma_f32_16x16x32_bf16 v[176:179], a[112:115], a[240:243], v[176:179]
    v_mfma_f32_16x16x32_bf16 v[176:179], a[108:111], a[224:227], v[176:179]
    v_mfma_f32_16x16x32_bf16 v[180:183], a[108:111], a[228:231], v[180:183]
    v_mfma_f32_16x16x32_bf16 v[180:183], a[112:115], a[244:247], v[180:183]
    v_mfma_f32_16x16x32_bf16 v[184:187], a[112:115], a[248:251], v[184:187]
    s_waitcnt lgkmcnt(4)
    ds_read_b64_tr_b16 a[112:113], v115 offset:34824
    ds_read_b64_tr_b16 a[114:115], v115 offset:35336
    v_mfma_f32_16x16x32_bf16 v[184:187], a[108:111], a[232:235], v[184:187]
    ds_read_b64_tr_b16 a[108:109], v115 offset:32776
    ds_read_b64_tr_b16 a[110:111], v115 offset:33288
    v_mfma_f32_16x16x32_bf16 v[192:195], a[84:87], a[224:227], v[192:195]
    v_mfma_f32_16x16x32_bf16 v[192:195], a[88:91], a[240:243], v[192:195]
    v_mfma_f32_16x16x32_bf16 v[196:199], a[88:91], a[244:247], v[196:199]
    v_mfma_f32_16x16x32_bf16 v[196:199], a[84:87], a[228:231], v[196:199]
    v_mfma_f32_16x16x32_bf16 v[200:203], a[84:87], a[232:235], v[200:203]
    v_mfma_f32_16x16x32_bf16 v[200:203], a[88:91], a[248:251], v[200:203]
    buffer_load_dwordx4 v96, s[20:23], s77 offen offset:0 lds
    v_mfma_f32_16x16x32_bf16 v[208:211], a[92:95], a[224:227], v[208:211]
    v_mfma_f32_16x16x32_bf16 v[208:211], a[96:99], a[240:243], v[208:211]
    v_mfma_f32_16x16x32_bf16 v[212:215], a[96:99], a[244:247], v[212:215]
    v_mfma_f32_16x16x32_bf16 v[212:215], a[92:95], a[228:231], v[212:215]
    buffer_load_dwordx4 v97, s[20:23], s77 offen offset:1024 lds
    v_mfma_f32_16x16x32_bf16 v[216:219], a[92:95], a[232:235], v[216:219]
    s_waitcnt lgkmcnt(0)
    v_mfma_f32_16x16x32_bf16 v[216:219], a[96:99], a[248:251], v[216:219]
    v_mfma_f32_16x16x32_bf16 v[224:227], a[100:103], a[224:227], v[224:227]
    v_mfma_f32_16x16x32_bf16 v[224:227], a[104:107], a[240:243], v[224:227]
    buffer_load_dwordx4 v98, s[20:23], s77 offen offset:2048 lds
    v_mfma_f32_16x16x32_bf16 v[228:231], a[104:107], a[244:247], v[228:231]
    v_mfma_f32_16x16x32_bf16 v[228:231], a[100:103], a[228:231], v[228:231]
    v_mfma_f32_16x16x32_bf16 v[232:235], a[100:103], a[232:235], v[232:235]
    v_mfma_f32_16x16x32_bf16 v[232:235], a[104:107], a[248:251], v[232:235]
    buffer_load_dwordx4 v99, s[20:23], s77 offen offset:3072 lds
    v_mfma_f32_16x16x32_bf16 v[240:243], a[108:111], a[224:227], v[240:243]
    s_add_u32 m0, s45, 28672
    s_waitcnt vmcnt(12) lgkmcnt(0)
    s_barrier
    v_mfma_f32_16x16x32_bf16 v[240:243], a[112:115], a[240:243], v[240:243]
    ds_read_b128 a[128:131], v109 offset:57344
    ds_read_b64_tr_b16 a[84:85], v112 offset:49152
    v_mfma_f32_16x16x32_bf16 v[244:247], a[112:115], a[244:247], v[244:247]
    ds_read_b64_tr_b16 a[86:87], v112 offset:49664
    ds_read_b128 a[144:147], v110 offset:57344
    v_mfma_f32_16x16x32_bf16 v[244:247], a[108:111], a[228:231], v[244:247]
    ds_read_b64_tr_b16 a[88:89], v112 offset:51200
    ds_read_b64_tr_b16 a[90:91], v112 offset:51712
    v_mfma_f32_16x16x32_bf16 v[248:251], a[108:111], a[232:235], v[248:251]
    ds_read_b128 a[132:135], v108 offset:57344
    ds_read_b128 a[116:119], v107 offset:57344
    v_mfma_f32_16x16x32_bf16 v[248:251], a[112:115], a[248:251], v[248:251]
    ds_read_b128 a[120:123], v107 offset:59392
    ds_read_b128 a[136:139], v108 offset:59392
    ds_read_b128 a[140:143], v108 offset:61440
    buffer_load_dwordx4 v100, s[8:11], s69 offen offset:0 lds
    ds_read_b128 a[124:127], v107 offset:61440
    ds_read_b64_tr_b16 a[92:93], v112 offset:49160
    ds_read_b64_tr_b16 a[94:95], v112 offset:49672
    ds_read_b64_tr_b16 a[96:97], v112 offset:51208
    ds_read_b64_tr_b16 a[98:99], v112 offset:51720
    ds_read_b64_tr_b16 a[100:101], v113 offset:49152
    ds_read_b64_tr_b16 a[102:103], v113 offset:49664
    ds_read_b64_tr_b16 a[104:105], v113 offset:51200
    ds_read_b64_tr_b16 a[106:107], v113 offset:51712
    ds_read_b64_tr_b16 a[108:109], v113 offset:49160
    ds_read_b64_tr_b16 a[110:111], v113 offset:49672
    ds_read_b64_tr_b16 a[112:113], v113 offset:51208
    buffer_load_dwordx4 v101, s[8:11], s69 offen offset:1024 lds
    s_waitcnt lgkmcnt(15)
    v_mfma_f32_16x16x32_bf16 v[140:143], a[84:87], a[128:131], v[140:143]
    ds_read_b64_tr_b16 a[114:115], v113 offset:51720
    v_mfma_f32_16x16x32_bf16 v[140:143], a[88:91], a[144:147], v[140:143]
    v_mfma_f32_16x16x32_bf16 v[128:131], a[88:91], a[132:135], v[128:131]
    buffer_load_dwordx4 v102, s[8:11], s69 offen offset:2048 lds
    v_mfma_f32_16x16x32_bf16 v[128:131], a[84:87], a[116:119], v[128:131]
    s_waitcnt lgkmcnt(13)
    v_mfma_f32_16x16x32_bf16 v[132:135], a[84:87], a[120:123], v[132:135]
    v_mfma_f32_16x16x32_bf16 v[132:135], a[88:91], a[136:139], v[132:135]
    s_waitcnt lgkmcnt(7)
    v_mfma_f32_16x16x32_bf16 v[136:139], a[88:91], a[140:143], v[136:139]
    buffer_load_dwordx4 v103, s[8:11], s69 offen offset:3072 lds
    v_mfma_f32_16x16x32_bf16 v[136:139], a[84:87], a[124:127], v[136:139]
    s_add_u32 m0, s45, 32768
    ds_read_b64_tr_b16 a[84:85], v114 offset:49152
    ds_read_b64_tr_b16 a[86:87], v114 offset:49664
    v_mfma_f32_16x16x32_bf16 v[156:159], a[92:95], a[128:131], v[156:159]
    ds_read_b64_tr_b16 a[88:89], v114 offset:51200
    ds_read_b64_tr_b16 a[90:91], v114 offset:51712
    v_mfma_f32_16x16x32_bf16 v[156:159], a[96:99], a[144:147], v[156:159]
    v_mfma_f32_16x16x32_bf16 v[144:147], a[96:99], a[132:135], v[144:147]
    buffer_load_dwordx4 v104, s[8:11], s69 offen offset:0 lds
    v_mfma_f32_16x16x32_bf16 v[144:147], a[92:95], a[116:119], v[144:147]
    v_mfma_f32_16x16x32_bf16 v[148:151], a[92:95], a[120:123], v[148:151]
    v_mfma_f32_16x16x32_bf16 v[148:151], a[96:99], a[136:139], v[148:151]
    v_mfma_f32_16x16x32_bf16 v[152:155], a[96:99], a[140:143], v[152:155]
    s_waitcnt lgkmcnt(4)
    buffer_load_dwordx4 v105, s[8:11], s69 offen offset:1024 lds
    v_mfma_f32_16x16x32_bf16 v[152:155], a[92:95], a[124:127], v[152:155]
    ds_read_b64_tr_b16 a[92:93], v114 offset:49160
    ds_read_b64_tr_b16 a[94:95], v114 offset:49672
    v_mfma_f32_16x16x32_bf16 v[172:175], a[100:103], a[128:131], v[172:175]
    ds_read_b64_tr_b16 a[96:97], v114 offset:51208
    ds_read_b64_tr_b16 a[98:99], v114 offset:51720
    v_mfma_f32_16x16x32_bf16 v[172:175], a[104:107], a[144:147], v[172:175]
    v_mfma_f32_16x16x32_bf16 v[160:163], a[104:107], a[132:135], v[160:163]
    buffer_load_dwordx4 v106, s[8:11], s69 offen offset:2048 lds
    v_mfma_f32_16x16x32_bf16 v[160:163], a[100:103], a[116:119], v[160:163]
    s_add_u32 m0, s44, 131072
    v_mfma_f32_16x16x32_bf16 v[164:167], a[100:103], a[120:123], v[164:167]
    v_mfma_f32_16x16x32_bf16 v[164:167], a[104:107], a[136:139], v[164:167]
    v_mfma_f32_16x16x32_bf16 v[168:171], a[104:107], a[140:143], v[168:171]
    buffer_load_dwordx4 v96, s[20:23], s78 offen offset:0 lds
    v_mfma_f32_16x16x32_bf16 v[168:171], a[100:103], a[124:127], v[168:171]
    ds_read_b64_tr_b16 a[100:101], v115 offset:49152
    ds_read_b64_tr_b16 a[102:103], v115 offset:49664
    v_mfma_f32_16x16x32_bf16 v[188:191], a[108:111], a[128:131], v[188:191]
    ds_read_b64_tr_b16 a[104:105], v115 offset:51200
    ds_read_b64_tr_b16 a[106:107], v115 offset:51712
    v_mfma_f32_16x16x32_bf16 v[188:191], a[112:115], a[144:147], v[188:191]
    v_mfma_f32_16x16x32_bf16 v[176:179], a[112:115], a[132:135], v[176:179]
    buffer_load_dwordx4 v97, s[20:23], s78 offen offset:1024 lds
    v_mfma_f32_16x16x32_bf16 v[176:179], a[108:111], a[116:119], v[176:179]
    v_mfma_f32_16x16x32_bf16 v[180:183], a[108:111], a[120:123], v[180:183]
    v_mfma_f32_16x16x32_bf16 v[180:183], a[112:115], a[136:139], v[180:183]
    v_mfma_f32_16x16x32_bf16 v[184:187], a[112:115], a[140:143], v[184:187]
    s_waitcnt lgkmcnt(4)
    buffer_load_dwordx4 v98, s[20:23], s78 offen offset:2048 lds
    v_mfma_f32_16x16x32_bf16 v[184:187], a[108:111], a[124:127], v[184:187]
    ds_read_b64_tr_b16 a[108:109], v115 offset:49160
    ds_read_b64_tr_b16 a[110:111], v115 offset:49672
    v_mfma_f32_16x16x32_bf16 v[192:195], a[84:87], a[116:119], v[192:195]
    ds_read_b64_tr_b16 a[112:113], v115 offset:51208
    ds_read_b64_tr_b16 a[114:115], v115 offset:51720
    v_mfma_f32_16x16x32_bf16 v[192:195], a[88:91], a[132:135], v[192:195]
    v_mfma_f32_16x16x32_bf16 v[196:199], a[88:91], a[136:139], v[196:199]
    buffer_load_dwordx4 v99, s[20:23], s78 offen offset:3072 lds
    v_mfma_f32_16x16x32_bf16 v[196:199], a[84:87], a[120:123], v[196:199]
    s_add_u32 m0, s45, 57344
    v_mfma_f32_16x16x32_bf16 v[200:203], a[84:87], a[124:127], v[200:203]
    v_mfma_f32_16x16x32_bf16 v[200:203], a[88:91], a[140:143], v[200:203]
    v_mfma_f32_16x16x32_bf16 v[208:211], a[92:95], a[116:119], v[208:211]
    buffer_load_dwordx4 v100, s[8:11], s70 offen offset:0 lds
    v_mfma_f32_16x16x32_bf16 v[208:211], a[96:99], a[132:135], v[208:211]
    v_mfma_f32_16x16x32_bf16 v[212:215], a[96:99], a[136:139], v[212:215]
    v_mfma_f32_16x16x32_bf16 v[212:215], a[92:95], a[120:123], v[212:215]
    v_mfma_f32_16x16x32_bf16 v[216:219], a[92:95], a[124:127], v[216:219]
    s_waitcnt lgkmcnt(0)
    buffer_load_dwordx4 v101, s[8:11], s70 offen offset:1024 lds
    v_mfma_f32_16x16x32_bf16 v[216:219], a[96:99], a[140:143], v[216:219]
    v_mfma_f32_16x16x32_bf16 v[224:227], a[100:103], a[116:119], v[224:227]
    v_mfma_f32_16x16x32_bf16 v[224:227], a[104:107], a[132:135], v[224:227]
    v_mfma_f32_16x16x32_bf16 v[228:231], a[104:107], a[136:139], v[228:231]
    buffer_load_dwordx4 v102, s[8:11], s70 offen offset:2048 lds
    v_mfma_f32_16x16x32_bf16 v[228:231], a[100:103], a[120:123], v[228:231]
    s_waitcnt vmcnt(7) lgkmcnt(0)
    s_barrier
    ds_read_b128 a[236:239], v109 offset:0
    v_mfma_f32_16x16x32_bf16 v[232:235], a[100:103], a[124:127], v[232:235]
    ds_read_b64_tr_b16 a[84:85], v112 offset:16384
    ds_read_b64_tr_b16 a[86:87], v112 offset:16896
    v_mfma_f32_16x16x32_bf16 v[232:235], a[104:107], a[140:143], v[232:235]
    ds_read_b128 a[252:255], v110 offset:0
    ds_read_b64_tr_b16 a[88:89], v112 offset:18432
    v_mfma_f32_16x16x32_bf16 v[240:243], a[108:111], a[116:119], v[240:243]
    buffer_load_dwordx4 v103, s[8:11], s70 offen offset:3072 lds
    v_mfma_f32_16x16x32_bf16 v[240:243], a[112:115], a[132:135], v[240:243]
    s_add_u32 m0, s45, 61440
    ds_read_b64_tr_b16 a[90:91], v112 offset:18944
    ds_read_b128 a[240:243], v108 offset:0
    v_mfma_f32_16x16x32_bf16 v[244:247], a[112:115], a[136:139], v[244:247]
    ds_read_b128 a[224:227], v107 offset:0
    ds_read_b128 a[228:231], v107 offset:2048
    v_mfma_f32_16x16x32_bf16 v[244:247], a[108:111], a[120:123], v[244:247]
    ds_read_b128 a[244:247], v108 offset:2048
    ds_read_b128 a[248:251], v108 offset:4096
    v_mfma_f32_16x16x32_bf16 v[248:251], a[108:111], a[124:127], v[248:251]
    buffer_load_dwordx4 v104, s[8:11], s70 offen offset:0 lds
    v_mfma_f32_16x16x32_bf16 v[248:251], a[112:115], a[140:143], v[248:251]
    ds_read_b128 a[232:235], v107 offset:4096
    ds_read_b64_tr_b16 a[92:93], v112 offset:16392
    ds_read_b64_tr_b16 a[94:95], v112 offset:16904
    ds_read_b64_tr_b16 a[96:97], v112 offset:18440
    s_waitcnt lgkmcnt(12)
    v_mfma_f32_16x16x32_bf16 v[140:143], a[84:87], a[236:239], v[140:143]
    ds_read_b64_tr_b16 a[98:99], v112 offset:18952
    ds_read_b64_tr_b16 a[100:101], v113 offset:16384
    ds_read_b64_tr_b16 a[102:103], v113 offset:16896
    buffer_load_dwordx4 v105, s[8:11], s70 offen offset:1024 lds
    ds_read_b64_tr_b16 a[104:105], v113 offset:18432
    ds_read_b64_tr_b16 a[106:107], v113 offset:18944
    ds_read_b64_tr_b16 a[108:109], v113 offset:16392
    s_waitcnt lgkmcnt(15)
    v_mfma_f32_16x16x32_bf16 v[140:143], a[88:91], a[252:255], v[140:143]
    s_waitcnt lgkmcnt(14)
    ds_read_b64_tr_b16 a[110:111], v113 offset:16904
    ds_read_b64_tr_b16 a[112:113], v113 offset:18440
    v_mfma_f32_16x16x32_bf16 v[128:131], a[88:91], a[240:243], v[128:131]
    s_waitcnt lgkmcnt(14)
    ds_read_b64_tr_b16 a[114:115], v113 offset:18952
    v_mfma_f32_16x16x32_bf16 v[128:131], a[84:87], a[224:227], v[128:131]
    s_waitcnt lgkmcnt(13)
    buffer_load_dwordx4 v106, s[8:11], s70 offen offset:2048 lds
    v_mfma_f32_16x16x32_bf16 v[132:135], a[84:87], a[228:231], v[132:135]
    s_add_u32 m0, s44, 147456
    v_mfma_f32_16x16x32_bf16 v[132:135], a[88:91], a[244:247], v[132:135]
    s_waitcnt lgkmcnt(11)
    v_mfma_f32_16x16x32_bf16 v[136:139], a[88:91], a[248:251], v[136:139]
    s_waitcnt lgkmcnt(9)
    ds_read_b64_tr_b16 a[88:89], v114 offset:18432
    ds_read_b64_tr_b16 a[90:91], v114 offset:18944
    v_mfma_f32_16x16x32_bf16 v[136:139], a[84:87], a[232:235], v[136:139]
    s_waitcnt lgkmcnt(8)
    buffer_load_dwordx4 v96, s[20:23], s79 offen offset:0 lds
    v_mfma_f32_16x16x32_bf16 v[156:159], a[92:95], a[236:239], v[156:159]
    ds_read_b64_tr_b16 a[84:85], v114 offset:16384
    ds_read_b64_tr_b16 a[86:87], v114 offset:16896
    v_mfma_f32_16x16x32_bf16 v[156:159], a[96:99], a[252:255], v[156:159]
    v_mfma_f32_16x16x32_bf16 v[144:147], a[96:99], a[240:243], v[144:147]
    v_mfma_f32_16x16x32_bf16 v[144:147], a[92:95], a[224:227], v[144:147]
    buffer_load_dwordx4 v97, s[20:23], s79 offen offset:1024 lds
    v_mfma_f32_16x16x32_bf16 v[148:151], a[92:95], a[228:231], v[148:151]
    v_mfma_f32_16x16x32_bf16 v[148:151], a[96:99], a[244:247], v[148:151]
    v_mfma_f32_16x16x32_bf16 v[152:155], a[96:99], a[248:251], v[152:155]
    ds_read_b64_tr_b16 a[96:97], v114 offset:18440
    ds_read_b64_tr_b16 a[98:99], v114 offset:18952
    v_mfma_f32_16x16x32_bf16 v[152:155], a[92:95], a[232:235], v[152:155]
    s_waitcnt lgkmcnt(4)
    buffer_load_dwordx4 v98, s[20:23], s79 offen offset:2048 lds
    v_mfma_f32_16x16x32_bf16 v[172:175], a[100:103], a[236:239], v[172:175]
    ds_read_b64_tr_b16 a[92:93], v114 offset:16392
    ds_read_b64_tr_b16 a[94:95], v114 offset:16904
    v_mfma_f32_16x16x32_bf16 v[172:175], a[104:107], a[252:255], v[172:175]
    v_mfma_f32_16x16x32_bf16 v[160:163], a[104:107], a[240:243], v[160:163]
    v_mfma_f32_16x16x32_bf16 v[160:163], a[100:103], a[224:227], v[160:163]
    buffer_load_dwordx4 v99, s[20:23], s79 offen offset:3072 lds
    v_mfma_f32_16x16x32_bf16 v[164:167], a[100:103], a[228:231], v[164:167]
    s_add_u32 m0, s45, 86016
    v_mfma_f32_16x16x32_bf16 v[164:167], a[104:107], a[244:247], v[164:167]
    v_mfma_f32_16x16x32_bf16 v[168:171], a[104:107], a[248:251], v[168:171]
    ds_read_b64_tr_b16 a[104:105], v115 offset:18432
    ds_read_b64_tr_b16 a[106:107], v115 offset:18944
    v_mfma_f32_16x16x32_bf16 v[168:171], a[100:103], a[232:235], v[168:171]
    buffer_load_dwordx4 v100, s[8:11], s71 offen offset:0 lds
    v_mfma_f32_16x16x32_bf16 v[188:191], a[108:111], a[236:239], v[188:191]
    ds_read_b64_tr_b16 a[100:101], v115 offset:16384
    ds_read_b64_tr_b16 a[102:103], v115 offset:16896
    v_mfma_f32_16x16x32_bf16 v[188:191], a[112:115], a[252:255], v[188:191]
    v_mfma_f32_16x16x32_bf16 v[176:179], a[112:115], a[240:243], v[176:179]
    v_mfma_f32_16x16x32_bf16 v[176:179], a[108:111], a[224:227], v[176:179]
    buffer_load_dwordx4 v101, s[8:11], s71 offen offset:1024 lds
    v_mfma_f32_16x16x32_bf16 v[180:183], a[108:111], a[228:231], v[180:183]
    v_mfma_f32_16x16x32_bf16 v[180:183], a[112:115], a[244:247], v[180:183]
    v_mfma_f32_16x16x32_bf16 v[184:187], a[112:115], a[248:251], v[184:187]
    s_waitcnt lgkmcnt(4)
    ds_read_b64_tr_b16 a[112:113], v115 offset:18440
    ds_read_b64_tr_b16 a[114:115], v115 offset:18952
    v_mfma_f32_16x16x32_bf16 v[184:187], a[108:111], a[232:235], v[184:187]
    buffer_load_dwordx4 v102, s[8:11], s71 offen offset:2048 lds
    v_mfma_f32_16x16x32_bf16 v[192:195], a[84:87], a[224:227], v[192:195]
    ds_read_b64_tr_b16 a[108:109], v115 offset:16392
    ds_read_b64_tr_b16 a[110:111], v115 offset:16904
    v_mfma_f32_16x16x32_bf16 v[192:195], a[88:91], a[240:243], v[192:195]
    v_mfma_f32_16x16x32_bf16 v[196:199], a[88:91], a[244:247], v[196:199]
    v_mfma_f32_16x16x32_bf16 v[196:199], a[84:87], a[228:231], v[196:199]
    buffer_load_dwordx4 v103, s[8:11], s71 offen offset:3072 lds
    v_mfma_f32_16x16x32_bf16 v[200:203], a[84:87], a[232:235], v[200:203]
    s_add_u32 m0, s45, 90112
    s_lshr_b32 s47, s2, 7
    s_lshl_b32 s47, s47, 1
    v_mfma_f32_16x16x32_bf16 v[200:203], a[88:91], a[248:251], v[200:203]
    s_xor_b32 s48, s60, 1
    s_lshr_b32 s46, s2, 7
    s_xor_b32 s46, s46, 1
    v_mfma_f32_16x16x32_bf16 v[208:211], a[92:95], a[224:227], v[208:211]
    s_and_b32 s46, s46, 3
    s_lshl_b32 s72, s46, 17
    s_mul_i32 s4, s48, 458752
    v_mfma_f32_16x16x32_bf16 v[208:211], a[96:99], a[240:243], v[208:211]
    s_mul_i32 s46, s46, 14336
    buffer_load_dwordx4 v104, s[8:11], s71 offen offset:0 lds
    v_mfma_f32_16x16x32_bf16 v[212:215], a[96:99], a[244:247], v[212:215]
    s_add_u32 s64, s46, s4
    s_add_u32 s68, s46, s5
    s_lshr_b32 s46, s2, 7
    v_mfma_f32_16x16x32_bf16 v[212:215], a[92:95], a[228:231], v[212:215]
    s_xor_b32 s46, s46, 3
    s_waitcnt vmcnt(9) lgkmcnt(0)
    s_barrier
    v_mfma_f32_16x16x32_bf16 v[216:219], a[92:95], a[232:235], v[216:219]
    s_and_b32 s46, s46, 3
    ds_read_b128 a[128:131], v109 offset:28672
    ds_read_b64_tr_b16 a[84:85], v112 offset:32768
    v_mfma_f32_16x16x32_bf16 v[216:219], a[96:99], a[248:251], v[216:219]
    s_lshl_b32 s73, s46, 17
    buffer_load_dwordx4 v105, s[8:11], s71 offen offset:1024 lds
    v_mfma_f32_16x16x32_bf16 v[224:227], a[100:103], a[224:227], v[224:227]
    s_mul_i32 s46, s46, 14336
    ds_read_b64_tr_b16 a[86:87], v112 offset:33280
    ds_read_b128 a[144:147], v110 offset:28672
    v_mfma_f32_16x16x32_bf16 v[224:227], a[104:107], a[240:243], v[224:227]
    s_add_u32 s65, s46, s4
    ds_read_b64_tr_b16 a[88:89], v112 offset:34816
    ds_read_b64_tr_b16 a[90:91], v112 offset:35328
    v_mfma_f32_16x16x32_bf16 v[228:231], a[104:107], a[244:247], v[228:231]
    s_add_u32 s69, s46, s5
    ds_read_b128 a[132:135], v108 offset:28672
    ds_read_b128 a[116:119], v107 offset:28672
    v_mfma_f32_16x16x32_bf16 v[228:231], a[100:103], a[228:231], v[228:231]
    s_lshr_b32 s46, s2, 7
    buffer_load_dwordx4 v106, s[8:11], s71 offen offset:2048 lds
    v_mfma_f32_16x16x32_bf16 v[232:235], a[100:103], a[232:235], v[232:235]
    s_xor_b32 s46, s46, 0
    ds_read_b128 a[120:123], v107 offset:30720
    ds_read_b128 a[136:139], v108 offset:30720
    v_mfma_f32_16x16x32_bf16 v[232:235], a[104:107], a[248:251], v[232:235]
    s_and_b32 s46, s46, 3
    ds_read_b128 a[140:143], v108 offset:32768
    ds_read_b128 a[124:127], v107 offset:32768
    v_mfma_f32_16x16x32_bf16 v[240:243], a[108:111], a[224:227], v[240:243]
    s_lshl_b32 s74, s46, 17
    ds_read_b64_tr_b16 a[92:93], v112 offset:32776
    ds_read_b64_tr_b16 a[94:95], v112 offset:33288
    v_mfma_f32_16x16x32_bf16 v[240:243], a[112:115], a[240:243], v[240:243]
    s_mul_i32 s46, s46, 14336
    ds_read_b64_tr_b16 a[96:97], v112 offset:34824
    ds_read_b64_tr_b16 a[98:99], v112 offset:35336
    v_mfma_f32_16x16x32_bf16 v[244:247], a[112:115], a[244:247], v[244:247]
    s_add_u32 s66, s46, s4
    ds_read_b64_tr_b16 a[100:101], v113 offset:32768
    ds_read_b64_tr_b16 a[102:103], v113 offset:33280
    v_mfma_f32_16x16x32_bf16 v[244:247], a[108:111], a[228:231], v[244:247]
    s_add_u32 s70, s46, s5
    ds_read_b64_tr_b16 a[104:105], v113 offset:34816
    ds_read_b64_tr_b16 a[106:107], v113 offset:35328
    v_mfma_f32_16x16x32_bf16 v[248:251], a[108:111], a[232:235], v[248:251]
    s_waitcnt lgkmcnt(14)
    ds_read_b64_tr_b16 a[108:109], v113 offset:32776
    ds_read_b64_tr_b16 a[110:111], v113 offset:33288
    v_mfma_f32_16x16x32_bf16 v[248:251], a[112:115], a[248:251], v[248:251]
    s_lshr_b32 s46, s2, 7
    ds_read_b64_tr_b16 a[112:113], v113 offset:34824
    ds_read_b64_tr_b16 a[114:115], v113 offset:35336
    v_mfma_f32_16x16x32_bf16 v[140:143], a[84:87], a[128:131], v[140:143]
    s_waitcnt lgkmcnt(15)
    s_xor_b32 s46, s46, 2
    s_and_b32 s46, s46, 3
    v_mfma_f32_16x16x32_bf16 v[140:143], a[88:91], a[144:147], v[140:143]
    s_lshl_b32 s75, s46, 17
    s_mul_i32 s46, s46, 14336
    s_add_u32 s67, s46, s4
    v_mfma_f32_16x16x32_bf16 v[128:131], a[88:91], a[132:135], v[128:131]
    s_add_u32 s71, s46, s5
    s_add_u32 m0, s44, 16384
    v_mfma_f32_16x16x32_bf16 v[128:131], a[84:87], a[116:119], v[128:131]
    s_waitcnt lgkmcnt(10)
    v_mfma_f32_16x16x32_bf16 v[132:135], a[84:87], a[120:123], v[132:135]
    buffer_load_dwordx4 v14, s[12:15], s85 offen offset:0 nt lds
    v_mfma_f32_16x16x32_bf16 v[132:135], a[88:91], a[136:139], v[132:135]
    v_mfma_f32_16x16x32_bf16 v[136:139], a[88:91], a[140:143], v[136:139]
    ds_read_b64_tr_b16 a[88:89], v114 offset:34816
    ds_read_b64_tr_b16 a[90:91], v114 offset:35328
    v_mfma_f32_16x16x32_bf16 v[136:139], a[84:87], a[124:127], v[136:139]
    s_waitcnt lgkmcnt(4)
    ds_read_b64_tr_b16 a[84:85], v114 offset:32768
    ds_read_b64_tr_b16 a[86:87], v114 offset:33280
    v_mfma_f32_16x16x32_bf16 v[156:159], a[92:95], a[128:131], v[156:159]
    v_mfma_f32_16x16x32_bf16 v[156:159], a[96:99], a[144:147], v[156:159]
    v_mfma_f32_16x16x32_bf16 v[144:147], a[96:99], a[132:135], v[144:147]
    v_mfma_f32_16x16x32_bf16 v[144:147], a[92:95], a[116:119], v[144:147]
    v_mfma_f32_16x16x32_bf16 v[148:151], a[92:95], a[120:123], v[148:151]
    v_mfma_f32_16x16x32_bf16 v[148:151], a[96:99], a[136:139], v[148:151]
    v_mfma_f32_16x16x32_bf16 v[152:155], a[96:99], a[140:143], v[152:155]
    ds_read_b64_tr_b16 a[96:97], v114 offset:34824
    ds_read_b64_tr_b16 a[98:99], v114 offset:35336
    v_mfma_f32_16x16x32_bf16 v[152:155], a[92:95], a[124:127], v[152:155]
    ds_read_b64_tr_b16 a[92:93], v114 offset:32776
    ds_read_b64_tr_b16 a[94:95], v114 offset:33288
    v_mfma_f32_16x16x32_bf16 v[172:175], a[100:103], a[128:131], v[172:175]
    v_mfma_f32_16x16x32_bf16 v[172:175], a[104:107], a[144:147], v[172:175]
    buffer_load_dwordx4 v15, s[12:15], s85 offen offset:1024 nt lds
    v_mfma_f32_16x16x32_bf16 v[160:163], a[104:107], a[132:135], v[160:163]
    v_mfma_f32_16x16x32_bf16 v[160:163], a[100:103], a[116:119], v[160:163]
    v_mfma_f32_16x16x32_bf16 v[164:167], a[100:103], a[120:123], v[164:167]
    v_mfma_f32_16x16x32_bf16 v[164:167], a[104:107], a[136:139], v[164:167]
    v_mfma_f32_16x16x32_bf16 v[168:171], a[104:107], a[140:143], v[168:171]
    ds_read_b64_tr_b16 a[104:105], v115 offset:34816
    ds_read_b64_tr_b16 a[106:107], v115 offset:35328
    v_mfma_f32_16x16x32_bf16 v[168:171], a[100:103], a[124:127], v[168:171]
    s_waitcnt lgkmcnt(4)
    ds_read_b64_tr_b16 a[100:101], v115 offset:32768
    ds_read_b64_tr_b16 a[102:103], v115 offset:33280
    v_mfma_f32_16x16x32_bf16 v[188:191], a[108:111], a[128:131], v[188:191]
    v_mfma_f32_16x16x32_bf16 v[188:191], a[112:115], a[144:147], v[188:191]
    v_mfma_f32_16x16x32_bf16 v[176:179], a[112:115], a[132:135], v[176:179]
    v_mfma_f32_16x16x32_bf16 v[176:179], a[108:111], a[116:119], v[176:179]
    v_mfma_f32_16x16x32_bf16 v[180:183], a[108:111], a[120:123], v[180:183]
    v_mfma_f32_16x16x32_bf16 v[180:183], a[112:115], a[136:139], v[180:183]
    v_mfma_f32_16x16x32_bf16 v[184:187], a[112:115], a[140:143], v[184:187]
    buffer_load_dwordx4 v16, s[12:15], s85 offen offset:2048 nt lds
    v_mfma_f32_16x16x32_bf16 v[184:187], a[108:111], a[124:127], v[184:187]
    ds_read_b64_tr_b16 a[108:109], v115 offset:32776
    ds_read_b64_tr_b16 a[110:111], v115 offset:33288
    v_mfma_f32_16x16x32_bf16 v[192:195], a[84:87], a[116:119], v[192:195]
    ds_read_b64_tr_b16 a[112:113], v115 offset:34824
    ds_read_b64_tr_b16 a[114:115], v115 offset:35336
    v_mfma_f32_16x16x32_bf16 v[192:195], a[88:91], a[132:135], v[192:195]
    v_mfma_f32_16x16x32_bf16 v[196:199], a[88:91], a[136:139], v[196:199]
    v_mfma_f32_16x16x32_bf16 v[196:199], a[84:87], a[120:123], v[196:199]
    v_mfma_f32_16x16x32_bf16 v[200:203], a[84:87], a[124:127], v[200:203]
    s_waitcnt lgkmcnt(4)
    v_mfma_f32_16x16x32_bf16 v[200:203], a[88:91], a[140:143], v[200:203]
    v_mfma_f32_16x16x32_bf16 v[208:211], a[92:95], a[116:119], v[208:211]
    v_mfma_f32_16x16x32_bf16 v[208:211], a[96:99], a[132:135], v[208:211]
    v_mfma_f32_16x16x32_bf16 v[212:215], a[96:99], a[136:139], v[212:215]
    v_mfma_f32_16x16x32_bf16 v[212:215], a[92:95], a[120:123], v[212:215]
    buffer_load_dwordx4 v17, s[12:15], s85 offen offset:3072 nt lds
    s_waitcnt vmcnt(4) lgkmcnt(0)
    s_barrier
    s_branch L_common
L_var1:
    s_waitcnt vmcnt(11) lgkmcnt(0)
    s_barrier
    ds_read_b128 a[128:131], v109 offset:28672
    ds_read_b64_tr_b16 a[84:85], v112 offset:32768
    ds_read_b64_tr_b16 a[86:87], v112 offset:33280
    ds_read_b128 a[144:147], v110 offset:28672
    ds_read_b64_tr_b16 a[88:89], v112 offset:34816
    ds_read_b64_tr_b16 a[90:91], v112 offset:35328
    ds_read_b128 a[132:135], v108 offset:28672
    ds_read_b128 a[116:119], v107 offset:28672
    ds_read_b128 a[120:123], v107 offset:30720
    ds_read_b128 a[136:139], v108 offset:30720
    ds_read_b128 a[140:143], v108 offset:32768
    ds_read_b128 a[124:127], v107 offset:32768
    ds_read_b64_tr_b16 a[92:93], v112 offset:32776
    ds_read_b64_tr_b16 a[94:95], v112 offset:33288
    ds_read_b64_tr_b16 a[96:97], v112 offset:34824
    ds_read_b64_tr_b16 a[98:99], v112 offset:35336
    ds_read_b64_tr_b16 a[100:101], v113 offset:32768
    ds_read_b64_tr_b16 a[102:103], v113 offset:33280
    ds_read_b64_tr_b16 a[104:105], v113 offset:34816
    ds_read_b64_tr_b16 a[106:107], v113 offset:35328
    ds_read_b64_tr_b16 a[108:109], v113 offset:32776
    ds_read_b64_tr_b16 a[110:111], v113 offset:33288
    ds_read_b64_tr_b16 a[112:113], v113 offset:34824
    ds_read_b64_tr_b16 a[114:115], v113 offset:35336
    s_add_u32 m0, s44, 114688
    s_mul_i32 s5, s60, 458752
    buffer_load_dwordx4 v96, s[20:23], s74 offen offset:0 lds
    s_waitcnt lgkmcnt(15)
    v_mfma_f32_16x16x32_bf16 v[140:143], a[84:87], a[128:131], 0
    v_mfma_f32_16x16x32_bf16 v[140:143], a[88:91], a[144:147], v[140:143]
    v_mfma_f32_16x16x32_bf16 v[128:131], a[88:91], a[132:135], 0
    buffer_load_dwordx4 v97, s[20:23], s74 offen offset:1024 lds
    v_mfma_f32_16x16x32_bf16 v[128:131], a[84:87], a[116:119], v[128:131]
    s_waitcnt lgkmcnt(8)
    v_mfma_f32_16x16x32_bf16 v[132:135], a[84:87], a[120:123], 0
    v_mfma_f32_16x16x32_bf16 v[132:135], a[88:91], a[136:139], v[132:135]
    v_mfma_f32_16x16x32_bf16 v[136:139], a[88:91], a[140:143], 0
    ds_read_b64_tr_b16 a[88:89], v114 offset:34816
    ds_read_b64_tr_b16 a[90:91], v114 offset:35328
    v_mfma_f32_16x16x32_bf16 v[136:139], a[84:87], a[124:127], v[136:139]
    ds_read_b64_tr_b16 a[84:85], v114 offset:32768
    ds_read_b64_tr_b16 a[86:87], v114 offset:33280
    v_mfma_f32_16x16x32_bf16 v[156:159], a[92:95], a[128:131], 0
    buffer_load_dwordx4 v98, s[20:23], s74 offen offset:2048 lds
    v_mfma_f32_16x16x32_bf16 v[156:159], a[96:99], a[144:147], v[156:159]
    v_mfma_f32_16x16x32_bf16 v[144:147], a[96:99], a[132:135], 0
    v_mfma_f32_16x16x32_bf16 v[144:147], a[92:95], a[116:119], v[144:147]
    v_mfma_f32_16x16x32_bf16 v[148:151], a[92:95], a[120:123], 0
    buffer_load_dwordx4 v99, s[20:23], s74 offen offset:3072 lds
    v_mfma_f32_16x16x32_bf16 v[148:151], a[96:99], a[136:139], v[148:151]
    s_add_u32 m0, s45, 28672
    v_mfma_f32_16x16x32_bf16 v[152:155], a[96:99], a[140:143], 0
    s_waitcnt lgkmcnt(4)
    ds_read_b64_tr_b16 a[96:97], v114 offset:34824
    ds_read_b64_tr_b16 a[98:99], v114 offset:35336
    v_mfma_f32_16x16x32_bf16 v[152:155], a[92:95], a[124:127], v[152:155]
    ds_read_b64_tr_b16 a[92:93], v114 offset:32776
    ds_read_b64_tr_b16 a[94:95], v114 offset:33288
    v_mfma_f32_16x16x32_bf16 v[172:175], a[100:103], a[128:131], 0
    buffer_load_dwordx4 v100, s[8:11], s66 offen offset:0 lds
    v_mfma_f32_16x16x32_bf16 v[172:175], a[104:107], a[144:147], v[172:175]
    v_mfma_f32_16x16x32_bf16 v[160:163], a[104:107], a[132:135], 0
    v_mfma_f32_16x16x32_bf16 v[160:163], a[100:103], a[116:119], v[160:163]
    v_mfma_f32_16x16x32_bf16 v[164:167], a[100:103], a[120:123], 0
    buffer_load_dwordx4 v101, s[8:11], s66 offen offset:1024 lds
    v_mfma_f32_16x16x32_bf16 v[164:167], a[104:107], a[136:139], v[164:167]
    v_mfma_f32_16x16x32_bf16 v[168:171], a[104:107], a[140:143], 0
    ds_read_b64_tr_b16 a[104:105], v115 offset:34816
    ds_read_b64_tr_b16 a[106:107], v115 offset:35328
    v_mfma_f32_16x16x32_bf16 v[168:171], a[100:103], a[124:127], v[168:171]
    ds_read_b64_tr_b16 a[100:101], v115 offset:32768
    ds_read_b64_tr_b16 a[102:103], v115 offset:33280
    v_mfma_f32_16x16x32_bf16 v[188:191], a[108:111], a[128:131], 0
    buffer_load_dwordx4 v102, s[8:11], s66 offen offset:2048 lds
    v_mfma_f32_16x16x32_bf16 v[188:191], a[112:115], a[144:147], v[188:191]
    v_mfma_f32_16x16x32_bf16 v[176:179], a[112:115], a[132:135], 0
    v_mfma_f32_16x16x32_bf16 v[176:179], a[108:111], a[116:119], v[176:179]
    v_mfma_f32_16x16x32_bf16 v[180:183], a[108:111], a[120:123], 0
    buffer_load_dwordx4 v103, s[8:11], s66 offen offset:3072 lds
    v_mfma_f32_16x16x32_bf16 v[180:183], a[112:115], a[136:139], v[180:183]
    s_add_u32 m0, s45, 32768
    v_mfma_f32_16x16x32_bf16 v[184:187], a[112:115], a[140:143], 0
    s_waitcnt lgkmcnt(4)
    ds_read_b64_tr_b16 a[112:113], v115 offset:34824
    ds_read_b64_tr_b16 a[114:115], v115 offset:35336
    v_mfma_f32_16x16x32_bf16 v[184:187], a[108:111], a[124:127], v[184:187]
    ds_read_b64_tr_b16 a[108:109], v115 offset:32776
    ds_read_b64_tr_b16 a[110:111], v115 offset:33288
    v_mfma_f32_16x16x32_bf16 v[192:195], a[84:87], a[116:119], 0
    buffer_load_dwordx4 v104, s[8:11], s66 offen offset:0 lds
    v_mfma_f32_16x16x32_bf16 v[192:195], a[88:91], a[132:135], v[192:195]
    v_mfma_f32_16x16x32_bf16 v[196:199], a[88:91], a[136:139], 0
    v_mfma_f32_16x16x32_bf16 v[196:199], a[84:87], a[120:123], v[196:199]
    v_mfma_f32_16x16x32_bf16 v[200:203], a[84:87], a[124:127], 0
    buffer_load_dwordx4 v105, s[8:11], s66 offen offset:1024 lds
    v_mfma_f32_16x16x32_bf16 v[200:203], a[88:91], a[140:143], v[200:203]
    v_mfma_f32_16x16x32_bf16 v[208:211], a[92:95], a[116:119], 0
    v_mfma_f32_16x16x32_bf16 v[208:211], a[96:99], a[132:135], v[208:211]
    v_mfma_f32_16x16x32_bf16 v[212:215], a[96:99], a[136:139], 0
    buffer_load_dwordx4 v106, s[8:11], s66 offen offset:2048 lds
    v_mfma_f32_16x16x32_bf16 v[212:215], a[92:95], a[120:123], v[212:215]
    s_waitcnt vmcnt(11) lgkmcnt(0)
    s_barrier
    ds_read_b128 a[236:239], v109 offset:57344
    v_mfma_f32_16x16x32_bf16 v[216:219], a[92:95], a[124:127], 0
    s_add_u32 m0, s44, 131072
    ds_read_b64_tr_b16 a[84:85], v112 offset:49152
    ds_read_b64_tr_b16 a[86:87], v112 offset:49664
    v_mfma_f32_16x16x32_bf16 v[216:219], a[96:99], a[140:143], v[216:219]
    ds_read_b128 a[252:255], v110 offset:57344
    ds_read_b64_tr_b16 a[88:89], v112 offset:51200
    v_mfma_f32_16x16x32_bf16 v[224:227], a[100:103], a[116:119], 0
    ds_read_b64_tr_b16 a[90:91], v112 offset:51712
    ds_read_b128 a[240:243], v108 offset:57344
    v_mfma_f32_16x16x32_bf16 v[224:227], a[104:107], a[132:135], v[224:227]
    ds_read_b128 a[224:227], v107 offset:57344
    ds_read_b128 a[228:231], v107 offset:59392
    v_mfma_f32_16x16x32_bf16 v[228:231], a[104:107], a[136:139], 0
    ds_read_b128 a[244:247], v108 offset:59392
    ds_read_b128 a[248:251], v108 offset:61440
    v_mfma_f32_16x16x32_bf16 v[228:231], a[100:103], a[120:123], v[228:231]
    ds_read_b128 a[232:235], v107 offset:61440
    ds_read_b64_tr_b16 a[92:93], v112 offset:49160
    v_mfma_f32_16x16x32_bf16 v[232:235], a[100:103], a[124:127], 0
    ds_read_b64_tr_b16 a[94:95], v112 offset:49672
    ds_read_b64_tr_b16 a[96:97], v112 offset:51208
    v_mfma_f32_16x16x32_bf16 v[232:235], a[104:107], a[140:143], v[232:235]
    ds_read_b64_tr_b16 a[98:99], v112 offset:51720
    ds_read_b64_tr_b16 a[100:101], v113 offset:49152
    v_mfma_f32_16x16x32_bf16 v[240:243], a[108:111], a[116:119], 0
    ds_read_b64_tr_b16 a[102:103], v113 offset:49664
    ds_read_b64_tr_b16 a[104:105], v113 offset:51200
    v_mfma_f32_16x16x32_bf16 v[240:243], a[112:115], a[132:135], v[240:243]
    ds_read_b64_tr_b16 a[106:107], v113 offset:51712
    v_mfma_f32_16x16x32_bf16 v[244:247], a[112:115], a[136:139], 0
    buffer_load_dwordx4 v96, s[20:23], s75 offen offset:0 lds
    v_mfma_f32_16x16x32_bf16 v[244:247], a[108:111], a[120:123], v[244:247]
    v_mfma_f32_16x16x32_bf16 v[248:251], a[108:111], a[124:127], 0
    s_waitcnt lgkmcnt(11)
    ds_read_b64_tr_b16 a[108:109], v113 offset:49160
    ds_read_b64_tr_b16 a[110:111], v113 offset:49672
    v_mfma_f32_16x16x32_bf16 v[248:251], a[112:115], a[140:143], v[248:251]
    ds_read_b64_tr_b16 a[112:113], v113 offset:51208
    ds_read_b64_tr_b16 a[114:115], v113 offset:51720
    v_mfma_f32_16x16x32_bf16 v[140:143], a[84:87], a[236:239], v[140:143]
    buffer_load_dwordx4 v97, s[20:23], s75 offen offset:1024 lds
    v_mfma_f32_16x16x32_bf16 v[140:143], a[88:91], a[252:255], v[140:143]
    v_mfma_f32_16x16x32_bf16 v[128:131], a[88:91], a[240:243], v[128:131]
    v_mfma_f32_16x16x32_bf16 v[128:131], a[84:87], a[224:227], v[128:131]
    s_waitcnt lgkmcnt(5)
    v_mfma_f32_16x16x32_bf16 v[132:135], a[84:87], a[228:231], v[132:135]
    buffer_load_dwordx4 v98, s[20:23], s75 offen offset:2048 lds
    v_mfma_f32_16x16x32_bf16 v[132:135], a[88:91], a[244:247], v[132:135]
    v_mfma_f32_16x16x32_bf16 v[136:139], a[88:91], a[248:251], v[136:139]
    ds_read_b64_tr_b16 a[88:89], v114 offset:51200
    ds_read_b64_tr_b16 a[90:91], v114 offset:51712
    v_mfma_f32_16x16x32_bf16 v[136:139], a[84:87], a[232:235], v[136:139]
    ds_read_b64_tr_b16 a[84:85], v114 offset:49152
    ds_read_b64_tr_b16 a[86:87], v114 offset:49664
    v_mfma_f32_16x16x32_bf16 v[156:159], a[92:95], a[236:239], v[156:159]
    buffer_load_dwordx4 v99, s[20:23], s75 offen offset:3072 lds
    v_mfma_f32_16x16x32_bf16 v[156:159], a[96:99], a[252:255], v[156:159]
    s_add_u32 m0, s45, 57344
    v_mfma_f32_16x16x32_bf16 v[144:147], a[96:99], a[240:243], v[144:147]
    v_mfma_f32_16x16x32_bf16 v[144:147], a[92:95], a[224:227], v[144:147]
    v_mfma_f32_16x16x32_bf16 v[148:151], a[92:95], a[228:231], v[148:151]
    buffer_load_dwordx4 v100, s[8:11], s67 offen offset:0 lds
    v_mfma_f32_16x16x32_bf16 v[148:151], a[96:99], a[244:247], v[148:151]
    v_mfma_f32_16x16x32_bf16 v[152:155], a[96:99], a[248:251], v[152:155]
    ds_read_b64_tr_b16 a[96:97], v114 offset:51208
    ds_read_b64_tr_b16 a[98:99], v114 offset:51720
    v_mfma_f32_16x16x32_bf16 v[152:155], a[92:95], a[232:235], v[152:155]
    s_waitcnt lgkmcnt(4)
    ds_read_b64_tr_b16 a[92:93], v114 offset:49160
    ds_read_b64_tr_b16 a[94:95], v114 offset:49672
    v_mfma_f32_16x16x32_bf16 v[172:175], a[100:103], a[236:239], v[172:175]
    buffer_load_dwordx4 v101, s[8:11], s67 offen offset:1024 lds
    v_mfma_f32_16x16x32_bf16 v[172:175], a[104:107], a[252:255], v[172:175]
    v_mfma_f32_16x16x32_bf16 v[160:163], a[104:107], a[240:243], v[160:163]
    v_mfma_f32_16x16x32_bf16 v[160:163], a[100:103], a[224:227], v[160:163]
    v_mfma_f32_16x16x32_bf16 v[164:167], a[100:103], a[228:231], v[164:167]
    buffer_load_dwordx4 v102, s[8:11], s67 offen offset:2048 lds
    v_mfma_f32_16x16x32_bf16 v[164:167], a[104:107], a[244:247], v[164:167]
    v_mfma_f32_16x16x32_bf16 v[168:171], a[104:107], a[248:251], v[168:171]
    ds_read_b64_tr_b16 a[104:105], v115 offset:51200
    ds_read_b64_tr_b16 a[106:107], v115 offset:51712
    v_mfma_f32_16x16x32_bf16 v[168:171], a[100:103], a[232:235], v[168:171]
    ds_read_b64_tr_b16 a[100:101], v115 offset:49152
    ds_read_b64_tr_b16 a[102:103], v115 offset:49664
    v_mfma_f32_16x16x32_bf16 v[188:191], a[108:111], a[236:239], v[188:191]
    buffer_load_dwordx4 v103, s[8:11], s67 offen offset:3072 lds
    v_mfma_f32_16x16x32_bf16 v[188:191], a[112:115], a[252:255], v[188:191]
    s_add_u32 m0, s45, 61440
    v_mfma_f32_16x16x32_bf16 v[176:179], a[112:115], a[240:243], v[176:179]
    v_mfma_f32_16x16x32_bf16 v[176:179], a[108:111], a[224:227], v[176:179]
    v_mfma_f32_16x16x32_bf16 v[180:183], a[108:111], a[228:231], v[180:183]
    buffer_load_dwordx4 v104, s[8:11], s67 offen offset:0 lds
    v_mfma_f32_16x16x32_bf16 v[180:183], a[112:115], a[244:247], v[180:183]
    v_mfma_f32_16x16x32_bf16 v[184:187], a[112:115], a[248:251], v[184:187]
    s_waitcnt lgkmcnt(4)
    ds_read_b64_tr_b16 a[112:113], v115 offset:51208
    ds_read_b64_tr_b16 a[114:115], v115 offset:51720
    v_mfma_f32_16x16x32_bf16 v[184:187], a[108:111], a[232:235], v[184:187]
    ds_read_b64_tr_b16 a[108:109], v115 offset:49160
    ds_read_b64_tr_b16 a[110:111], v115 offset:49672
    v_mfma_f32_16x16x32_bf16 v[192:195], a[84:87], a[224:227], v[192:195]
    buffer_load_dwordx4 v105, s[8:11], s67 offen offset:1024 lds
    v_mfma_f32_16x16x32_bf16 v[192:195], a[88:91], a[240:243], v[192:195]
    v_mfma_f32_16x16x32_bf16 v[196:199], a[88:91], a[244:247], v[196:199]
    v_mfma_f32_16x16x32_bf16 v[196:199], a[84:87], a[228:231], v[196:199]
    v_mfma_f32_16x16x32_bf16 v[200:203], a[84:87], a[232:235], v[200:203]
    buffer_load_dwordx4 v106, s[8:11], s67 offen offset:2048 lds
    v_mfma_f32_16x16x32_bf16 v[200:203], a[88:91], a[248:251], v[200:203]
    v_mfma_f32_16x16x32_bf16 v[208:211], a[92:95], a[224:227], v[208:211]
    v_mfma_f32_16x16x32_bf16 v[208:211], a[96:99], a[240:243], v[208:211]
    v_mfma_f32_16x16x32_bf16 v[212:215], a[96:99], a[244:247], v[212:215]
    v_mfma_f32_16x16x32_bf16 v[212:215], a[92:95], a[228:231], v[212:215]
    s_waitcnt vmcnt(11) lgkmcnt(0)
    s_barrier
    ds_read_b128 a[128:131], v109 offset:0
    v_mfma_f32_16x16x32_bf16 v[216:219], a[92:95], a[232:235], v[216:219]
    s_add_u32 m0, s44, 147456
    ds_read_b64_tr_b16 a[84:85], v112 offset:16384
    ds_read_b64_tr_b16 a[86:87], v112 offset:16896
    v_mfma_f32_16x16x32_bf16 v[216:219], a[96:99], a[248:251], v[216:219]
    ds_read_b128 a[144:147], v110 offset:0
    ds_read_b64_tr_b16 a[88:89], v112 offset:18432
    v_mfma_f32_16x16x32_bf16 v[224:227], a[100:103], a[224:227], v[224:227]
    ds_read_b64_tr_b16 a[90:91], v112 offset:18944
    ds_read_b128 a[132:135], v108 offset:0
    v_mfma_f32_16x16x32_bf16 v[224:227], a[104:107], a[240:243], v[224:227]
    ds_read_b128 a[116:119], v107 offset:0
    ds_read_b128 a[120:123], v107 offset:2048
    v_mfma_f32_16x16x32_bf16 v[228:231], a[104:107], a[244:247], v[228:231]
    ds_read_b128 a[136:139], v108 offset:2048
    ds_read_b128 a[140:143], v108 offset:4096
    v_mfma_f32_16x16x32_bf16 v[228:231], a[100:103], a[228:231], v[228:231]
    ds_read_b128 a[124:127], v107 offset:4096
    ds_read_b64_tr_b16 a[92:93], v112 offset:16392
    v_mfma_f32_16x16x32_bf16 v[232:235], a[100:103], a[232:235], v[232:235]
    ds_read_b64_tr_b16 a[94:95], v112 offset:16904
    ds_read_b64_tr_b16 a[96:97], v112 offset:18440
    v_mfma_f32_16x16x32_bf16 v[232:235], a[104:107], a[248:251], v[232:235]
    ds_read_b64_tr_b16 a[98:99], v112 offset:18952
    ds_read_b64_tr_b16 a[100:101], v113 offset:16384
    v_mfma_f32_16x16x32_bf16 v[240:243], a[108:111], a[224:227], v[240:243]
    ds_read_b64_tr_b16 a[102:103], v113 offset:16896
    ds_read_b64_tr_b16 a[104:105], v113 offset:18432
    v_mfma_f32_16x16x32_bf16 v[240:243], a[112:115], a[240:243], v[240:243]
    ds_read_b64_tr_b16 a[106:107], v113 offset:18944
    v_mfma_f32_16x16x32_bf16 v[244:247], a[112:115], a[244:247], v[244:247]
    buffer_load_dwordx4 v96, s[20:23], s76 offen offset:0 lds
    v_mfma_f32_16x16x32_bf16 v[244:247], a[108:111], a[228:231], v[244:247]
    v_mfma_f32_16x16x32_bf16 v[248:251], a[108:111], a[232:235], v[248:251]
    s_waitcnt lgkmcnt(11)
    ds_read_b64_tr_b16 a[108:109], v113 offset:16392
    ds_read_b64_tr_b16 a[110:111], v113 offset:16904
    v_mfma_f32_16x16x32_bf16 v[248:251], a[112:115], a[248:251], v[248:251]
    ds_read_b64_tr_b16 a[112:113], v113 offset:18440
    ds_read_b64_tr_b16 a[114:115], v113 offset:18952
    v_mfma_f32_16x16x32_bf16 v[140:143], a[84:87], a[128:131], v[140:143]
    buffer_load_dwordx4 v97, s[20:23], s76 offen offset:1024 lds
    v_mfma_f32_16x16x32_bf16 v[140:143], a[88:91], a[144:147], v[140:143]
    v_mfma_f32_16x16x32_bf16 v[128:131], a[88:91], a[132:135], v[128:131]
    v_mfma_f32_16x16x32_bf16 v[128:131], a[84:87], a[116:119], v[128:131]
    s_waitcnt lgkmcnt(5)
    v_mfma_f32_16x16x32_bf16 v[132:135], a[84:87], a[120:123], v[132:135]
    buffer_load_dwordx4 v98, s[20:23], s76 offen offset:2048 lds
    v_mfma_f32_16x16x32_bf16 v[132:135], a[88:91], a[136:139], v[132:135]
    v_mfma_f32_16x16x32_bf16 v[136:139], a[88:91], a[140:143], v[136:139]
    ds_read_b64_tr_b16 a[88:89], v114 offset:18432
    ds_read_b64_tr_b16 a[90:91], v114 offset:18944
    v_mfma_f32_16x16x32_bf16 v[136:139], a[84:87], a[124:127], v[136:139]
    ds_read_b64_tr_b16 a[84:85], v114 offset:16384
    ds_read_b64_tr_b16 a[86:87], v114 offset:16896
    v_mfma_f32_16x16x32_bf16 v[156:159], a[92:95], a[128:131], v[156:159]
    buffer_load_dwordx4 v99, s[20:23], s76 offen offset:3072 lds
    v_mfma_f32_16x16x32_bf16 v[156:159], a[96:99], a[144:147], v[156:159]
    s_add_u32 m0, s45, 86016
    v_mfma_f32_16x16x32_bf16 v[144:147], a[96:99], a[132:135], v[144:147]
    v_mfma_f32_16x16x32_bf16 v[144:147], a[92:95], a[116:119], v[144:147]
    v_mfma_f32_16x16x32_bf16 v[148:151], a[92:95], a[120:123], v[148:151]
    buffer_load_dwordx4 v100, s[8:11], s68 offen offset:0 lds
    v_mfma_f32_16x16x32_bf16 v[148:151], a[96:99], a[136:139], v[148:151]
    v_mfma_f32_16x16x32_bf16 v[152:155], a[96:99], a[140:143], v[152:155]
    ds_read_b64_tr_b16 a[96:97], v114 offset:18440
    ds_read_b64_tr_b16 a[98:99], v114 offset:18952
    v_mfma_f32_16x16x32_bf16 v[152:155], a[92:95], a[124:127], v[152:155]
    s_waitcnt lgkmcnt(4)
    ds_read_b64_tr_b16 a[92:93], v114 offset:16392
    ds_read_b64_tr_b16 a[94:95], v114 offset:16904
    v_mfma_f32_16x16x32_bf16 v[172:175], a[100:103], a[128:131], v[172:175]
    buffer_load_dwordx4 v101, s[8:11], s68 offen offset:1024 lds
    v_mfma_f32_16x16x32_bf16 v[172:175], a[104:107], a[144:147], v[172:175]
    v_mfma_f32_16x16x32_bf16 v[160:163], a[104:107], a[132:135], v[160:163]
    v_mfma_f32_16x16x32_bf16 v[160:163], a[100:103], a[116:119], v[160:163]
    v_mfma_f32_16x16x32_bf16 v[164:167], a[100:103], a[120:123], v[164:167]
    buffer_load_dwordx4 v102, s[8:11], s68 offen offset:2048 lds
    v_mfma_f32_16x16x32_bf16 v[164:167], a[104:107], a[136:139], v[164:167]
    v_mfma_f32_16x16x32_bf16 v[168:171], a[104:107], a[140:143], v[168:171]
    ds_read_b64_tr_b16 a[104:105], v115 offset:18432
    ds_read_b64_tr_b16 a[106:107], v115 offset:18944
    v_mfma_f32_16x16x32_bf16 v[168:171], a[100:103], a[124:127], v[168:171]
    ds_read_b64_tr_b16 a[100:101], v115 offset:16384
    ds_read_b64_tr_b16 a[102:103], v115 offset:16896
    v_mfma_f32_16x16x32_bf16 v[188:191], a[108:111], a[128:131], v[188:191]
    buffer_load_dwordx4 v103, s[8:11], s68 offen offset:3072 lds
    v_mfma_f32_16x16x32_bf16 v[188:191], a[112:115], a[144:147], v[188:191]
    s_add_u32 m0, s45, 90112
    v_mfma_f32_16x16x32_bf16 v[176:179], a[112:115], a[132:135], v[176:179]
    v_mfma_f32_16x16x32_bf16 v[176:179], a[108:111], a[116:119], v[176:179]
    v_mfma_f32_16x16x32_bf16 v[180:183], a[108:111], a[120:123], v[180:183]
    buffer_load_dwordx4 v104, s[8:11], s68 offen offset:0 lds
    v_mfma_f32_16x16x32_bf16 v[180:183], a[112:115], a[136:139], v[180:183]
    v_mfma_f32_16x16x32_bf16 v[184:187], a[112:115], a[140:143], v[184:187]
    s_waitcnt lgkmcnt(4)
    ds_read_b64_tr_b16 a[112:113], v115 offset:18440
    ds_read_b64_tr_b16 a[114:115], v115 offset:18952
    v_mfma_f32_16x16x32_bf16 v[184:187], a[108:111], a[124:127], v[184:187]
    ds_read_b64_tr_b16 a[108:109], v115 offset:16392
    ds_read_b64_tr_b16 a[110:111], v115 offset:16904
    v_mfma_f32_16x16x32_bf16 v[192:195], a[84:87], a[116:119], v[192:195]
    buffer_load_dwordx4 v105, s[8:11], s68 offen offset:1024 lds
    v_mfma_f32_16x16x32_bf16 v[192:195], a[88:91], a[132:135], v[192:195]
    v_mfma_f32_16x16x32_bf16 v[196:199], a[88:91], a[136:139], v[196:199]
    v_mfma_f32_16x16x32_bf16 v[196:199], a[84:87], a[120:123], v[196:199]
    v_mfma_f32_16x16x32_bf16 v[200:203], a[84:87], a[124:127], v[200:203]
    buffer_load_dwordx4 v106, s[8:11], s68 offen offset:2048 lds
    v_mfma_f32_16x16x32_bf16 v[200:203], a[88:91], a[140:143], v[200:203]
    v_mfma_f32_16x16x32_bf16 v[208:211], a[92:95], a[116:119], v[208:211]
    v_mfma_f32_16x16x32_bf16 v[208:211], a[96:99], a[132:135], v[208:211]
    v_mfma_f32_16x16x32_bf16 v[212:215], a[96:99], a[136:139], v[212:215]
    v_mfma_f32_16x16x32_bf16 v[212:215], a[92:95], a[120:123], v[212:215]
    s_waitcnt vmcnt(11) lgkmcnt(0)
    s_barrier
    ds_read_b128 a[236:239], v109 offset:28672
    v_mfma_f32_16x16x32_bf16 v[216:219], a[92:95], a[124:127], v[216:219]
    s_add_u32 m0, s44, 114688
    ds_read_b64_tr_b16 a[84:85], v112 offset:32768
    ds_read_b64_tr_b16 a[86:87], v112 offset:33280
    v_mfma_f32_16x16x32_bf16 v[216:219], a[96:99], a[140:143], v[216:219]
    ds_read_b128 a[252:255], v110 offset:28672
    ds_read_b64_tr_b16 a[88:89], v112 offset:34816
    v_mfma_f32_16x16x32_bf16 v[224:227], a[100:103], a[116:119], v[224:227]
    ds_read_b64_tr_b16 a[90:91], v112 offset:35328
    ds_read_b128 a[240:243], v108 offset:28672
    v_mfma_f32_16x16x32_bf16 v[224:227], a[104:107], a[132:135], v[224:227]
    ds_read_b128 a[224:227], v107 offset:28672
    ds_read_b128 a[228:231], v107 offset:30720
    v_mfma_f32_16x16x32_bf16 v[228:231], a[104:107], a[136:139], v[228:231]
    ds_read_b128 a[244:247], v108 offset:30720
    ds_read_b128 a[248:251], v108 offset:32768
    v_mfma_f32_16x16x32_bf16 v[228:231], a[100:103], a[120:123], v[228:231]
    ds_read_b128 a[232:235], v107 offset:32768
    ds_read_b64_tr_b16 a[92:93], v112 offset:32776
    v_mfma_f32_16x16x32_bf16 v[232:235], a[100:103], a[124:127], v[232:235]
    ds_read_b64_tr_b16 a[94:95], v112 offset:33288
    ds_read_b64_tr_b16 a[96:97], v112 offset:34824
    v_mfma_f32_16x16x32_bf16 v[232:235], a[104:107], a[140:143], v[232:235]
    ds_read_b64_tr_b16 a[98:99], v112 offset:35336
    ds_read_b64_tr_b16 a[100:101], v113 offset:32768
    v_mfma_f32_16x16x32_bf16 v[240:243], a[108:111], a[116:119], v[240:243]
    buffer_load_dwordx4 v96, s[20:23], s77 offen offset:0 lds
    v_mfma_f32_16x16x32_bf16 v[240:243], a[112:115], a[132:135], v[240:243]
    ds_read_b64_tr_b16 a[102:103], v113 offset:33280
    ds_read_b64_tr_b16 a[104:105], v113 offset:34816
    v_mfma_f32_16x16x32_bf16 v[244:247], a[112:115], a[136:139], v[244:247]
    ds_read_b64_tr_b16 a[106:107], v113 offset:35328
    v_mfma_f32_16x16x32_bf16 v[244:247], a[108:111], a[120:123], v[244:247]
    v_mfma_f32_16x16x32_bf16 v[248:251], a[108:111], a[124:127], v[248:251]
    s_waitcnt lgkmcnt(11)
    buffer_load_dwordx4 v97, s[20:23], s77 offen offset:1024 lds
    v_mfma_f32_16x16x32_bf16 v[248:251], a[112:115], a[140:143], v[248:251]
    ds_read_b64_tr_b16 a[108:109], v113 offset:32776
    ds_read_b64_tr_b16 a[110:111], v113 offset:33288
    v_mfma_f32_16x16x32_bf16 v[140:143], a[84:87], a[236:239], v[140:143]
    ds_read_b64_tr_b16 a[112:113], v113 offset:34824
    ds_read_b64_tr_b16 a[114:115], v113 offset:35336
    v_mfma_f32_16x16x32_bf16 v[140:143], a[88:91], a[252:255], v[140:143]
    v_mfma_f32_16x16x32_bf16 v[128:131], a[88:91], a[240:243], v[128:131]
    buffer_load_dwordx4 v98, s[20:23], s77 offen offset:2048 lds
    v_mfma_f32_16x16x32_bf16 v[128:131], a[84:87], a[224:227], v[128:131]
    s_waitcnt lgkmcnt(7)
    v_mfma_f32_16x16x32_bf16 v[132:135], a[84:87], a[228:231], v[132:135]
    v_mfma_f32_16x16x32_bf16 v[132:135], a[88:91], a[244:247], v[132:135]
    v_mfma_f32_16x16x32_bf16 v[136:139], a[88:91], a[248:251], v[136:139]
    buffer_load_dwordx4 v99, s[20:23], s77 offen offset:3072 lds
    v_mfma_f32_16x16x32_bf16 v[136:139], a[84:87], a[232:235], v[136:139]
    s_add_u32 m0, s45, 28672
    ds_read_b64_tr_b16 a[84:85], v114 offset:32768
    ds_read_b64_tr_b16 a[86:87], v114 offset:33280
    v_mfma_f32_16x16x32_bf16 v[156:159], a[92:95], a[236:239], v[156:159]
    ds_read_b64_tr_b16 a[88:89], v114 offset:34816
    ds_read_b64_tr_b16 a[90:91], v114 offset:35328
    v_mfma_f32_16x16x32_bf16 v[156:159], a[96:99], a[252:255], v[156:159]
    v_mfma_f32_16x16x32_bf16 v[144:147], a[96:99], a[240:243], v[144:147]
    buffer_load_dwordx4 v100, s[8:11], s69 offen offset:0 lds
    v_mfma_f32_16x16x32_bf16 v[144:147], a[92:95], a[224:227], v[144:147]
    v_mfma_f32_16x16x32_bf16 v[148:151], a[92:95], a[228:231], v[148:151]
    v_mfma_f32_16x16x32_bf16 v[148:151], a[96:99], a[244:247], v[148:151]
    v_mfma_f32_16x16x32_bf16 v[152:155], a[96:99], a[248:251], v[152:155]
    s_waitcnt lgkmcnt(4)
    buffer_load_dwordx4 v101, s[8:11], s69 offen offset:1024 lds
    v_mfma_f32_16x16x32_bf16 v[152:155], a[92:95], a[232:235], v[152:155]
    ds_read_b64_tr_b16 a[92:93], v114 offset:32776
    ds_read_b64_tr_b16 a[94:95], v114 offset:33288
    v_mfma_f32_16x16x32_bf16 v[172:175], a[100:103], a[236:239], v[172:175]
    ds_read_b64_tr_b16 a[96:97], v114 offset:34824
    ds_read_b64_tr_b16 a[98:99], v114 offset:35336
    v_mfma_f32_16x16x32_bf16 v[172:175], a[104:107], a[252:255], v[172:175]
    v_mfma_f32_16x16x32_bf16 v[160:163], a[104:107], a[240:243], v[160:163]
    buffer_load_dwordx4 v102, s[8:11], s69 offen offset:2048 lds
    v_mfma_f32_16x16x32_bf16 v[160:163], a[100:103], a[224:227], v[160:163]
    v_mfma_f32_16x16x32_bf16 v[164:167], a[100:103], a[228:231], v[164:167]
    v_mfma_f32_16x16x32_bf16 v[164:167], a[104:107], a[244:247], v[164:167]
    v_mfma_f32_16x16x32_bf16 v[168:171], a[104:107], a[248:251], v[168:171]
    buffer_load_dwordx4 v103, s[8:11], s69 offen offset:3072 lds
    v_mfma_f32_16x16x32_bf16 v[168:171], a[100:103], a[232:235], v[168:171]
    s_add_u32 m0, s45, 32768
    ds_read_b64_tr_b16 a[100:101], v115 offset:32768
    ds_read_b64_tr_b16 a[102:103], v115 offset:33280
    v_mfma_f32_16x16x32_bf16 v[188:191], a[108:111], a[236:239], v[188:191]
    ds_read_b64_tr_b16 a[104:105], v115 offset:34816
    ds_read_b64_tr_b16 a[106:107], v115 offset:35328
    v_mfma_f32_16x16x32_bf16 v[188:191], a[112:115], a[252:255], v[188:191]
    v_mfma_f32_16x16x32_bf16 v[176:179], a[112:115], a[240:243], v[176:179]
    buffer_load_dwordx4 v104, s[8:11], s69 offen offset:0 lds
    v_mfma_f32_16x16x32_bf16 v[176:179], a[108:111], a[224:227], v[176:179]
    v_mfma_f32_16x16x32_bf16 v[180:183], a[108:111], a[228:231], v[180:183]
    v_mfma_f32_16x16x32_bf16 v[180:183], a[112:115], a[244:247], v[180:183]
    v_mfma_f32_16x16x32_bf16 v[184:187], a[112:115], a[248:251], v[184:187]
    s_waitcnt lgkmcnt(4)
    ds_read_b64_tr_b16 a[112:113], v115 offset:34824
    ds_read_b64_tr_b16 a[114:115], v115 offset:35336
    v_mfma_f32_16x16x32_bf16 v[184:187], a[108:111], a[232:235], v[184:187]
    ds_read_b64_tr_b16 a[108:109], v115 offset:32776
    ds_read_b64_tr_b16 a[110:111], v115 offset:33288
    v_mfma_f32_16x16x32_bf16 v[192:195], a[84:87], a[224:227], v[192:195]
    buffer_load_dwordx4 v105, s[8:11], s69 offen offset:1024 lds
    v_mfma_f32_16x16x32_bf16 v[192:195], a[88:91], a[240:243], v[192:195]
    v_mfma_f32_16x16x32_bf16 v[196:199], a[88:91], a[244:247], v[196:199]
    v_mfma_f32_16x16x32_bf16 v[196:199], a[84:87], a[228:231], v[196:199]
    v_mfma_f32_16x16x32_bf16 v[200:203], a[84:87], a[232:235], v[200:203]
    buffer_load_dwordx4 v106, s[8:11], s69 offen offset:2048 lds
    v_mfma_f32_16x16x32_bf16 v[200:203], a[88:91], a[248:251], v[200:203]
    v_mfma_f32_16x16x32_bf16 v[208:211], a[92:95], a[224:227], v[208:211]
    v_mfma_f32_16x16x32_bf16 v[208:211], a[96:99], a[240:243], v[208:211]
    v_mfma_f32_16x16x32_bf16 v[212:215], a[96:99], a[244:247], v[212:215]
    v_mfma_f32_16x16x32_bf16 v[212:215], a[92:95], a[228:231], v[212:215]
    s_waitcnt vmcnt(11) lgkmcnt(0)
    s_barrier
    ds_read_b128 a[128:131], v109 offset:57344
    v_mfma_f32_16x16x32_bf16 v[216:219], a[92:95], a[232:235], v[216:219]
    s_add_u32 m0, s44, 131072
    ds_read_b64_tr_b16 a[84:85], v112 offset:49152
    ds_read_b64_tr_b16 a[86:87], v112 offset:49664
    v_mfma_f32_16x16x32_bf16 v[216:219], a[96:99], a[248:251], v[216:219]
    ds_read_b128 a[144:147], v110 offset:57344
    ds_read_b64_tr_b16 a[88:89], v112 offset:51200
    v_mfma_f32_16x16x32_bf16 v[224:227], a[100:103], a[224:227], v[224:227]
    ds_read_b64_tr_b16 a[90:91], v112 offset:51712
    ds_read_b128 a[132:135], v108 offset:57344
    v_mfma_f32_16x16x32_bf16 v[224:227], a[104:107], a[240:243], v[224:227]
    ds_read_b128 a[116:119], v107 offset:57344
    ds_read_b128 a[120:123], v107 offset:59392
    v_mfma_f32_16x16x32_bf16 v[228:231], a[104:107], a[244:247], v[228:231]
    buffer_load_dwordx4 v96, s[20:23], s78 offen offset:0 lds
    v_mfma_f32_16x16x32_bf16 v[228:231], a[100:103], a[228:231], v[228:231]
    ds_read_b128 a[136:139], v108 offset:59392
    ds_read_b128 a[140:143], v108 offset:61440
    v_mfma_f32_16x16x32_bf16 v[232:235], a[100:103], a[232:235], v[232:235]
    ds_read_b128 a[124:127], v107 offset:61440
    ds_read_b64_tr_b16 a[92:93], v112 offset:49160
    v_mfma_f32_16x16x32_bf16 v[232:235], a[104:107], a[248:251], v[232:235]
    ds_read_b64_tr_b16 a[94:95], v112 offset:49672
    ds_read_b64_tr_b16 a[96:97], v112 offset:51208
    v_mfma_f32_16x16x32_bf16 v[240:243], a[108:111], a[224:227], v[240:243]
    buffer_load_dwordx4 v97, s[20:23], s78 offen offset:1024 lds
    v_mfma_f32_16x16x32_bf16 v[240:243], a[112:115], a[240:243], v[240:243]
    ds_read_b64_tr_b16 a[98:99], v112 offset:51720
    ds_read_b64_tr_b16 a[100:101], v113 offset:49152
    v_mfma_f32_16x16x32_bf16 v[244:247], a[112:115], a[244:247], v[244:247]
    ds_read_b64_tr_b16 a[102:103], v113 offset:49664
    ds_read_b64_tr_b16 a[104:105], v113 offset:51200
    v_mfma_f32_16x16x32_bf16 v[244:247], a[108:111], a[228:231], v[244:247]
    ds_read_b64_tr_b16 a[106:107], v113 offset:51712
    v_mfma_f32_16x16x32_bf16 v[248:251], a[108:111], a[232:235], v[248:251]
    s_waitcnt lgkmcnt(11)
    buffer_load_dwordx4 v98, s[20:23], s78 offen offset:2048 lds
    v_mfma_f32_16x16x32_bf16 v[248:251], a[112:115], a[248:251], v[248:251]
    ds_read_b64_tr_b16 a[108:109], v113 offset:49160
    ds_read_b64_tr_b16 a[110:111], v113 offset:49672
    v_mfma_f32_16x16x32_bf16 v[140:143], a[84:87], a[128:131], v[140:143]
    ds_read_b64_tr_b16 a[112:113], v113 offset:51208
    ds_read_b64_tr_b16 a[114:115], v113 offset:51720
    v_mfma_f32_16x16x32_bf16 v[140:143], a[88:91], a[144:147], v[140:143]
    v_mfma_f32_16x16x32_bf16 v[128:131], a[88:91], a[132:135], v[128:131]
    buffer_load_dwordx4 v99, s[20:23], s78 offen offset:3072 lds
    v_mfma_f32_16x16x32_bf16 v[128:131], a[84:87], a[116:119], v[128:131]
    s_waitcnt lgkmcnt(9)
    s_add_u32 m0, s45, 57344
    v_mfma_f32_16x16x32_bf16 v[132:135], a[84:87], a[120:123], v[132:135]
    v_mfma_f32_16x16x32_bf16 v[132:135], a[88:91], a[136:139], v[132:135]
    v_mfma_f32_16x16x32_bf16 v[136:139], a[88:91], a[140:143], v[136:139]
    buffer_load_dwordx4 v100, s[8:11], s70 offen offset:0 lds
    v_mfma_f32_16x16x32_bf16 v[136:139], a[84:87], a[124:127], v[136:139]
    s_waitcnt lgkmcnt(4)
    ds_read_b64_tr_b16 a[84:85], v114 offset:49152
    ds_read_b64_tr_b16 a[86:87], v114 offset:49664
    v_mfma_f32_16x16x32_bf16 v[156:159], a[92:95], a[128:131], v[156:159]
    ds_read_b64_tr_b16 a[88:89], v114 offset:51200
    ds_read_b64_tr_b16 a[90:91], v114 offset:51712
    v_mfma_f32_16x16x32_bf16 v[156:159], a[96:99], a[144:147], v[156:159]
    v_mfma_f32_16x16x32_bf16 v[144:147], a[96:99], a[132:135], v[144:147]
    buffer_load_dwordx4 v101, s[8:11], s70 offen offset:1024 lds
    v_mfma_f32_16x16x32_bf16 v[144:147], a[92:95], a[116:119], v[144:147]
    v_mfma_f32_16x16x32_bf16 v[148:151], a[92:95], a[120:123], v[148:151]
    v_mfma_f32_16x16x32_bf16 v[148:151], a[96:99], a[136:139], v[148:151]
    v_mfma_f32_16x16x32_bf16 v[152:155], a[96:99], a[140:143], v[152:155]
    buffer_load_dwordx4 v102, s[8:11], s70 offen offset:2048 lds
    v_mfma_f32_16x16x32_bf16 v[152:155], a[92:95], a[124:127], v[152:155]
    ds_read_b64_tr_b16 a[92:93], v114 offset:49160
    ds_read_b64_tr_b16 a[94:95], v114 offset:49672
    v_mfma_f32_16x16x32_bf16 v[172:175], a[100:103], a[128:131], v[172:175]
    ds_read_b64_tr_b16 a[96:97], v114 offset:51208
    ds_read_b64_tr_b16 a[98:99], v114 offset:51720
    v_mfma_f32_16x16x32_bf16 v[172:175], a[104:107], a[144:147], v[172:175]
    v_mfma_f32_16x16x32_bf16 v[160:163], a[104:107], a[132:135], v[160:163]
    buffer_load_dwordx4 v103, s[8:11], s70 offen offset:3072 lds
    v_mfma_f32_16x16x32_bf16 v[160:163], a[100:103], a[116:119], v[160:163]
    s_add_u32 m0, s45, 61440
    v_mfma_f32_16x16x32_bf16 v[164:167], a[100:103], a[120:123], v[164:167]
    v_mfma_f32_16x16x32_bf16 v[164:167], a[104:107], a[136:139], v[164:167]
    v_mfma_f32_16x16x32_bf16 v[168:171], a[104:107], a[140:143], v[168:171]
    s_waitcnt lgkmcnt(4)
    buffer_load_dwordx4 v104, s[8:11], s70 offen offset:0 lds
    v_mfma_f32_16x16x32_bf16 v[168:171], a[100:103], a[124:127], v[168:171]
    ds_read_b64_tr_b16 a[100:101], v115 offset:49152
    ds_read_b64_tr_b16 a[102:103], v115 offset:49664
    v_mfma_f32_16x16x32_bf16 v[188:191], a[108:111], a[128:131], v[188:191]
    ds_read_b64_tr_b16 a[104:105], v115 offset:51200
    ds_read_b64_tr_b16 a[106:107], v115 offset:51712
    v_mfma_f32_16x16x32_bf16 v[188:191], a[112:115], a[144:147], v[188:191]
    v_mfma_f32_16x16x32_bf16 v[176:179], a[112:115], a[132:135], v[176:179]
    buffer_load_dwordx4 v105, s[8:11], s70 offen offset:1024 lds
    v_mfma_f32_16x16x32_bf16 v[176:179], a[108:111], a[116:119], v[176:179]
    v_mfma_f32_16x16x32_bf16 v[180:183], a[108:111], a[120:123], v[180:183]
    v_mfma_f32_16x16x32_bf16 v[180:183], a[112:115], a[136:139], v[180:183]
    v_mfma_f32_16x16x32_bf16 v[184:187], a[112:115], a[140:143], v[184:187]
    ds_read_b64_tr_b16 a[112:113], v115 offset:51208
    ds_read_b64_tr_b16 a[114:115], v115 offset:51720
    v_mfma_f32_16x16x32_bf16 v[184:187], a[108:111], a[124:127], v[184:187]
    ds_read_b64_tr_b16 a[108:109], v115 offset:49160
    ds_read_b64_tr_b16 a[110:111], v115 offset:49672
    v_mfma_f32_16x16x32_bf16 v[192:195], a[84:87], a[116:119], v[192:195]
    buffer_load_dwordx4 v106, s[8:11], s70 offen offset:2048 lds
    v_mfma_f32_16x16x32_bf16 v[192:195], a[88:91], a[132:135], v[192:195]
    v_mfma_f32_16x16x32_bf16 v[196:199], a[88:91], a[136:139], v[196:199]
    v_mfma_f32_16x16x32_bf16 v[196:199], a[84:87], a[120:123], v[196:199]
    v_mfma_f32_16x16x32_bf16 v[200:203], a[84:87], a[124:127], v[200:203]
    s_waitcnt lgkmcnt(4)
    v_mfma_f32_16x16x32_bf16 v[200:203], a[88:91], a[140:143], v[200:203]
    v_mfma_f32_16x16x32_bf16 v[208:211], a[92:95], a[116:119], v[208:211]
    v_mfma_f32_16x16x32_bf16 v[208:211], a[96:99], a[132:135], v[208:211]
    v_mfma_f32_16x16x32_bf16 v[212:215], a[96:99], a[136:139], v[212:215]
    v_mfma_f32_16x16x32_bf16 v[212:215], a[92:95], a[120:123], v[212:215]
    s_waitcnt vmcnt(11) lgkmcnt(0)
    s_barrier
    s_add_u32 m0, s44, 147456
    v_mfma_f32_16x16x32_bf16 v[216:219], a[92:95], a[124:127], v[216:219]
    buffer_load_dwordx4 v96, s[20:23], s79 offen offset:0 lds
    v_mfma_f32_16x16x32_bf16 v[216:219], a[96:99], a[140:143], v[216:219]
    ds_read_b128 a[236:239], v109 offset:0
    ds_read_b64_tr_b16 a[84:85], v112 offset:16384
    v_mfma_f32_16x16x32_bf16 v[224:227], a[100:103], a[116:119], v[224:227]
    ds_read_b64_tr_b16 a[86:87], v112 offset:16896
    ds_read_b128 a[252:255], v110 offset:0
    v_mfma_f32_16x16x32_bf16 v[224:227], a[104:107], a[132:135], v[224:227]
    ds_read_b64_tr_b16 a[88:89], v112 offset:18432
    ds_read_b64_tr_b16 a[90:91], v112 offset:18944
    v_mfma_f32_16x16x32_bf16 v[228:231], a[104:107], a[136:139], v[228:231]
    buffer_load_dwordx4 v97, s[20:23], s79 offen offset:1024 lds
    v_mfma_f32_16x16x32_bf16 v[228:231], a[100:103], a[120:123], v[228:231]
    ds_read_b128 a[240:243], v108 offset:0
    ds_read_b128 a[224:227], v107 offset:0
    v_mfma_f32_16x16x32_bf16 v[232:235], a[100:103], a[124:127], v[232:235]
    ds_read_b128 a[228:231], v107 offset:2048
    ds_read_b128 a[244:247], v108 offset:2048
    v_mfma_f32_16x16x32_bf16 v[232:235], a[104:107], a[140:143], v[232:235]
    ds_read_b128 a[248:251], v108 offset:4096
    ds_read_b128 a[232:235], v107 offset:4096
    v_mfma_f32_16x16x32_bf16 v[240:243], a[108:111], a[116:119], v[240:243]
    buffer_load_dwordx4 v98, s[20:23], s79 offen offset:2048 lds
    v_mfma_f32_16x16x32_bf16 v[240:243], a[112:115], a[132:135], v[240:243]
    ds_read_b64_tr_b16 a[92:93], v112 offset:16392
    ds_read_b64_tr_b16 a[94:95], v112 offset:16904
    v_mfma_f32_16x16x32_bf16 v[244:247], a[112:115], a[136:139], v[244:247]
    ds_read_b64_tr_b16 a[96:97], v112 offset:18440
    ds_read_b64_tr_b16 a[98:99], v112 offset:18952
    v_mfma_f32_16x16x32_bf16 v[244:247], a[108:111], a[120:123], v[244:247]
    ds_read_b64_tr_b16 a[100:101], v113 offset:16384
    ds_read_b64_tr_b16 a[102:103], v113 offset:16896
    v_mfma_f32_16x16x32_bf16 v[248:251], a[108:111], a[124:127], v[248:251]
    s_waitcnt lgkmcnt(12)
    buffer_load_dwordx4 v99, s[20:23], s79 offen offset:3072 lds
    v_mfma_f32_16x16x32_bf16 v[248:251], a[112:115], a[140:143], v[248:251]
    s_add_u32 m0, s45, 86016
    ds_read_b64_tr_b16 a[104:105], v113 offset:18432
    ds_read_b64_tr_b16 a[106:107], v113 offset:18944
    v_mfma_f32_16x16x32_bf16 v[140:143], a[84:87], a[236:239], v[140:143]
    s_waitcnt lgkmcnt(12)
    ds_read_b64_tr_b16 a[108:109], v113 offset:16392
    ds_read_b64_tr_b16 a[110:111], v113 offset:16904
    v_mfma_f32_16x16x32_bf16 v[140:143], a[88:91], a[252:255], v[140:143]
    ds_read_b64_tr_b16 a[112:113], v113 offset:18440
    ds_read_b64_tr_b16 a[114:115], v113 offset:18952
    v_mfma_f32_16x16x32_bf16 v[128:131], a[88:91], a[240:243], v[128:131]
    s_waitcnt lgkmcnt(12)
    buffer_load_dwordx4 v100, s[8:11], s71 offen offset:0 lds
    v_mfma_f32_16x16x32_bf16 v[128:131], a[84:87], a[224:227], v[128:131]
    v_mfma_f32_16x16x32_bf16 v[132:135], a[84:87], a[228:231], v[132:135]
    v_mfma_f32_16x16x32_bf16 v[132:135], a[88:91], a[244:247], v[132:135]
    v_mfma_f32_16x16x32_bf16 v[136:139], a[88:91], a[248:251], v[136:139]
    s_waitcnt lgkmcnt(6)
    buffer_load_dwordx4 v101, s[8:11], s71 offen offset:1024 lds
    v_mfma_f32_16x16x32_bf16 v[136:139], a[84:87], a[232:235], v[136:139]
    ds_read_b64_tr_b16 a[84:85], v114 offset:16384
    ds_read_b64_tr_b16 a[86:87], v114 offset:16896
    v_mfma_f32_16x16x32_bf16 v[156:159], a[92:95], a[236:239], v[156:159]
    ds_read_b64_tr_b16 a[88:89], v114 offset:18432
    ds_read_b64_tr_b16 a[90:91], v114 offset:18944
    v_mfma_f32_16x16x32_bf16 v[156:159], a[96:99], a[252:255], v[156:159]
    v_mfma_f32_16x16x32_bf16 v[144:147], a[96:99], a[240:243], v[144:147]
    buffer_load_dwordx4 v102, s[8:11], s71 offen offset:2048 lds
    v_mfma_f32_16x16x32_bf16 v[144:147], a[92:95], a[224:227], v[144:147]
    v_mfma_f32_16x16x32_bf16 v[148:151], a[92:95], a[228:231], v[148:151]
    v_mfma_f32_16x16x32_bf16 v[148:151], a[96:99], a[244:247], v[148:151]
    v_mfma_f32_16x16x32_bf16 v[152:155], a[96:99], a[248:251], v[152:155]
    buffer_load_dwordx4 v103, s[8:11], s71 offen offset:3072 lds
    v_mfma_f32_16x16x32_bf16 v[152:155], a[92:95], a[232:235], v[152:155]
    s_waitcnt lgkmcnt(4)
    s_add_u32 m0, s45, 90112
    ds_read_b64_tr_b16 a[92:93], v114 offset:16392
    v_mfma_f32_16x16x32_bf16 v[172:175], a[100:103], a[236:239], v[172:175]
    ds_read_b64_tr_b16 a[94:95], v114 offset:16904
    ds_read_b64_tr_b16 a[96:97], v114 offset:18440
    v_mfma_f32_16x16x32_bf16 v[172:175], a[104:107], a[252:255], v[172:175]
    ds_read_b64_tr_b16 a[98:99], v114 offset:18952
    v_mfma_f32_16x16x32_bf16 v[160:163], a[104:107], a[240:243], v[160:163]
    buffer_load_dwordx4 v104, s[8:11], s71 offen offset:0 lds
    v_mfma_f32_16x16x32_bf16 v[160:163], a[100:103], a[224:227], v[160:163]
    v_mfma_f32_16x16x32_bf16 v[164:167], a[100:103], a[228:231], v[164:167]
    v_mfma_f32_16x16x32_bf16 v[164:167], a[104:107], a[244:247], v[164:167]
    v_mfma_f32_16x16x32_bf16 v[168:171], a[104:107], a[248:251], v[168:171]
    buffer_load_dwordx4 v105, s[8:11], s71 offen offset:1024 lds
    v_mfma_f32_16x16x32_bf16 v[168:171], a[100:103], a[232:235], v[168:171]
    ds_read_b64_tr_b16 a[100:101], v115 offset:16384
    ds_read_b64_tr_b16 a[102:103], v115 offset:16896
    v_mfma_f32_16x16x32_bf16 v[188:191], a[108:111], a[236:239], v[188:191]
    ds_read_b64_tr_b16 a[104:105], v115 offset:18432
    ds_read_b64_tr_b16 a[106:107], v115 offset:18944
    v_mfma_f32_16x16x32_bf16 v[188:191], a[112:115], a[252:255], v[188:191]
    v_mfma_f32_16x16x32_bf16 v[176:179], a[112:115], a[240:243], v[176:179]
    buffer_load_dwordx4 v106, s[8:11], s71 offen offset:2048 lds
    v_mfma_f32_16x16x32_bf16 v[176:179], a[108:111], a[224:227], v[176:179]
    s_add_u32 m0, s44, 0
    s_lshr_b32 s47, s2, 7
    s_lshl_b32 s47, s47, 1
    v_mfma_f32_16x16x32_bf16 v[180:183], a[108:111], a[228:231], v[180:183]
    s_xor_b32 s48, s60, 1
    s_lshr_b32 s46, s2, 7
    s_xor_b32 s46, s46, 1
    v_mfma_f32_16x16x32_bf16 v[180:183], a[112:115], a[244:247], v[180:183]
    s_and_b32 s46, s46, 3
    s_lshl_b32 s72, s46, 17
    s_mul_i32 s4, s48, 458752
    v_mfma_f32_16x16x32_bf16 v[184:187], a[112:115], a[248:251], v[184:187]
    s_waitcnt lgkmcnt(4)
    buffer_load_dwordx4 v14, s[12:15], s84 offen offset:0 nt lds
    v_mfma_f32_16x16x32_bf16 v[184:187], a[108:111], a[232:235], v[184:187]
    s_mul_i32 s46, s46, 14336
    ds_read_b64_tr_b16 a[108:109], v115 offset:16392
    ds_read_b64_tr_b16 a[110:111], v115 offset:16904
    v_mfma_f32_16x16x32_bf16 v[192:195], a[84:87], a[224:227], v[192:195]
    s_add_u32 s64, s46, s4
    ds_read_b64_tr_b16 a[112:113], v115 offset:18440
    ds_read_b64_tr_b16 a[114:115], v115 offset:18952
    v_mfma_f32_16x16x32_bf16 v[192:195], a[88:91], a[240:243], v[192:195]
    s_add_u32 s68, s46, s5
    s_lshr_b32 s46, s2, 7
    s_xor_b32 s46, s46, 3
    v_mfma_f32_16x16x32_bf16 v[196:199], a[88:91], a[244:247], v[196:199]
    s_and_b32 s46, s46, 3
    buffer_load_dwordx4 v15, s[12:15], s84 offen offset:1024 nt lds
    v_mfma_f32_16x16x32_bf16 v[196:199], a[84:87], a[228:231], v[196:199]
    s_lshl_b32 s73, s46, 17
    s_mul_i32 s46, s46, 14336
    s_add_u32 s65, s46, s4
    v_mfma_f32_16x16x32_bf16 v[200:203], a[84:87], a[232:235], v[200:203]
    s_add_u32 s69, s46, s5
    s_lshr_b32 s46, s2, 7
    s_xor_b32 s46, s46, 0
    v_mfma_f32_16x16x32_bf16 v[200:203], a[88:91], a[248:251], v[200:203]
    s_and_b32 s46, s46, 3
    s_lshl_b32 s74, s46, 17
    s_mul_i32 s46, s46, 14336
    v_mfma_f32_16x16x32_bf16 v[208:211], a[92:95], a[224:227], v[208:211]
    s_add_u32 s66, s46, s4
    buffer_load_dwordx4 v16, s[12:15], s84 offen offset:2048 nt lds
    v_mfma_f32_16x16x32_bf16 v[208:211], a[96:99], a[240:243], v[208:211]
    s_add_u32 s70, s46, s5
    s_lshr_b32 s46, s2, 7
    s_xor_b32 s46, s46, 2
    v_mfma_f32_16x16x32_bf16 v[212:215], a[96:99], a[244:247], v[212:215]
    s_and_b32 s46, s46, 3
    s_lshl_b32 s75, s46, 17
    s_mul_i32 s46, s46, 14336
    v_mfma_f32_16x16x32_bf16 v[212:215], a[92:95], a[228:231], v[212:215]
    s_add_u32 s67, s46, s4
    s_waitcnt vmcnt(14) lgkmcnt(0)
    s_barrier
    v_mfma_f32_16x16x32_bf16 v[216:219], a[92:95], a[232:235], v[216:219]
    s_add_u32 s71, s46, s5
    buffer_load_dwordx4 v17, s[12:15], s84 offen offset:3072 nt lds
    v_mfma_f32_16x16x32_bf16 v[216:219], a[96:99], a[248:251], v[216:219]
    s_add_u32 m0, s44, 16384
    ds_read_b128 a[128:131], v109 offset:28672
    ds_read_b64_tr_b16 a[84:85], v112 offset:32768
    v_mfma_f32_16x16x32_bf16 v[224:227], a[100:103], a[224:227], v[224:227]
    ds_read_b64_tr_b16 a[86:87], v112 offset:33280
    ds_read_b128 a[144:147], v110 offset:28672
    v_mfma_f32_16x16x32_bf16 v[224:227], a[104:107], a[240:243], v[224:227]
    ds_read_b64_tr_b16 a[88:89], v112 offset:34816
    ds_read_b64_tr_b16 a[90:91], v112 offset:35328
    v_mfma_f32_16x16x32_bf16 v[228:231], a[104:107], a[244:247], v[228:231]
    buffer_load_dwordx4 a[148:151], v18, s[16:19], s84 offen offset:0 nt
    v_mfma_f32_16x16x32_bf16 v[228:231], a[100:103], a[228:231], v[228:231]
    ds_read_b128 a[132:135], v108 offset:28672
    ds_read_b128 a[116:119], v107 offset:28672
    v_mfma_f32_16x16x32_bf16 v[232:235], a[100:103], a[232:235], v[232:235]
    ds_read_b128 a[120:123], v107 offset:30720
    ds_read_b128 a[136:139], v108 offset:30720
    v_mfma_f32_16x16x32_bf16 v[232:235], a[104:107], a[248:251], v[232:235]
    ds_read_b128 a[140:143], v108 offset:32768
    ds_read_b128 a[124:127], v107 offset:32768
    v_mfma_f32_16x16x32_bf16 v[240:243], a[108:111], a[224:227], v[240:243]
    buffer_load_dwordx4 a[152:155], v19, s[16:19], s84 offen offset:1024 nt
    v_mfma_f32_16x16x32_bf16 v[240:243], a[112:115], a[240:243], v[240:243]
    ds_read_b64_tr_b16 a[92:93], v112 offset:32776
    ds_read_b64_tr_b16 a[94:95], v112 offset:33288
    v_mfma_f32_16x16x32_bf16 v[244:247], a[112:115], a[244:247], v[244:247]
    ds_read_b64_tr_b16 a[96:97], v112 offset:34824
    ds_read_b64_tr_b16 a[98:99], v112 offset:35336
    v_mfma_f32_16x16x32_bf16 v[244:247], a[108:111], a[228:231], v[244:247]
    ds_read_b64_tr_b16 a[100:101], v113 offset:32768
    ds_read_b64_tr_b16 a[102:103], v113 offset:33280
    v_mfma_f32_16x16x32_bf16 v[248:251], a[108:111], a[232:235], v[248:251]
    s_waitcnt lgkmcnt(12)
    buffer_load_dwordx4 a[156:159], v20, s[16:19], s84 offen offset:2048 nt
    v_mfma_f32_16x16x32_bf16 v[248:251], a[112:115], a[248:251], v[248:251]
    ds_read_b64_tr_b16 a[104:105], v113 offset:34816
    ds_read_b64_tr_b16 a[106:107], v113 offset:35328
    v_mfma_f32_16x16x32_bf16 v[140:143], a[84:87], a[128:131], v[140:143]
    s_waitcnt lgkmcnt(12)
    ds_read_b64_tr_b16 a[108:109], v113 offset:32776
    ds_read_b64_tr_b16 a[110:111], v113 offset:33288
    v_mfma_f32_16x16x32_bf16 v[140:143], a[88:91], a[144:147], v[140:143]
    ds_read_b64_tr_b16 a[112:113], v113 offset:34824
    ds_read_b64_tr_b16 a[114:115], v113 offset:35336
    v_mfma_f32_16x16x32_bf16 v[128:131], a[88:91], a[132:135], v[128:131]
    s_waitcnt lgkmcnt(12)
    buffer_load_dwordx4 a[160:163], v21, s[16:19], s84 offen offset:3072 nt
    v_mfma_f32_16x16x32_bf16 v[128:131], a[84:87], a[116:119], v[128:131]
    v_mfma_f32_16x16x32_bf16 v[132:135], a[84:87], a[120:123], v[132:135]
    v_mfma_f32_16x16x32_bf16 v[132:135], a[88:91], a[136:139], v[132:135]
    v_mfma_f32_16x16x32_bf16 v[136:139], a[88:91], a[140:143], v[136:139]
    s_waitcnt lgkmcnt(6)
    ds_read_b64_tr_b16 a[88:89], v114 offset:34816
    ds_read_b64_tr_b16 a[90:91], v114 offset:35328
    v_mfma_f32_16x16x32_bf16 v[136:139], a[84:87], a[124:127], v[136:139]
    ds_read_b64_tr_b16 a[84:85], v114 offset:32768
    ds_read_b64_tr_b16 a[86:87], v114 offset:33280
    v_mfma_f32_16x16x32_bf16 v[156:159], a[92:95], a[128:131], v[156:159]
    v_mfma_f32_16x16x32_bf16 v[156:159], a[96:99], a[144:147], v[156:159]
    v_mfma_f32_16x16x32_bf16 v[144:147], a[96:99], a[132:135], v[144:147]
    v_mfma_f32_16x16x32_bf16 v[144:147], a[92:95], a[116:119], v[144:147]
    v_mfma_f32_16x16x32_bf16 v[148:151], a[92:95], a[120:123], v[148:151]
    v_mfma_f32_16x16x32_bf16 v[148:151], a[96:99], a[136:139], v[148:151]
    v_mfma_f32_16x16x32_bf16 v[152:155], a[96:99], a[140:143], v[152:155]
    ds_read_b64_tr_b16 a[96:97], v114 offset:34824
    ds_read_b64_tr_b16 a[98:99], v114 offset:35336
    v_mfma_f32_16x16x32_bf16 v[152:155], a[92:95], a[124:127], v[152:155]
    s_waitcnt lgkmcnt(4)
    buffer_load_dwordx4 v14, s[12:15], s85 offen offset:0 nt lds
    v_mfma_f32_16x16x32_bf16 v[172:175], a[100:103], a[128:131], v[172:175]
    ds_read_b64_tr_b16 a[92:93], v114 offset:32776
    ds_read_b64_tr_b16 a[94:95], v114 offset:33288
    v_mfma_f32_16x16x32_bf16 v[172:175], a[104:107], a[144:147], v[172:175]
    v_mfma_f32_16x16x32_bf16 v[160:163], a[104:107], a[132:135], v[160:163]
    v_mfma_f32_16x16x32_bf16 v[160:163], a[100:103], a[116:119], v[160:163]
    v_mfma_f32_16x16x32_bf16 v[164:167], a[100:103], a[120:123], v[164:167]
    v_mfma_f32_16x16x32_bf16 v[164:167], a[104:107], a[136:139], v[164:167]
    v_mfma_f32_16x16x32_bf16 v[168:171], a[104:107], a[140:143], v[168:171]
    ds_read_b64_tr_b16 a[104:105], v115 offset:34816
    ds_read_b64_tr_b16 a[106:107], v115 offset:35328
    v_mfma_f32_16x16x32_bf16 v[168:171], a[100:103], a[124:127], v[168:171]
    ds_read_b64_tr_b16 a[100:101], v115 offset:32768
    ds_read_b64_tr_b16 a[102:103], v115 offset:33280
    v_mfma_f32_16x16x32_bf16 v[188:191], a[108:111], a[128:131], v[188:191]
    v_mfma_f32_16x16x32_bf16 v[188:191], a[112:115], a[144:147], v[188:191]
    v_mfma_f32_16x16x32_bf16 v[176:179], a[112:115], a[132:135], v[176:179]
    v_mfma_f32_16x16x32_bf16 v[176:179], a[108:111], a[116:119], v[176:179]
    v_mfma_f32_16x16x32_bf16 v[180:183], a[108:111], a[120:123], v[180:183]
    buffer_load_dwordx4 v15, s[12:15], s85 offen offset:1024 nt lds
    v_mfma_f32_16x16x32_bf16 v[180:183], a[112:115], a[136:139], v[180:183]
    v_mfma_f32_16x16x32_bf16 v[184:187], a[112:115], a[140:143], v[184:187]
    s_waitcnt lgkmcnt(4)
    ds_read_b64_tr_b16 a[112:113], v115 offset:34824
    ds_read_b64_tr_b16 a[114:115], v115 offset:35336
    v_mfma_f32_16x16x32_bf16 v[184:187], a[108:111], a[124:127], v[184:187]
    ds_read_b64_tr_b16 a[108:109], v115 offset:32776
    ds_read_b64_tr_b16 a[110:111], v115 offset:33288
    v_mfma_f32_16x16x32_bf16 v[192:195], a[84:87], a[116:119], v[192:195]
    v_mfma_f32_16x16x32_bf16 v[192:195], a[88:91], a[132:135], v[192:195]
    v_mfma_f32_16x16x32_bf16 v[196:199], a[88:91], a[136:139], v[196:199]
    v_mfma_f32_16x16x32_bf16 v[196:199], a[84:87], a[120:123], v[196:199]
    v_mfma_f32_16x16x32_bf16 v[200:203], a[84:87], a[124:127], v[200:203]
    v_mfma_f32_16x16x32_bf16 v[200:203], a[88:91], a[140:143], v[200:203]
    v_mfma_f32_16x16x32_bf16 v[208:211], a[92:95], a[116:119], v[208:211]
    v_mfma_f32_16x16x32_bf16 v[208:211], a[96:99], a[132:135], v[208:211]
    v_mfma_f32_16x16x32_bf16 v[212:215], a[96:99], a[136:139], v[212:215]
    v_mfma_f32_16x16x32_bf16 v[212:215], a[92:95], a[120:123], v[212:215]
    buffer_load_dwordx4 v16, s[12:15], s85 offen offset:2048 nt lds
    buffer_load_dwordx4 v17, s[12:15], s85 offen offset:3072 nt lds
    s_waitcnt vmcnt(12) lgkmcnt(0)
    s_barrier
    s_branch L_common
L_var2:
    s_waitcnt vmcnt(11) lgkmcnt(0)
    s_barrier
    ds_read_b128 a[128:131], v109 offset:28672
    ds_read_b64_tr_b16 a[84:85], v112 offset:32768
    ds_read_b64_tr_b16 a[86:87], v112 offset:33280
    ds_read_b128 a[144:147], v110 offset:28672
    ds_read_b64_tr_b16 a[88:89], v112 offset:34816
    ds_read_b64_tr_b16 a[90:91], v112 offset:35328
    ds_read_b128 a[132:135], v108 offset:28672
    ds_read_b128 a[116:119], v107 offset:28672
    ds_read_b128 a[120:123], v107 offset:30720
    ds_read_b128 a[136:139], v108 offset:30720
    ds_read_b128 a[140:143], v108 offset:32768
    ds_read_b128 a[124:127], v107 offset:32768
    ds_read_b64_tr_b16 a[92:93], v112 offset:32776
    ds_read_b64_tr_b16 a[94:95], v112 offset:33288
    ds_read_b64_tr_b16 a[96:97], v112 offset:34824
    ds_read_b64_tr_b16 a[98:99], v112 offset:35336
    ds_read_b64_tr_b16 a[100:101], v113 offset:32768
    ds_read_b64_tr_b16 a[102:103], v113 offset:33280
    ds_read_b64_tr_b16 a[104:105], v113 offset:34816
    ds_read_b64_tr_b16 a[106:107], v113 offset:35328
    ds_read_b64_tr_b16 a[108:109], v113 offset:32776
    ds_read_b64_tr_b16 a[110:111], v113 offset:33288
    ds_read_b64_tr_b16 a[112:113], v113 offset:34824
    ds_read_b64_tr_b16 a[114:115], v113 offset:35336
    s_add_u32 m0, s44, 114688
    s_mul_i32 s5, s60, 458752
    buffer_load_dwordx4 v96, s[20:23], s74 offen offset:0 lds
    s_waitcnt lgkmcnt(15)
    v_mfma_f32_16x16x32_bf16 v[140:143], a[84:87], a[128:131], 0
    v_mfma_f32_16x16x32_bf16 v[140:143], a[88:91], a[144:147], v[140:143]
    v_mfma_f32_16x16x32_bf16 v[128:131], a[88:91], a[132:135], 0
    buffer_load_dwordx4 v97, s[20:23], s74 offen offset:1024 lds
    v_mfma_f32_16x16x32_bf16 v[128:131], a[84:87], a[116:119], v[128:131]
    s_waitcnt lgkmcnt(8)
    v_mfma_f32_16x16x32_bf16 v[132:135], a[84:87], a[120:123], 0
    v_mfma_f32_16x16x32_bf16 v[132:135], a[88:91], a[136:139], v[132:135]
    v_mfma_f32_16x16x32_bf16 v[136:139], a[88:91], a[140:143], 0
    ds_read_b64_tr_b16 a[88:89], v114 offset:34816
    ds_read_b64_tr_b16 a[90:91], v114 offset:35328
    v_mfma_f32_16x16x32_bf16 v[136:139], a[84:87], a[124:127], v[136:139]
    ds_read_b64_tr_b16 a[84:85], v114 offset:32768
    ds_read_b64_tr_b16 a[86:87], v114 offset:33280
    v_mfma_f32_16x16x32_bf16 v[156:159], a[92:95], a[128:131], 0
    buffer_load_dwordx4 v98, s[20:23], s74 offen offset:2048 lds
    v_mfma_f32_16x16x32_bf16 v[156:159], a[96:99], a[144:147], v[156:159]
    v_mfma_f32_16x16x32_bf16 v[144:147], a[96:99], a[132:135], 0
    v_mfma_f32_16x16x32_bf16 v[144:147], a[92:95], a[116:119], v[144:147]
    v_mfma_f32_16x16x32_bf16 v[148:151], a[92:95], a[120:123], 0
    buffer_load_dwordx4 v99, s[20:23], s74 offen offset:3072 lds
    v_mfma_f32_16x16x32_bf16 v[148:151], a[96:99], a[136:139], v[148:151]
    s_add_u32 m0, s45, 28672
    v_mfma_f32_16x16x32_bf16 v[152:155], a[96:99], a[140:143], 0
    s_waitcnt lgkmcnt(4)
    ds_read_b64_tr_b16 a[96:97], v114 offset:34824
    ds_read_b64_tr_b16 a[98:99], v114 offset:35336
    v_mfma_f32_16x16x32_bf16 v[152:155], a[92:95], a[124:127], v[152:155]
    ds_read_b64_tr_b16 a[92:93], v114 offset:32776
    ds_read_b64_tr_b16 a[94:95], v114 offset:33288
    v_mfma_f32_16x16x32_bf16 v[172:175], a[100:103], a[128:131], 0
    buffer_load_dwordx4 v100, s[8:11], s66 offen offset:0 lds
    v_mfma_f32_16x16x32_bf16 v[172:175], a[104:107], a[144:147], v[172:175]
    v_mfma_f32_16x16x32_bf16 v[160:163], a[104:107], a[132:135], 0
    v_mfma_f32_16x16x32_bf16 v[160:163], a[100:103], a[116:119], v[160:163]
    v_mfma_f32_16x16x32_bf16 v[164:167], a[100:103], a[120:123], 0
    buffer_load_dwordx4 v101, s[8:11], s66 offen offset:1024 lds
    v_mfma_f32_16x16x32_bf16 v[164:167], a[104:107], a[136:139], v[164:167]
    v_mfma_f32_16x16x32_bf16 v[168:171], a[104:107], a[140:143], 0
    ds_read_b64_tr_b16 a[104:105], v115 offset:34816
    ds_read_b64_tr_b16 a[106:107], v115 offset:35328
    v_mfma_f32_16x16x32_bf16 v[168:171], a[100:103], a[124:127], v[168:171]
    ds_read_b64_tr_b16 a[100:101], v115 offset:32768
    ds_read_b64_tr_b16 a[102:103], v115 offset:33280
    v_mfma_f32_16x16x32_bf16 v[188:191], a[108:111], a[128:131], 0
    buffer_load_dwordx4 v102, s[8:11], s66 offen offset:2048 lds
    v_mfma_f32_16x16x32_bf16 v[188:191], a[112:115], a[144:147], v[188:191]
    v_mfma_f32_16x16x32_bf16 v[176:179], a[112:115], a[132:135], 0
    v_mfma_f32_16x16x32_bf16 v[176:179], a[108:111], a[116:119], v[176:179]
    v_mfma_f32_16x16x32_bf16 v[180:183], a[108:111], a[120:123], 0
    buffer_load_dwordx4 v103, s[8:11], s66 offen offset:3072 lds
    v_mfma_f32_16x16x32_bf16 v[180:183], a[112:115], a[136:139], v[180:183]
    s_add_u32 m0, s45, 32768
    v_mfma_f32_16x16x32_bf16 v[184:187], a[112:115], a[140:143], 0
    s_waitcnt lgkmcnt(4)
    ds_read_b64_tr_b16 a[112:113], v115 offset:34824
    ds_read_b64_tr_b16 a[114:115], v115 offset:35336
    v_mfma_f32_16x16x32_bf16 v[184:187], a[108:111], a[124:127], v[184:187]
    ds_read_b64_tr_b16 a[108:109], v115 offset:32776
    ds_read_b64_tr_b16 a[110:111], v115 offset:33288
    v_mfma_f32_16x16x32_bf16 v[192:195], a[84:87], a[116:119], 0
    buffer_load_dwordx4 v104, s[8:11], s66 offen offset:0 lds
    v_mfma_f32_16x16x32_bf16 v[192:195], a[88:91], a[132:135], v[192:195]
    v_mfma_f32_16x16x32_bf16 v[196:199], a[88:91], a[136:139], 0
    v_mfma_f32_16x16x32_bf16 v[196:199], a[84:87], a[120:123], v[196:199]
    v_mfma_f32_16x16x32_bf16 v[200:203], a[84:87], a[124:127], 0
    buffer_load_dwordx4 v105, s[8:11], s66 offen offset:1024 lds
    v_mfma_f32_16x16x32_bf16 v[200:203], a[88:91], a[140:143], v[200:203]
    v_mfma_f32_16x16x32_bf16 v[208:211], a[92:95], a[116:119], 0
    v_mfma_f32_16x16x32_bf16 v[208:211], a[96:99], a[132:135], v[208:211]
    v_mfma_f32_16x16x32_bf16 v[212:215], a[96:99], a[136:139], 0
    buffer_load_dwordx4 v106, s[8:11], s66 offen offset:2048 lds
    v_mfma_f32_16x16x32_bf16 v[212:215], a[92:95], a[120:123], v[212:215]
    v_mfma_f32_16x16x32_bf16 v[216:219], a[92:95], a[124:127], 0
    s_waitcnt lgkmcnt(0)
    v_mfma_f32_16x16x32_bf16 v[216:219], a[96:99], a[140:143], v[216:219]
    v_mfma_f32_16x16x32_bf16 v[224:227], a[100:103], a[116:119], 0
    v_mfma_f32_16x16x32_bf16 v[224:227], a[104:107], a[132:135], v[224:227]
    v_mfma_f32_16x16x32_bf16 v[228:231], a[104:107], a[136:139], 0
    v_mfma_f32_16x16x32_bf16 v[228:231], a[100:103], a[120:123], v[228:231]
    v_mfma_f32_16x16x32_bf16 v[232:235], a[100:103], a[124:127], 0
    v_mfma_f32_16x16x32_bf16 v[232:235], a[104:107], a[140:143], v[232:235]
    v_mfma_f32_16x16x32_bf16 v[240:243], a[108:111], a[116:119], 0
    v_mfma_f32_16x16x32_bf16 v[240:243], a[112:115], a[132:135], v[240:243]
    v_mfma_f32_16x16x32_bf16 v[244:247], a[112:115], a[136:139], 0
    v_mfma_f32_16x16x32_bf16 v[244:247], a[108:111], a[120:123], v[244:247]
    v_mfma_f32_16x16x32_bf16 v[248:251], a[108:111], a[124:127], 0
    s_waitcnt vmcnt(11) lgkmcnt(0)
    s_barrier
    ds_read_b128 a[236:239], v109 offset:57344
    v_mfma_f32_16x16x32_bf16 v[248:251], a[112:115], a[140:143], v[248:251]
    s_add_u32 m0, s44, 131072
    ds_read_b64_tr_b16 a[84:85], v112 offset:49152
    ds_read_b64_tr_b16 a[86:87], v112 offset:49664
    ds_read_b128 a[252:255], v110 offset:57344
    ds_read_b64_tr_b16 a[88:89], v112 offset:51200
    ds_read_b64_tr_b16 a[90:91], v112 offset:51712
    ds_read_b128 a[240:243], v108 offset:57344
    ds_read_b128 a[224:227], v107 offset:57344
    ds_read_b128 a[228:231], v107 offset:59392
    ds_read_b128 a[244:247], v108 offset:59392
    ds_read_b128 a[248:251], v108 offset:61440
    ds_read_b128 a[232:235], v107 offset:61440
    ds_read_b64_tr_b16 a[92:93], v112 offset:49160
    ds_read_b64_tr_b16 a[94:95], v112 offset:49672
    ds_read_b64_tr_b16 a[96:97], v112 offset:51208
    ds_read_b64_tr_b16 a[98:99], v112 offset:51720
    ds_read_b64_tr_b16 a[100:101], v113 offset:49152
    ds_read_b64_tr_b16 a[102:103], v113 offset:49664
    ds_read_b64_tr_b16 a[104:105], v113 offset:51200
    ds_read_b64_tr_b16 a[106:107], v113 offset:51712
    ds_read_b64_tr_b16 a[108:109], v113 offset:49160
    ds_read_b64_tr_b16 a[110:111], v113 offset:49672
    ds_read_b64_tr_b16 a[112:113], v113 offset:51208
    ds_read_b64_tr_b16 a[114:115], v113 offset:51720
    buffer_load_dwordx4 v96, s[20:23], s75 offen offset:0 lds
    s_waitcnt lgkmcnt(15)
    v_mfma_f32_16x16x32_bf16 v[140:143], a[84:87], a[236:239], v[140:143]
    v_mfma_f32_16x16x32_bf16 v[140:143], a[88:91], a[252:255], v[140:143]
    buffer_load_dwordx4 v97, s[20:23], s75 offen offset:1024 lds
    v_mfma_f32_16x16x32_bf16 v[128:131], a[88:91], a[240:243], v[128:131]
    v_mfma_f32_16x16x32_bf16 v[128:131], a[84:87], a[224:227], v[128:131]
    s_waitcnt lgkmcnt(8)
    v_mfma_f32_16x16x32_bf16 v[132:135], a[84:87], a[228:231], v[132:135]
    v_mfma_f32_16x16x32_bf16 v[132:135], a[88:91], a[244:247], v[132:135]
    buffer_load_dwordx4 v98, s[20:23], s75 offen offset:2048 lds
    v_mfma_f32_16x16x32_bf16 v[136:139], a[88:91], a[248:251], v[136:139]
    ds_read_b64_tr_b16 a[88:89], v114 offset:51200
    ds_read_b64_tr_b16 a[90:91], v114 offset:51712
    v_mfma_f32_16x16x32_bf16 v[136:139], a[84:87], a[232:235], v[136:139]
    ds_read_b64_tr_b16 a[84:85], v114 offset:49152
    ds_read_b64_tr_b16 a[86:87], v114 offset:49664
    v_mfma_f32_16x16x32_bf16 v[156:159], a[92:95], a[236:239], v[156:159]
    v_mfma_f32_16x16x32_bf16 v[156:159], a[96:99], a[252:255], v[156:159]
    buffer_load_dwordx4 v99, s[20:23], s75 offen offset:3072 lds
    v_mfma_f32_16x16x32_bf16 v[144:147], a[96:99], a[240:243], v[144:147]
    s_add_u32 m0, s45, 57344
    v_mfma_f32_16x16x32_bf16 v[144:147], a[92:95], a[224:227], v[144:147]
    v_mfma_f32_16x16x32_bf16 v[148:151], a[92:95], a[228:231], v[148:151]
    v_mfma_f32_16x16x32_bf16 v[148:151], a[96:99], a[244:247], v[148:151]
    buffer_load_dwordx4 v100, s[8:11], s67 offen offset:0 lds
    v_mfma_f32_16x16x32_bf16 v[152:155], a[96:99], a[248:251], v[152:155]
    s_waitcnt lgkmcnt(4)
    ds_read_b64_tr_b16 a[96:97], v114 offset:51208
    ds_read_b64_tr_b16 a[98:99], v114 offset:51720
    v_mfma_f32_16x16x32_bf16 v[152:155], a[92:95], a[232:235], v[152:155]
    ds_read_b64_tr_b16 a[92:93], v114 offset:49160
    ds_read_b64_tr_b16 a[94:95], v114 offset:49672
    v_mfma_f32_16x16x32_bf16 v[172:175], a[100:103], a[236:239], v[172:175]
    v_mfma_f32_16x16x32_bf16 v[172:175], a[104:107], a[252:255], v[172:175]
    buffer_load_dwordx4 v101, s[8:11], s67 offen offset:1024 lds
    v_mfma_f32_16x16x32_bf16 v[160:163], a[104:107], a[240:243], v[160:163]
    v_mfma_f32_16x16x32_bf16 v[160:163], a[100:103], a[224:227], v[160:163]
    v_mfma_f32_16x16x32_bf16 v[164:167], a[100:103], a[228:231], v[164:167]
    v_mfma_f32_16x16x32_bf16 v[164:167], a[104:107], a[244:247], v[164:167]
    buffer_load_dwordx4 v102, s[8:11], s67 offen offset:2048 lds
    v_mfma_f32_16x16x32_bf16 v[168:171], a[104:107], a[248:251], v[168:171]
    ds_read_b64_tr_b16 a[104:105], v115 offset:51200
    ds_read_b64_tr_b16 a[106:107], v115 offset:51712
    v_mfma_f32_16x16x32_bf16 v[168:171], a[100:103], a[232:235], v[168:171]
    ds_read_b64_tr_b16 a[100:101], v115 offset:49152
    ds_read_b64_tr_b16 a[102:103], v115 offset:49664
    v_mfma_f32_16x16x32_bf16 v[188:191], a[108:111], a[236:239], v[188:191]
    v_mfma_f32_16x16x32_bf16 v[188:191], a[112:115], a[252:255], v[188:191]
    buffer_load_dwordx4 v103, s[8:11], s67 offen offset:3072 lds
    v_mfma_f32_16x16x32_bf16 v[176:179], a[112:115], a[240:243], v[176:179]
    s_add_u32 m0, s45, 61440
    v_mfma_f32_16x16x32_bf16 v[176:179], a[108:111], a[224:227], v[176:179]
    v_mfma_f32_16x16x32_bf16 v[180:183], a[108:111], a[228:231], v[180:183]
    v_mfma_f32_16x16x32_bf16 v[180:183], a[112:115], a[244:247], v[180:183]
    buffer_load_dwordx4 v104, s[8:11], s67 offen offset:0 lds
    v_mfma_f32_16x16x32_bf16 v[184:187], a[112:115], a[248:251], v[184:187]
    s_waitcnt lgkmcnt(4)
    ds_read_b64_tr_b16 a[112:113], v115 offset:51208
    ds_read_b64_tr_b16 a[114:115], v115 offset:51720
    v_mfma_f32_16x16x32_bf16 v[184:187], a[108:111], a[232:235], v[184:187]
    ds_read_b64_tr_b16 a[108:109], v115 offset:49160
    ds_read_b64_tr_b16 a[110:111], v115 offset:49672
    v_mfma_f32_16x16x32_bf16 v[192:195], a[84:87], a[224:227], v[192:195]
    v_mfma_f32_16x16x32_bf16 v[192:195], a[88:91], a[240:243], v[192:195]
    buffer_load_dwordx4 v105, s[8:11], s67 offen offset:1024 lds
    v_mfma_f32_16x16x32_bf16 v[196:199], a[88:91], a[244:247], v[196:199]
    v_mfma_f32_16x16x32_bf16 v[196:199], a[84:87], a[228:231], v[196:199]
    v_mfma_f32_16x16x32_bf16 v[200:203], a[84:87], a[232:235], v[200:203]
    v_mfma_f32_16x16x32_bf16 v[200:203], a[88:91], a[248:251], v[200:203]
    buffer_load_dwordx4 v106, s[8:11], s67 offen offset:2048 lds
    v_mfma_f32_16x16x32_bf16 v[208:211], a[92:95], a[224:227], v[208:211]
    v_mfma_f32_16x16x32_bf16 v[208:211], a[96:99], a[240:243], v[208:211]
    v_mfma_f32_16x16x32_bf16 v[212:215], a[96:99], a[244:247], v[212:215]
    v_mfma_f32_16x16x32_bf16 v[212:215], a[92:95], a[228:231], v[212:215]
    v_mfma_f32_16x16x32_bf16 v[216:219], a[92:95], a[232:235], v[216:219]
    s_waitcnt lgkmcnt(0)
    v_mfma_f32_16x16x32_bf16 v[216:219], a[96:99], a[248:251], v[216:219]
    v_mfma_f32_16x16x32_bf16 v[224:227], a[100:103], a[224:227], v[224:227]
    v_mfma_f32_16x16x32_bf16 v[224:227], a[104:107], a[240:243], v[224:227]
    v_mfma_f32_16x16x32_bf16 v[228:231], a[104:107], a[244:247], v[228:231]
    v_mfma_f32_16x16x32_bf16 v[228:231], a[100:103], a[228:231], v[228:231]
    v_mfma_f32_16x16x32_bf16 v[232:235], a[100:103], a[232:235], v[232:235]
    v_mfma_f32_16x16x32_bf16 v[232:235], a[104:107], a[248:251], v[232:235]
    v_mfma_f32_16x16x32_bf16 v[240:243], a[108:111], a[224:227], v[240:243]
    v_mfma_f32_16x16x32_bf16 v[240:243], a[112:115], a[240:243], v[240:243]
    v_mfma_f32_16x16x32_bf16 v[244:247], a[112:115], a[244:247], v[244:247]
    v_mfma_f32_16x16x32_bf16 v[244:247], a[108:111], a[228:231], v[244:247]
    v_mfma_f32_16x16x32_bf16 v[248:251], a[108:111], a[232:235], v[248:251]
    s_waitcnt vmcnt(11) lgkmcnt(0)
    s_barrier
    ds_read_b128 a[128:131], v109 offset:0
    v_mfma_f32_16x16x32_bf16 v[248:251], a[112:115], a[248:251], v[248:251]
    s_add_u32 m0, s44, 147456
    ds_read_b64_tr_b16 a[84:85], v112 offset:16384
    ds_read_b64_tr_b16 a[86:87], v112 offset:16896
    ds_read_b128 a[144:147], v110 offset:0
    ds_read_b64_tr_b16 a[88:89], v112 offset:18432
    ds_read_b64_tr_b16 a[90:91], v112 offset:18944
    ds_read_b128 a[132:135], v108 offset:0
    ds_read_b128 a[116:119], v107 offset:0
    ds_read_b128 a[120:123], v107 offset:2048
    ds_read_b128 a[136:139], v108 offset:2048
    ds_read_b128 a[140:143], v108 offset:4096
    ds_read_b128 a[124:127], v107 offset:4096
    ds_read_b64_tr_b16 a[92:93], v112 offset:16392
    ds_read_b64_tr_b16 a[94:95], v112 offset:16904
    ds_read_b64_tr_b16 a[96:97], v112 offset:18440
    ds_read_b64_tr_b16 a[98:99], v112 offset:18952
    ds_read_b64_tr_b16 a[100:101], v113 offset:16384
    ds_read_b64_tr_b16 a[102:103], v113 offset:16896
    ds_read_b64_tr_b16 a[104:105], v113 offset:18432
    ds_read_b64_tr_b16 a[106:107], v113 offset:18944
    buffer_load_dwordx4 v96, s[20:23], s76 offen offset:0 lds
    ds_read_b64_tr_b16 a[108:109], v113 offset:16392
    ds_read_b64_tr_b16 a[110:111], v113 offset:16904
    ds_read_b64_tr_b16 a[112:113], v113 offset:18440
    ds_read_b64_tr_b16 a[114:115], v113 offset:18952
    s_waitcnt lgkmcnt(15)
    v_mfma_f32_16x16x32_bf16 v[140:143], a[84:87], a[128:131], v[140:143]
    buffer_load_dwordx4 v97, s[20:23], s76 offen offset:1024 lds
    v_mfma_f32_16x16x32_bf16 v[140:143], a[88:91], a[144:147], v[140:143]
    v_mfma_f32_16x16x32_bf16 v[128:131], a[88:91], a[132:135], v[128:131]
    v_mfma_f32_16x16x32_bf16 v[128:131], a[84:87], a[116:119], v[128:131]
    s_waitcnt lgkmcnt(8)
    v_mfma_f32_16x16x32_bf16 v[132:135], a[84:87], a[120:123], v[132:135]
    buffer_load_dwordx4 v98, s[20:23], s76 offen offset:2048 lds
    v_mfma_f32_16x16x32_bf16 v[132:135], a[88:91], a[136:139], v[132:135]
    v_mfma_f32_16x16x32_bf16 v[136:139], a[88:91], a[140:143], v[136:139]
    ds_read_b64_tr_b16 a[88:89], v114 offset:18432
    ds_read_b64_tr_b16 a[90:91], v114 offset:18944
    v_mfma_f32_16x16x32_bf16 v[136:139], a[84:87], a[124:127], v[136:139]
    ds_read_b64_tr_b16 a[84:85], v114 offset:16384
    ds_read_b64_tr_b16 a[86:87], v114 offset:16896
    v_mfma_f32_16x16x32_bf16 v[156:159], a[92:95], a[128:131], v[156:159]
    buffer_load_dwordx4 v99, s[20:23], s76 offen offset:3072 lds
    v_mfma_f32_16x16x32_bf16 v[156:159], a[96:99], a[144:147], v[156:159]
    s_add_u32 m0, s45, 86016
    v_mfma_f32_16x16x32_bf16 v[144:147], a[96:99], a[132:135], v[144:147]
    v_mfma_f32_16x16x32_bf16 v[144:147], a[92:95], a[116:119], v[144:147]
    v_mfma_f32_16x16x32_bf16 v[148:151], a[92:95], a[120:123], v[148:151]
    buffer_load_dwordx4 v100, s[8:11], s68 offen offset:0 lds
    v_mfma_f32_16x16x32_bf16 v[148:151], a[96:99], a[136:139], v[148:151]
    v_mfma_f32_16x16x32_bf16 v[152:155], a[96:99], a[140:143], v[152:155]
    s_waitcnt lgkmcnt(4)
    ds_read_b64_tr_b16 a[96:97], v114 offset:18440
    ds_read_b64_tr_b16 a[98:99], v114 offset:18952
    v_mfma_f32_16x16x32_bf16 v[152:155], a[92:95], a[124:127], v[152:155]
    ds_read_b64_tr_b16 a[92:93], v114 offset:16392
    ds_read_b64_tr_b16 a[94:95], v114 offset:16904
    v_mfma_f32_16x16x32_bf16 v[172:175], a[100:103], a[128:131], v[172:175]
    buffer_load_dwordx4 v101, s[8:11], s68 offen offset:1024 lds
    v_mfma_f32_16x16x32_bf16 v[172:175], a[104:107], a[144:147], v[172:175]
    v_mfma_f32_16x16x32_bf16 v[160:163], a[104:107], a[132:135], v[160:163]
    v_mfma_f32_16x16x32_bf16 v[160:163], a[100:103], a[116:119], v[160:163]
    v_mfma_f32_16x16x32_bf16 v[164:167], a[100:103], a[120:123], v[164:167]
    buffer_load_dwordx4 v102, s[8:11], s68 offen offset:2048 lds
    v_mfma_f32_16x16x32_bf16 v[164:167], a[104:107], a[136:139], v[164:167]
    v_mfma_f32_16x16x32_bf16 v[168:171], a[104:107], a[140:143], v[168:171]
    ds_read_b64_tr_b16 a[104:105], v115 offset:18432
    ds_read_b64_tr_b16 a[106:107], v115 offset:18944
    v_mfma_f32_16x16x32_bf16 v[168:171], a[100:103], a[124:127], v[168:171]
    ds_read_b64_tr_b16 a[100:101], v115 offset:16384
    ds_read_b64_tr_b16 a[102:103], v115 offset:16896
    v_mfma_f32_16x16x32_bf16 v[188:191], a[108:111], a[128:131], v[188:191]
    buffer_load_dwordx4 v103, s[8:11], s68 offen offset:3072 lds
    v_mfma_f32_16x16x32_bf16 v[188:191], a[112:115], a[144:147], v[188:191]
    s_add_u32 m0, s45, 90112
    v_mfma_f32_16x16x32_bf16 v[176:179], a[112:115], a[132:135], v[176:179]
    v_mfma_f32_16x16x32_bf16 v[176:179], a[108:111], a[116:119], v[176:179]
    v_mfma_f32_16x16x32_bf16 v[180:183], a[108:111], a[120:123], v[180:183]
    buffer_load_dwordx4 v104, s[8:11], s68 offen offset:0 lds
    v_mfma_f32_16x16x32_bf16 v[180:183], a[112:115], a[136:139], v[180:183]
    v_mfma_f32_16x16x32_bf16 v[184:187], a[112:115], a[140:143], v[184:187]
    s_waitcnt lgkmcnt(4)
    ds_read_b64_tr_b16 a[112:113], v115 offset:18440
    ds_read_b64_tr_b16 a[114:115], v115 offset:18952
    v_mfma_f32_16x16x32_bf16 v[184:187], a[108:111], a[124:127], v[184:187]
    ds_read_b64_tr_b16 a[108:109], v115 offset:16392
    ds_read_b64_tr_b16 a[110:111], v115 offset:16904
    v_mfma_f32_16x16x32_bf16 v[192:195], a[84:87], a[116:119], v[192:195]
    buffer_load_dwordx4 v105, s[8:11], s68 offen offset:1024 lds
    v_mfma_f32_16x16x32_bf16 v[192:195], a[88:91], a[132:135], v[192:195]
    v_mfma_f32_16x16x32_bf16 v[196:199], a[88:91], a[136:139], v[196:199]
    v_mfma_f32_16x16x32_bf16 v[196:199], a[84:87], a[120:123], v[196:199]
    v_mfma_f32_16x16x32_bf16 v[200:203], a[84:87], a[124:127], v[200:203]
    buffer_load_dwordx4 v106, s[8:11], s68 offen offset:2048 lds
    v_mfma_f32_16x16x32_bf16 v[200:203], a[88:91], a[140:143], v[200:203]
    v_mfma_f32_16x16x32_bf16 v[208:211], a[92:95], a[116:119], v[208:211]
    v_mfma_f32_16x16x32_bf16 v[208:211], a[96:99], a[132:135], v[208:211]
    v_mfma_f32_16x16x32_bf16 v[212:215], a[96:99], a[136:139], v[212:215]
    v_mfma_f32_16x16x32_bf16 v[212:215], a[92:95], a[120:123], v[212:215]
    v_mfma_f32_16x16x32_bf16 v[216:219], a[92:95], a[124:127], v[216:219]
    s_waitcnt lgkmcnt(0)
    v_mfma_f32_16x16x32_bf16 v[216:219], a[96:99], a[140:143], v[216:219]
    v_mfma_f32_16x16x32_bf16 v[224:227], a[100:103], a[116:119], v[224:227]
    v_mfma_f32_16x16x32_bf16 v[224:227], a[104:107], a[132:135], v[224:227]
    v_mfma_f32_16x16x32_bf16 v[228:231], a[104:107], a[136:139], v[228:231]
    v_mfma_f32_16x16x32_bf16 v[228:231], a[100:103], a[120:123], v[228:231]
    v_mfma_f32_16x16x32_bf16 v[232:235], a[100:103], a[124:127], v[232:235]
    v_mfma_f32_16x16x32_bf16 v[232:235], a[104:107], a[140:143], v[232:235]
    v_mfma_f32_16x16x32_bf16 v[240:243], a[108:111], a[116:119], v[240:243]
    v_mfma_f32_16x16x32_bf16 v[240:243], a[112:115], a[132:135], v[240:243]
    v_mfma_f32_16x16x32_bf16 v[244:247], a[112:115], a[136:139], v[244:247]
    v_mfma_f32_16x16x32_bf16 v[244:247], a[108:111], a[120:123], v[244:247]
    v_mfma_f32_16x16x32_bf16 v[248:251], a[108:111], a[124:127], v[248:251]
    s_waitcnt vmcnt(11) lgkmcnt(0)
    s_barrier
    ds_read_b128 a[236:239], v109 offset:28672
    v_mfma_f32_16x16x32_bf16 v[248:251], a[112:115], a[140:143], v[248:251]
    s_add_u32 m0, s44, 114688
    ds_read_b64_tr_b16 a[84:85], v112 offset:32768
    ds_read_b64_tr_b16 a[86:87], v112 offset:33280
    ds_read_b128 a[252:255], v110 offset:28672
    ds_read_b64_tr_b16 a[88:89], v112 offset:34816
    ds_read_b64_tr_b16 a[90:91], v112 offset:35328
    ds_read_b128 a[240:243], v108 offset:28672
    ds_read_b128 a[224:227], v107 offset:28672
    ds_read_b128 a[228:231], v107 offset:30720
    ds_read_b128 a[244:247], v108 offset:30720
    ds_read_b128 a[248:251], v108 offset:32768
    ds_read_b128 a[232:235], v107 offset:32768
    ds_read_b64_tr_b16 a[92:93], v112 offset:32776
    ds_read_b64_tr_b16 a[94:95], v112 offset:33288
    ds_read_b64_tr_b16 a[96:97], v112 offset:34824
    ds_read_b64_tr_b16 a[98:99], v112 offset:35336
    buffer_load_dwordx4 v96, s[20:23], s77 offen offset:0 lds
    ds_read_b64_tr_b16 a[100:101], v113 offset:32768
    ds_read_b64_tr_b16 a[102:103], v113 offset:33280
    ds_read_b64_tr_b16 a[104:105], v113 offset:34816
    ds_read_b64_tr_b16 a[106:107], v113 offset:35328
    ds_read_b64_tr_b16 a[108:109], v113 offset:32776
    ds_read_b64_tr_b16 a[110:111], v113 offset:33288
    ds_read_b64_tr_b16 a[112:113], v113 offset:34824
    ds_read_b64_tr_b16 a[114:115], v113 offset:35336
    s_waitcnt lgkmcnt(15)
    v_mfma_f32_16x16x32_bf16 v[140:143], a[84:87], a[236:239], v[140:143]
    buffer_load_dwordx4 v97, s[20:23], s77 offen offset:1024 lds
    v_mfma_f32_16x16x32_bf16 v[140:143], a[88:91], a[252:255], v[140:143]
    v_mfma_f32_16x16x32_bf16 v[128:131], a[88:91], a[240:243], v[128:131]
    v_mfma_f32_16x16x32_bf16 v[128:131], a[84:87], a[224:227], v[128:131]
    s_waitcnt lgkmcnt(8)
    v_mfma_f32_16x16x32_bf16 v[132:135], a[84:87], a[228:231], v[132:135]
    buffer_load_dwordx4 v98, s[20:23], s77 offen offset:2048 lds
    v_mfma_f32_16x16x32_bf16 v[132:135], a[88:91], a[244:247], v[132:135]
    v_mfma_f32_16x16x32_bf16 v[136:139], a[88:91], a[248:251], v[136:139]
    ds_read_b64_tr_b16 a[88:89], v114 offset:34816
    ds_read_b64_tr_b16 a[90:91], v114 offset:35328
    v_mfma_f32_16x16x32_bf16 v[136:139], a[84:87], a[232:235], v[136:139]
    ds_read_b64_tr_b16 a[84:85], v114 offset:32768
    ds_read_b64_tr_b16 a[86:87], v114 offset:33280
    v_mfma_f32_16x16x32_bf16 v[156:159], a[92:95], a[236:239], v[156:159]
    buffer_load_dwordx4 v99, s[20:23], s77 offen offset:3072 lds
    v_mfma_f32_16x16x32_bf16 v[156:159], a[96:99], a[252:255], v[156:159]
    s_add_u32 m0, s45, 28672
    v_mfma_f32_16x16x32_bf16 v[144:147], a[96:99], a[240:243], v[144:147]
    v_mfma_f32_16x16x32_bf16 v[144:147], a[92:95], a[224:227], v[144:147]
    v_mfma_f32_16x16x32_bf16 v[148:151], a[92:95], a[228:231], v[148:151]
    buffer_load_dwordx4 v100, s[8:11], s69 offen offset:0 lds
    v_mfma_f32_16x16x32_bf16 v[148:151], a[96:99], a[244:247], v[148:151]
    v_mfma_f32_16x16x32_bf16 v[152:155], a[96:99], a[248:251], v[152:155]
    s_waitcnt lgkmcnt(4)
    ds_read_b64_tr_b16 a[96:97], v114 offset:34824
    ds_read_b64_tr_b16 a[98:99], v114 offset:35336
    v_mfma_f32_16x16x32_bf16 v[152:155], a[92:95], a[232:235], v[152:155]
    ds_read_b64_tr_b16 a[92:93], v114 offset:32776
    ds_read_b64_tr_b16 a[94:95], v114 offset:33288
    v_mfma_f32_16x16x32_bf16 v[172:175], a[100:103], a[236:239], v[172:175]
    buffer_load_dwordx4 v101, s[8:11], s69 offen offset:1024 lds
    v_mfma_f32_16x16x32_bf16 v[172:175], a[104:107], a[252:255], v[172:175]
    v_mfma_f32_16x16x32_bf16 v[160:163], a[104:107], a[240:243], v[160:163]
    v_mfma_f32_16x16x32_bf16 v[160:163], a[100:103], a[224:227], v[160:163]
    v_mfma_f32_16x16x32_bf16 v[164:167], a[100:103], a[228:231], v[164:167]
    buffer_load_dwordx4 v102, s[8:11], s69 offen offset:2048 lds
    v_mfma_f32_16x16x32_bf16 v[164:167], a[104:107], a[244:247], v[164:167]
    v_mfma_f32_16x16x32_bf16 v[168:171], a[104:107], a[248:251], v[168:171]
    ds_read_b64_tr_b16 a[104:105], v115 offset:34816
    ds_read_b64_tr_b16 a[106:107], v115 offset:35328
    v_mfma_f32_16x16x32_bf16 v[168:171], a[100:103], a[232:235], v[168:171]
    ds_read_b64_tr_b16 a[100:101], v115 offset:32768
    ds_read_b64_tr_b16 a[102:103], v115 offset:33280
    v_mfma_f32_16x16x32_bf16 v[188:191], a[108:111], a[236:239], v[188:191]
    buffer_load_dwordx4 v103, s[8:11], s69 offen offset:3072 lds
    v_mfma_f32_16x16x32_bf16 v[188:191], a[112:115], a[252:255], v[188:191]
    s_add_u32 m0, s45, 32768
    v_mfma_f32_16x16x32_bf16 v[176:179], a[112:115], a[240:243], v[176:179]
    v_mfma_f32_16x16x32_bf16 v[176:179], a[108:111], a[224:227], v[176:179]
    v_mfma_f32_16x16x32_bf16 v[180:183], a[108:111], a[228:231], v[180:183]
    buffer_load_dwordx4 v104, s[8:11], s69 offen offset:0 lds
    v_mfma_f32_16x16x32_bf16 v[180:183], a[112:115], a[244:247], v[180:183]
    v_mfma_f32_16x16x32_bf16 v[184:187], a[112:115], a[248:251], v[184:187]
    s_waitcnt lgkmcnt(4)
    ds_read_b64_tr_b16 a[112:113], v115 offset:34824
    ds_read_b64_tr_b16 a[114:115], v115 offset:35336
    v_mfma_f32_16x16x32_bf16 v[184:187], a[108:111], a[232:235], v[184:187]
    ds_read_b64_tr_b16 a[108:109], v115 offset:32776
    ds_read_b64_tr_b16 a[110:111], v115 offset:33288
    v_mfma_f32_16x16x32_bf16 v[192:195], a[84:87], a[224:227], v[192:195]
    buffer_load_dwordx4 v105, s[8:11], s69 offen offset:1024 lds
    v_mfma_f32_16x16x32_bf16 v[192:195], a[88:91], a[240:243], v[192:195]
    v_mfma_f32_16x16x32_bf16 v[196:199], a[88:91], a[244:247], v[196:199]
    v_mfma_f32_16x16x32_bf16 v[196:199], a[84:87], a[228:231], v[196:199]
    v_mfma_f32_16x16x32_bf16 v[200:203], a[84:87], a[232:235], v[200:203]
    buffer_load_dwordx4 v106, s[8:11], s69 offen offset:2048 lds
    v_mfma_f32_16x16x32_bf16 v[200:203], a[88:91], a[248:251], v[200:203]
    s_add_u32 m0, s44, 0
    v_mfma_f32_16x16x32_bf16 v[208:211], a[92:95], a[224:227], v[208:211]
    v_mfma_f32_16x16x32_bf16 v[208:211], a[96:99], a[240:243], v[208:211]
    v_mfma_f32_16x16x32_bf16 v[212:215], a[96:99], a[244:247], v[212:215]
    buffer_load_dwordx4 v14, s[12:15], s84 offen offset:0 nt lds
    v_mfma_f32_16x16x32_bf16 v[212:215], a[92:95], a[228:231], v[212:215]
    v_mfma_f32_16x16x32_bf16 v[216:219], a[92:95], a[232:235], v[216:219]
    s_waitcnt lgkmcnt(0)
    v_mfma_f32_16x16x32_bf16 v[216:219], a[96:99], a[248:251], v[216:219]
    v_mfma_f32_16x16x32_bf16 v[224:227], a[100:103], a[224:227], v[224:227]
    buffer_load_dwordx4 v15, s[12:15], s84 offen offset:1024 nt lds
    v_mfma_f32_16x16x32_bf16 v[224:227], a[104:107], a[240:243], v[224:227]
    v_mfma_f32_16x16x32_bf16 v[228:231], a[104:107], a[244:247], v[228:231]
    v_mfma_f32_16x16x32_bf16 v[228:231], a[100:103], a[228:231], v[228:231]
    v_mfma_f32_16x16x32_bf16 v[232:235], a[100:103], a[232:235], v[232:235]
    buffer_load_dwordx4 v16, s[12:15], s84 offen offset:2048 nt lds
    v_mfma_f32_16x16x32_bf16 v[232:235], a[104:107], a[248:251], v[232:235]
    v_mfma_f32_16x16x32_bf16 v[240:243], a[108:111], a[224:227], v[240:243]
    s_waitcnt vmcnt(14) lgkmcnt(0)
    s_barrier
    ds_read_b128 a[128:131], v109 offset:57344
    v_mfma_f32_16x16x32_bf16 v[240:243], a[112:115], a[240:243], v[240:243]
    ds_read_b64_tr_b16 a[84:85], v112 offset:49152
    ds_read_b64_tr_b16 a[86:87], v112 offset:49664
    v_mfma_f32_16x16x32_bf16 v[244:247], a[112:115], a[244:247], v[244:247]
    ds_read_b128 a[144:147], v110 offset:57344
    ds_read_b64_tr_b16 a[88:89], v112 offset:51200
    v_mfma_f32_16x16x32_bf16 v[244:247], a[108:111], a[228:231], v[244:247]
    ds_read_b64_tr_b16 a[90:91], v112 offset:51712
    ds_read_b128 a[132:135], v108 offset:57344
    v_mfma_f32_16x16x32_bf16 v[248:251], a[108:111], a[232:235], v[248:251]
    ds_read_b128 a[116:119], v107 offset:57344
    buffer_load_dwordx4 v17, s[12:15], s84 offen offset:3072 nt lds
    v_mfma_f32_16x16x32_bf16 v[248:251], a[112:115], a[248:251], v[248:251]
    s_add_u32 m0, s44, 131072
    ds_read_b128 a[120:123], v107 offset:59392
    ds_read_b128 a[136:139], v108 offset:59392
    ds_read_b128 a[140:143], v108 offset:61440
    ds_read_b128 a[124:127], v107 offset:61440
    ds_read_b64_tr_b16 a[92:93], v112 offset:49160
    ds_read_b64_tr_b16 a[94:95], v112 offset:49672
    ds_read_b64_tr_b16 a[96:97], v112 offset:51208
    ds_read_b64_tr_b16 a[98:99], v112 offset:51720
    ds_read_b64_tr_b16 a[100:101], v113 offset:49152
    ds_read_b64_tr_b16 a[102:103], v113 offset:49664
    buffer_load_dwordx4 a[148:151], v18, s[16:19], s84 offen offset:0 nt
    ds_read_b64_tr_b16 a[104:105], v113 offset:51200
    ds_read_b64_tr_b16 a[106:107], v113 offset:51712
    ds_read_b64_tr_b16 a[108:109], v113 offset:49160
    s_waitcnt lgkmcnt(15)
    v_mfma_f32_16x16x32_bf16 v[140:143], a[84:87], a[128:131], v[140:143]
    ds_read_b64_tr_b16 a[110:111], v113 offset:49672
    ds_read_b64_tr_b16 a[112:113], v113 offset:51208
    ds_read_b64_tr_b16 a[114:115], v113 offset:51720
    v_mfma_f32_16x16x32_bf16 v[140:143], a[88:91], a[144:147], v[140:143]
    s_waitcnt lgkmcnt(15)
    buffer_load_dwordx4 a[152:155], v19, s[16:19], s84 offen offset:1024 nt
    v_mfma_f32_16x16x32_bf16 v[128:131], a[88:91], a[132:135], v[128:131]
    v_mfma_f32_16x16x32_bf16 v[128:131], a[84:87], a[116:119], v[128:131]
    v_mfma_f32_16x16x32_bf16 v[132:135], a[84:87], a[120:123], v[132:135]
    s_waitcnt lgkmcnt(11)
    v_mfma_f32_16x16x32_bf16 v[132:135], a[88:91], a[136:139], v[132:135]
    buffer_load_dwordx4 a[156:159], v20, s[16:19], s84 offen offset:2048 nt
    v_mfma_f32_16x16x32_bf16 v[136:139], a[88:91], a[140:143], v[136:139]
    s_waitcnt lgkmcnt(5)
    ds_read_b64_tr_b16 a[88:89], v114 offset:51200
    ds_read_b64_tr_b16 a[90:91], v114 offset:51712
    v_mfma_f32_16x16x32_bf16 v[136:139], a[84:87], a[124:127], v[136:139]
    ds_read_b64_tr_b16 a[84:85], v114 offset:49152
    ds_read_b64_tr_b16 a[86:87], v114 offset:49664
    v_mfma_f32_16x16x32_bf16 v[156:159], a[92:95], a[128:131], v[156:159]
    v_mfma_f32_16x16x32_bf16 v[156:159], a[96:99], a[144:147], v[156:159]
    buffer_load_dwordx4 a[160:163], v21, s[16:19], s84 offen offset:3072 nt
    v_mfma_f32_16x16x32_bf16 v[144:147], a[96:99], a[132:135], v[144:147]
    v_mfma_f32_16x16x32_bf16 v[144:147], a[92:95], a[116:119], v[144:147]
    v_mfma_f32_16x16x32_bf16 v[148:151], a[92:95], a[120:123], v[148:151]
    v_mfma_f32_16x16x32_bf16 v[148:151], a[96:99], a[136:139], v[148:151]
    v_mfma_f32_16x16x32_bf16 v[152:155], a[96:99], a[140:143], v[152:155]
    ds_read_b64_tr_b16 a[96:97], v114 offset:51208
    ds_read_b64_tr_b16 a[98:99], v114 offset:51720
    v_mfma_f32_16x16x32_bf16 v[152:155], a[92:95], a[124:127], v[152:155]
    s_waitcnt lgkmcnt(4)
    ds_read_b64_tr_b16 a[92:93], v114 offset:49160
    ds_read_b64_tr_b16 a[94:95], v114 offset:49672
    v_mfma_f32_16x16x32_bf16 v[172:175], a[100:103], a[128:131], v[172:175]
    v_mfma_f32_16x16x32_bf16 v[172:175], a[104:107], a[144:147], v[172:175]
    v_mfma_f32_16x16x32_bf16 v[160:163], a[104:107], a[132:135], v[160:163]
    v_mfma_f32_16x16x32_bf16 v[160:163], a[100:103], a[116:119], v[160:163]
    v_mfma_f32_16x16x32_bf16 v[164:167], a[100:103], a[120:123], v[164:167]
    v_mfma_f32_16x16x32_bf16 v[164:167], a[104:107], a[136:139], v[164:167]
    v_mfma_f32_16x16x32_bf16 v[168:171], a[104:107], a[140:143], v[168:171]
    ds_read_b64_tr_b16 a[104:105], v115 offset:51200
    ds_read_b64_tr_b16 a[106:107], v115 offset:51712
    v_mfma_f32_16x16x32_bf16 v[168:171], a[100:103], a[124:127], v[168:171]
    ds_read_b64_tr_b16 a[100:101], v115 offset:49152
    ds_read_b64_tr_b16 a[102:103], v115 offset:49664
    v_mfma_f32_16x16x32_bf16 v[188:191], a[108:111], a[128:131], v[188:191]
    v_mfma_f32_16x16x32_bf16 v[188:191], a[112:115], a[144:147], v[188:191]
    v_mfma_f32_16x16x32_bf16 v[176:179], a[112:115], a[132:135], v[176:179]
    v_mfma_f32_16x16x32_bf16 v[176:179], a[108:111], a[116:119], v[176:179]
    v_mfma_f32_16x16x32_bf16 v[180:183], a[108:111], a[120:123], v[180:183]
    v_mfma_f32_16x16x32_bf16 v[180:183], a[112:115], a[136:139], v[180:183]
    v_mfma_f32_16x16x32_bf16 v[184:187], a[112:115], a[140:143], v[184:187]
    s_waitcnt lgkmcnt(4)
    ds_read_b64_tr_b16 a[112:113], v115 offset:51208
    ds_read_b64_tr_b16 a[114:115], v115 offset:51720
    v_mfma_f32_16x16x32_bf16 v[184:187], a[108:111], a[124:127], v[184:187]
    ds_read_b64_tr_b16 a[108:109], v115 offset:49160
    ds_read_b64_tr_b16 a[110:111], v115 offset:49672
    v_mfma_f32_16x16x32_bf16 v[192:195], a[84:87], a[116:119], v[192:195]
    v_mfma_f32_16x16x32_bf16 v[192:195], a[88:91], a[132:135], v[192:195]
    v_mfma_f32_16x16x32_bf16 v[196:199], a[88:91], a[136:139], v[196:199]
    v_mfma_f32_16x16x32_bf16 v[196:199], a[84:87], a[120:123], v[196:199]
    v_mfma_f32_16x16x32_bf16 v[200:203], a[84:87], a[124:127], v[200:203]
    v_mfma_f32_16x16x32_bf16 v[200:203], a[88:91], a[140:143], v[200:203]
    v_mfma_f32_16x16x32_bf16 v[208:211], a[92:95], a[116:119], v[208:211]
    v_mfma_f32_16x16x32_bf16 v[208:211], a[96:99], a[132:135], v[208:211]
    v_mfma_f32_16x16x32_bf16 v[212:215], a[96:99], a[136:139], v[212:215]
    v_mfma_f32_16x16x32_bf16 v[212:215], a[92:95], a[120:123], v[212:215]
    buffer_load_dwordx4 v96, s[20:23], s78 offen offset:0 lds
    v_mfma_f32_16x16x32_bf16 v[216:219], a[92:95], a[124:127], v[216:219]
    s_waitcnt lgkmcnt(0)
    v_mfma_f32_16x16x32_bf16 v[216:219], a[96:99], a[140:143], v[216:219]
    v_mfma_f32_16x16x32_bf16 v[224:227], a[100:103], a[116:119], v[224:227]
    v_mfma_f32_16x16x32_bf16 v[224:227], a[104:107], a[132:135], v[224:227]
    buffer_load_dwordx4 v97, s[20:23], s78 offen offset:1024 lds
    v_mfma_f32_16x16x32_bf16 v[228:231], a[104:107], a[136:139], v[228:231]
    s_waitcnt vmcnt(10) lgkmcnt(0)
    s_barrier
    ds_read_b128 a[236:239], v109 offset:0
    v_mfma_f32_16x16x32_bf16 v[228:231], a[100:103], a[120:123], v[228:231]
    ds_read_b64_tr_b16 a[84:85], v112 offset:16384
    ds_read_b64_tr_b16 a[86:87], v112 offset:16896
    v_mfma_f32_16x16x32_bf16 v[232:235], a[100:103], a[124:127], v[232:235]
    ds_read_b128 a[252:255], v110 offset:0
    ds_read_b64_tr_b16 a[88:89], v112 offset:18432
    v_mfma_f32_16x16x32_bf16 v[232:235], a[104:107], a[140:143], v[232:235]
    buffer_load_dwordx4 v98, s[20:23], s78 offen offset:2048 lds
    v_mfma_f32_16x16x32_bf16 v[240:243], a[108:111], a[116:119], v[240:243]
    ds_read_b64_tr_b16 a[90:91], v112 offset:18944
    ds_read_b128 a[240:243], v108 offset:0
    v_mfma_f32_16x16x32_bf16 v[240:243], a[112:115], a[132:135], v[240:243]
    ds_read_b128 a[224:227], v107 offset:0
    ds_read_b128 a[228:231], v107 offset:2048
    v_mfma_f32_16x16x32_bf16 v[244:247], a[112:115], a[136:139], v[244:247]
    ds_read_b128 a[244:247], v108 offset:2048
    ds_read_b128 a[248:251], v108 offset:4096
    v_mfma_f32_16x16x32_bf16 v[244:247], a[108:111], a[120:123], v[244:247]
    buffer_load_dwordx4 v99, s[20:23], s78 offen offset:3072 lds
    v_mfma_f32_16x16x32_bf16 v[248:251], a[108:111], a[124:127], v[248:251]
    s_add_u32 m0, s45, 57344
    ds_read_b128 a[232:235], v107 offset:4096
    ds_read_b64_tr_b16 a[92:93], v112 offset:16392
    v_mfma_f32_16x16x32_bf16 v[248:251], a[112:115], a[140:143], v[248:251]
    s_waitcnt lgkmcnt(10)
    ds_read_b64_tr_b16 a[94:95], v112 offset:16904
    ds_read_b64_tr_b16 a[96:97], v112 offset:18440
    v_mfma_f32_16x16x32_bf16 v[140:143], a[84:87], a[236:239], v[140:143]
    ds_read_b64_tr_b16 a[98:99], v112 offset:18952
    ds_read_b64_tr_b16 a[100:101], v113 offset:16384
    buffer_load_dwordx4 v100, s[8:11], s70 offen offset:0 lds
    ds_read_b64_tr_b16 a[102:103], v113 offset:16896
    ds_read_b64_tr_b16 a[104:105], v113 offset:18432
    ds_read_b64_tr_b16 a[106:107], v113 offset:18944
    s_waitcnt lgkmcnt(14)
    v_mfma_f32_16x16x32_bf16 v[140:143], a[88:91], a[252:255], v[140:143]
    s_waitcnt lgkmcnt(13)
    ds_read_b64_tr_b16 a[108:109], v113 offset:16392
    ds_read_b64_tr_b16 a[110:111], v113 offset:16904
    v_mfma_f32_16x16x32_bf16 v[128:131], a[88:91], a[240:243], v[128:131]
    s_waitcnt lgkmcnt(13)
    ds_read_b64_tr_b16 a[112:113], v113 offset:18440
    ds_read_b64_tr_b16 a[114:115], v113 offset:18952
    v_mfma_f32_16x16x32_bf16 v[128:131], a[84:87], a[224:227], v[128:131]
    s_waitcnt lgkmcnt(13)
    buffer_load_dwordx4 v101, s[8:11], s70 offen offset:1024 lds
    v_mfma_f32_16x16x32_bf16 v[132:135], a[84:87], a[228:231], v[132:135]
    v_mfma_f32_16x16x32_bf16 v[132:135], a[88:91], a[244:247], v[132:135]
    s_waitcnt lgkmcnt(11)
    v_mfma_f32_16x16x32_bf16 v[136:139], a[88:91], a[248:251], v[136:139]
    s_waitcnt lgkmcnt(9)
    ds_read_b64_tr_b16 a[88:89], v114 offset:18432
    ds_read_b64_tr_b16 a[90:91], v114 offset:18944
    v_mfma_f32_16x16x32_bf16 v[136:139], a[84:87], a[232:235], v[136:139]
    s_waitcnt lgkmcnt(9)
    buffer_load_dwordx4 v102, s[8:11], s70 offen offset:2048 lds
    v_mfma_f32_16x16x32_bf16 v[156:159], a[92:95], a[236:239], v[156:159]
    ds_read_b64_tr_b16 a[84:85], v114 offset:16384
    ds_read_b64_tr_b16 a[86:87], v114 offset:16896
    v_mfma_f32_16x16x32_bf16 v[156:159], a[96:99], a[252:255], v[156:159]
    v_mfma_f32_16x16x32_bf16 v[144:147], a[96:99], a[240:243], v[144:147]
    v_mfma_f32_16x16x32_bf16 v[144:147], a[92:95], a[224:227], v[144:147]
    buffer_load_dwordx4 v103, s[8:11], s70 offen offset:3072 lds
    v_mfma_f32_16x16x32_bf16 v[148:151], a[92:95], a[228:231], v[148:151]
    s_add_u32 m0, s45, 61440
    v_mfma_f32_16x16x32_bf16 v[148:151], a[96:99], a[244:247], v[148:151]
    v_mfma_f32_16x16x32_bf16 v[152:155], a[96:99], a[248:251], v[152:155]
    s_waitcnt lgkmcnt(4)
    ds_read_b64_tr_b16 a[96:97], v114 offset:18440
    ds_read_b64_tr_b16 a[98:99], v114 offset:18952
    v_mfma_f32_16x16x32_bf16 v[152:155], a[92:95], a[232:235], v[152:155]
    buffer_load_dwordx4 v104, s[8:11], s70 offen offset:0 lds
    v_mfma_f32_16x16x32_bf16 v[172:175], a[100:103], a[236:239], v[172:175]
    ds_read_b64_tr_b16 a[92:93], v114 offset:16392
    ds_read_b64_tr_b16 a[94:95], v114 offset:16904
    v_mfma_f32_16x16x32_bf16 v[172:175], a[104:107], a[252:255], v[172:175]
    v_mfma_f32_16x16x32_bf16 v[160:163], a[104:107], a[240:243], v[160:163]
    v_mfma_f32_16x16x32_bf16 v[160:163], a[100:103], a[224:227], v[160:163]
    buffer_load_dwordx4 v105, s[8:11], s70 offen offset:1024 lds
    v_mfma_f32_16x16x32_bf16 v[164:167], a[100:103], a[228:231], v[164:167]
    v_mfma_f32_16x16x32_bf16 v[164:167], a[104:107], a[244:247], v[164:167]
    v_mfma_f32_16x16x32_bf16 v[168:171], a[104:107], a[248:251], v[168:171]
    ds_read_b64_tr_b16 a[104:105], v115 offset:18432
    ds_read_b64_tr_b16 a[106:107], v115 offset:18944
    v_mfma_f32_16x16x32_bf16 v[168:171], a[100:103], a[232:235], v[168:171]
    buffer_load_dwordx4 v106, s[8:11], s70 offen offset:2048 lds
    v_mfma_f32_16x16x32_bf16 v[188:191], a[108:111], a[236:239], v[188:191]
    s_add_u32 m0, s44, 147456
    ds_read_b64_tr_b16 a[100:101], v115 offset:16384
    ds_read_b64_tr_b16 a[102:103], v115 offset:16896
    v_mfma_f32_16x16x32_bf16 v[188:191], a[112:115], a[252:255], v[188:191]
    v_mfma_f32_16x16x32_bf16 v[176:179], a[112:115], a[240:243], v[176:179]
    v_mfma_f32_16x16x32_bf16 v[176:179], a[108:111], a[224:227], v[176:179]
    buffer_load_dwordx4 v96, s[20:23], s79 offen offset:0 lds
    v_mfma_f32_16x16x32_bf16 v[180:183], a[108:111], a[228:231], v[180:183]
    v_mfma_f32_16x16x32_bf16 v[180:183], a[112:115], a[244:247], v[180:183]
    v_mfma_f32_16x16x32_bf16 v[184:187], a[112:115], a[248:251], v[184:187]
    s_waitcnt lgkmcnt(4)
    ds_read_b64_tr_b16 a[112:113], v115 offset:18440
    ds_read_b64_tr_b16 a[114:115], v115 offset:18952
    v_mfma_f32_16x16x32_bf16 v[184:187], a[108:111], a[232:235], v[184:187]
    buffer_load_dwordx4 v97, s[20:23], s79 offen offset:1024 lds
    v_mfma_f32_16x16x32_bf16 v[192:195], a[84:87], a[224:227], v[192:195]
    ds_read_b64_tr_b16 a[108:109], v115 offset:16392
    ds_read_b64_tr_b16 a[110:111], v115 offset:16904
    v_mfma_f32_16x16x32_bf16 v[192:195], a[88:91], a[240:243], v[192:195]
    v_mfma_f32_16x16x32_bf16 v[196:199], a[88:91], a[244:247], v[196:199]
    v_mfma_f32_16x16x32_bf16 v[196:199], a[84:87], a[228:231], v[196:199]
    buffer_load_dwordx4 v98, s[20:23], s79 offen offset:2048 lds
    v_mfma_f32_16x16x32_bf16 v[200:203], a[84:87], a[232:235], v[200:203]
    v_mfma_f32_16x16x32_bf16 v[200:203], a[88:91], a[248:251], v[200:203]
    v_mfma_f32_16x16x32_bf16 v[208:211], a[92:95], a[224:227], v[208:211]
    v_mfma_f32_16x16x32_bf16 v[208:211], a[96:99], a[240:243], v[208:211]
    buffer_load_dwordx4 v99, s[20:23], s79 offen offset:3072 lds
    v_mfma_f32_16x16x32_bf16 v[212:215], a[96:99], a[244:247], v[212:215]
    s_add_u32 m0, s45, 86016
    v_mfma_f32_16x16x32_bf16 v[212:215], a[92:95], a[228:231], v[212:215]
    v_mfma_f32_16x16x32_bf16 v[216:219], a[92:95], a[232:235], v[216:219]
    s_waitcnt lgkmcnt(0)
    v_mfma_f32_16x16x32_bf16 v[216:219], a[96:99], a[248:251], v[216:219]
    buffer_load_dwordx4 v100, s[8:11], s71 offen offset:0 lds
    v_mfma_f32_16x16x32_bf16 v[224:227], a[100:103], a[224:227], v[224:227]
    v_mfma_f32_16x16x32_bf16 v[224:227], a[104:107], a[240:243], v[224:227]
    v_mfma_f32_16x16x32_bf16 v[228:231], a[104:107], a[244:247], v[228:231]
    v_mfma_f32_16x16x32_bf16 v[228:231], a[100:103], a[228:231], v[228:231]
    buffer_load_dwordx4 v101, s[8:11], s71 offen offset:1024 lds
    v_mfma_f32_16x16x32_bf16 v[232:235], a[100:103], a[232:235], v[232:235]
    v_mfma_f32_16x16x32_bf16 v[232:235], a[104:107], a[248:251], v[232:235]
    v_mfma_f32_16x16x32_bf16 v[240:243], a[108:111], a[224:227], v[240:243]
    v_mfma_f32_16x16x32_bf16 v[240:243], a[112:115], a[240:243], v[240:243]
    buffer_load_dwordx4 v102, s[8:11], s71 offen offset:2048 lds
    v_mfma_f32_16x16x32_bf16 v[244:247], a[112:115], a[244:247], v[244:247]
    s_waitcnt vmcnt(7) lgkmcnt(0)
    s_barrier
    ds_read_b128 a[128:131], v109 offset:28672
    v_mfma_f32_16x16x32_bf16 v[244:247], a[108:111], a[228:231], v[244:247]
    ds_read_b64_tr_b16 a[84:85], v112 offset:32768
    ds_read_b64_tr_b16 a[86:87], v112 offset:33280
    v_mfma_f32_16x16x32_bf16 v[248:251], a[108:111], a[232:235], v[248:251]
    ds_read_b128 a[144:147], v110 offset:28672
    ds_read_b64_tr_b16 a[88:89], v112 offset:34816
    v_mfma_f32_16x16x32_bf16 v[248:251], a[112:115], a[248:251], v[248:251]
    ds_read_b64_tr_b16 a[90:91], v112 offset:35328
    ds_read_b128 a[132:135], v108 offset:28672
    ds_read_b128 a[116:119], v107 offset:28672
    ds_read_b128 a[120:123], v107 offset:30720
    ds_read_b128 a[136:139], v108 offset:30720
    ds_read_b128 a[140:143], v108 offset:32768
    ds_read_b128 a[124:127], v107 offset:32768
    ds_read_b64_tr_b16 a[92:93], v112 offset:32776
    ds_read_b64_tr_b16 a[94:95], v112 offset:33288
    ds_read_b64_tr_b16 a[96:97], v112 offset:34824
    ds_read_b64_tr_b16 a[98:99], v112 offset:35336
    buffer_load_dwordx4 v103, s[8:11], s71 offen offset:3072 lds
    ds_read_b64_tr_b16 a[100:101], v113 offset:32768
    ds_read_b64_tr_b16 a[102:103], v113 offset:33280
    ds_read_b64_tr_b16 a[104:105], v113 offset:34816
    ds_read_b64_tr_b16 a[106:107], v113 offset:35328
    ds_read_b64_tr_b16 a[108:109], v113 offset:32776
    ds_read_b64_tr_b16 a[110:111], v113 offset:33288
    ds_read_b64_tr_b16 a[112:113], v113 offset:34824
    ds_read_b64_tr_b16 a[114:115], v113 offset:35336
    s_add_u32 m0, s45, 90112
    s_lshr_b32 s47, s2, 7
    s_lshl_b32 s47, s47, 1
    s_waitcnt lgkmcnt(15)
    v_mfma_f32_16x16x32_bf16 v[140:143], a[84:87], a[128:131], v[140:143]
    s_xor_b32 s48, s60, 1
    buffer_load_dwordx4 v104, s[8:11], s71 offen offset:0 lds
    s_lshr_b32 s46, s2, 7
    s_xor_b32 s46, s46, 1
    s_and_b32 s46, s46, 3
    v_mfma_f32_16x16x32_bf16 v[140:143], a[88:91], a[144:147], v[140:143]
    s_lshl_b32 s72, s46, 17
    s_mul_i32 s4, s48, 458752
    s_mul_i32 s46, s46, 14336
    v_mfma_f32_16x16x32_bf16 v[128:131], a[88:91], a[132:135], v[128:131]
    s_add_u32 s64, s46, s4
    s_add_u32 s68, s46, s5
    s_lshr_b32 s46, s2, 7
    v_mfma_f32_16x16x32_bf16 v[128:131], a[84:87], a[116:119], v[128:131]
    s_waitcnt lgkmcnt(9)
    buffer_load_dwordx4 v105, s[8:11], s71 offen offset:1024 lds
    v_mfma_f32_16x16x32_bf16 v[132:135], a[84:87], a[120:123], v[132:135]
    s_xor_b32 s46, s46, 3
    s_and_b32 s46, s46, 3
    s_lshl_b32 s73, s46, 17
    v_mfma_f32_16x16x32_bf16 v[132:135], a[88:91], a[136:139], v[132:135]
    s_mul_i32 s46, s46, 14336
    s_add_u32 s65, s46, s4
    s_add_u32 s69, s46, s5
    v_mfma_f32_16x16x32_bf16 v[136:139], a[88:91], a[140:143], v[136:139]
    s_lshr_b32 s46, s2, 7
    ds_read_b64_tr_b16 a[88:89], v114 offset:34816
    ds_read_b64_tr_b16 a[90:91], v114 offset:35328
    v_mfma_f32_16x16x32_bf16 v[136:139], a[84:87], a[124:127], v[136:139]
    s_waitcnt lgkmcnt(2)
    buffer_load_dwordx4 v106, s[8:11], s71 offen offset:2048 lds
    v_mfma_f32_16x16x32_bf16 v[156:159], a[92:95], a[128:131], v[156:159]
    s_xor_b32 s46, s46, 0
    ds_read_b64_tr_b16 a[84:85], v114 offset:32768
    ds_read_b64_tr_b16 a[86:87], v114 offset:33280
    v_mfma_f32_16x16x32_bf16 v[156:159], a[96:99], a[144:147], v[156:159]
    s_and_b32 s46, s46, 3
    s_lshl_b32 s74, s46, 17
    s_mul_i32 s46, s46, 14336
    v_mfma_f32_16x16x32_bf16 v[144:147], a[96:99], a[132:135], v[144:147]
    s_add_u32 s66, s46, s4
    s_add_u32 s70, s46, s5
    s_lshr_b32 s46, s2, 7
    v_mfma_f32_16x16x32_bf16 v[144:147], a[92:95], a[116:119], v[144:147]
    s_xor_b32 s46, s46, 2
    s_and_b32 s46, s46, 3
    s_lshl_b32 s75, s46, 17
    v_mfma_f32_16x16x32_bf16 v[148:151], a[92:95], a[120:123], v[148:151]
    s_mul_i32 s46, s46, 14336
    s_add_u32 s67, s46, s4
    s_add_u32 s71, s46, s5
    v_mfma_f32_16x16x32_bf16 v[148:151], a[96:99], a[136:139], v[148:151]
    s_add_u32 m0, s44, 16384
    v_mfma_f32_16x16x32_bf16 v[152:155], a[96:99], a[140:143], v[152:155]
    buffer_load_dwordx4 v14, s[12:15], s85 offen offset:0 nt lds
    v_mfma_f32_16x16x32_bf16 v[152:155], a[92:95], a[124:127], v[152:155]
    ds_read_b64_tr_b16 a[92:93], v114 offset:32776
    ds_read_b64_tr_b16 a[94:95], v114 offset:33288
    v_mfma_f32_16x16x32_bf16 v[172:175], a[100:103], a[128:131], v[172:175]
    ds_read_b64_tr_b16 a[96:97], v114 offset:34824
    ds_read_b64_tr_b16 a[98:99], v114 offset:35336
    v_mfma_f32_16x16x32_bf16 v[172:175], a[104:107], a[144:147], v[172:175]
    v_mfma_f32_16x16x32_bf16 v[160:163], a[104:107], a[132:135], v[160:163]
    buffer_load_dwordx4 v15, s[12:15], s85 offen offset:1024 nt lds
    v_mfma_f32_16x16x32_bf16 v[160:163], a[100:103], a[116:119], v[160:163]
    v_mfma_f32_16x16x32_bf16 v[164:167], a[100:103], a[120:123], v[164:167]
    v_mfma_f32_16x16x32_bf16 v[164:167], a[104:107], a[136:139], v[164:167]
    v_mfma_f32_16x16x32_bf16 v[168:171], a[104:107], a[140:143], v[168:171]
    buffer_load_dwordx4 v16, s[12:15], s85 offen offset:2048 nt lds
    v_mfma_f32_16x16x32_bf16 v[168:171], a[100:103], a[124:127], v[168:171]
    ds_read_b64_tr_b16 a[100:101], v115 offset:32768
    ds_read_b64_tr_b16 a[102:103], v115 offset:33280
    v_mfma_f32_16x16x32_bf16 v[188:191], a[108:111], a[128:131], v[188:191]
    ds_read_b64_tr_b16 a[104:105], v115 offset:34816
    ds_read_b64_tr_b16 a[106:107], v115 offset:35328
    v_mfma_f32_16x16x32_bf16 v[188:191], a[112:115], a[144:147], v[188:191]
    v_mfma_f32_16x16x32_bf16 v[176:179], a[112:115], a[132:135], v[176:179]
    buffer_load_dwordx4 v17, s[12:15], s85 offen offset:3072 nt lds
    v_mfma_f32_16x16x32_bf16 v[176:179], a[108:111], a[116:119], v[176:179]
    v_mfma_f32_16x16x32_bf16 v[180:183], a[108:111], a[120:123], v[180:183]
    v_mfma_f32_16x16x32_bf16 v[180:183], a[112:115], a[136:139], v[180:183]
    v_mfma_f32_16x16x32_bf16 v[184:187], a[112:115], a[140:143], v[184:187]
    s_waitcnt lgkmcnt(4)
    ds_read_b64_tr_b16 a[112:113], v115 offset:34824
    ds_read_b64_tr_b16 a[114:115], v115 offset:35336
    v_mfma_f32_16x16x32_bf16 v[184:187], a[108:111], a[124:127], v[184:187]
    ds_read_b64_tr_b16 a[108:109], v115 offset:32776
    ds_read_b64_tr_b16 a[110:111], v115 offset:33288
    v_mfma_f32_16x16x32_bf16 v[192:195], a[84:87], a[116:119], v[192:195]
    v_mfma_f32_16x16x32_bf16 v[192:195], a[88:91], a[132:135], v[192:195]
    v_mfma_f32_16x16x32_bf16 v[196:199], a[88:91], a[136:139], v[196:199]
    v_mfma_f32_16x16x32_bf16 v[196:199], a[84:87], a[120:123], v[196:199]
    v_mfma_f32_16x16x32_bf16 v[200:203], a[84:87], a[124:127], v[200:203]
    v_mfma_f32_16x16x32_bf16 v[200:203], a[88:91], a[140:143], v[200:203]
    v_mfma_f32_16x16x32_bf16 v[208:211], a[92:95], a[116:119], v[208:211]
    v_mfma_f32_16x16x32_bf16 v[208:211], a[96:99], a[132:135], v[208:211]
    v_mfma_f32_16x16x32_bf16 v[212:215], a[96:99], a[136:139], v[212:215]
    v_mfma_f32_16x16x32_bf16 v[212:215], a[92:95], a[120:123], v[212:215]
    s_waitcnt vmcnt(4) lgkmcnt(0)
    s_barrier
L_common:
L_s0:
    s_cbranch_execz L_s4
    v_mfma_f32_16x16x32_bf16 v[216:219], a[92:95], a[124:127], v[216:219]
    s_add_u32 m0, s44, 131072
    ds_read_b128 a[236:239], v109 offset:57344
    ds_read_b64_tr_b16 a[84:85], v112 offset:49152
    v_mfma_f32_16x16x32_bf16 v[216:219], a[96:99], a[140:143], v[216:219]
    s_lshl_b32 s63, s2, 14
    ds_read_b64_tr_b16 a[86:87], v112 offset:49664
    ds_read_b128 a[252:255], v110 offset:57344
    v_mfma_f32_16x16x32_bf16 v[224:227], a[100:103], a[116:119], v[224:227]
    ds_read_b64_tr_b16 a[88:89], v112 offset:51200
    ds_read_b64_tr_b16 a[90:91], v112 offset:51712
    v_mfma_f32_16x16x32_bf16 v[224:227], a[104:107], a[132:135], v[224:227]
    ds_read_b128 a[240:243], v108 offset:57344
    ds_read_b128 a[224:227], v107 offset:57344
    v_mfma_f32_16x16x32_bf16 v[228:231], a[104:107], a[136:139], v[228:231]
    ds_read_b128 a[228:231], v107 offset:59392
    ds_read_b128 a[244:247], v108 offset:59392
    v_mfma_f32_16x16x32_bf16 v[228:231], a[100:103], a[120:123], v[228:231]
    ds_read_b128 a[248:251], v108 offset:61440
    ds_read_b128 a[232:235], v107 offset:61440
    v_mfma_f32_16x16x32_bf16 v[232:235], a[100:103], a[124:127], v[232:235]
    buffer_load_dwordx4 v18, s[16:19], s85 offen offset:0 nt lds
    v_mfma_f32_16x16x32_bf16 v[232:235], a[104:107], a[140:143], v[232:235]
    ds_read_b64_tr_b16 a[92:93], v112 offset:49160
    ds_read_b64_tr_b16 a[94:95], v112 offset:49672
    v_mfma_f32_16x16x32_bf16 v[240:243], a[108:111], a[116:119], v[240:243]
    ds_read_b64_tr_b16 a[96:97], v112 offset:51208
    ds_read_b64_tr_b16 a[98:99], v112 offset:51720
    v_mfma_f32_16x16x32_bf16 v[240:243], a[112:115], a[132:135], v[240:243]
    ds_read_b64_tr_b16 a[100:101], v113 offset:49152
    ds_read_b64_tr_b16 a[102:103], v113 offset:49664
    v_mfma_f32_16x16x32_bf16 v[244:247], a[112:115], a[136:139], v[244:247]
    ds_read_b64_tr_b16 a[104:105], v113 offset:51200
    ds_read_b64_tr_b16 a[106:107], v113 offset:51712
    v_mfma_f32_16x16x32_bf16 v[244:247], a[108:111], a[120:123], v[244:247]
    v_lshrrev_b32 v31, 1, v0
    v_lshlrev_b32 v31, 7, v31
    v_mfma_f32_16x16x32_bf16 v[248:251], a[108:111], a[124:127], v[248:251]
    s_waitcnt lgkmcnt(12)
    ds_read_b64_tr_b16 a[108:109], v113 offset:49160
    ds_read_b64_tr_b16 a[110:111], v113 offset:49672
    v_mfma_f32_16x16x32_bf16 v[248:251], a[112:115], a[140:143], v[248:251]
    ds_read_b64_tr_b16 a[112:113], v113 offset:51208
    ds_read_b64_tr_b16 a[114:115], v113 offset:51720
    v_mfma_f32_16x16x32_bf16 v[140:143], a[84:87], a[236:239], v[140:143]
    v_mov_b32 v56, 0
    v_mov_b32 v57, 0
    v_mfma_f32_16x16x32_bf16 v[140:143], a[88:91], a[252:255], v[140:143]
    v_mov_b32 v58, 0
    v_mov_b32 v59, 0
    v_mfma_f32_16x16x32_bf16 v[128:131], a[88:91], a[240:243], v[128:131]
    s_waitcnt lgkmcnt(10)
    buffer_load_dwordx4 v19, s[16:19], s85 offen offset:1024 nt lds
    v_mfma_f32_16x16x32_bf16 v[128:131], a[84:87], a[224:227], v[128:131]
    v_mfma_f32_16x16x32_bf16 v[132:135], a[84:87], a[228:231], v[132:135]
    v_mfma_f32_16x16x32_bf16 v[132:135], a[88:91], a[244:247], v[132:135]
    v_mul_f32 v140, s49, v140
    v_mul_f32 v141, s49, v141
    v_mfma_f32_16x16x32_bf16 v[136:139], a[88:91], a[248:251], v[136:139]
    ds_read_b64_tr_b16 a[88:89], v114 offset:51200
    ds_read_b64_tr_b16 a[90:91], v114 offset:51712
    v_mfma_f32_16x16x32_bf16 v[136:139], a[84:87], a[232:235], v[136:139]
    s_waitcnt lgkmcnt(4)
    ds_read_b64_tr_b16 a[84:85], v114 offset:49152
    ds_read_b64_tr_b16 a[86:87], v114 offset:49664
    v_mfma_f32_16x16x32_bf16 v[156:159], a[92:95], a[236:239], v[156:159]
    v_mul_f32 v142, s49, v142
    v_mul_f32 v143, s49, v143
    v_mfma_f32_16x16x32_bf16 v[156:159], a[96:99], a[252:255], v[156:159]
    v_cvt_pk_bf16_f32 v140, v140, v141
    v_cvt_pk_bf16_f32 v141, v142, v143
    v_mfma_f32_16x16x32_bf16 v[144:147], a[96:99], a[240:243], v[144:147]
    v_mul_f32 v128, s49, v128
    v_mul_f32 v129, s49, v129
    v_mfma_f32_16x16x32_bf16 v[144:147], a[92:95], a[224:227], v[144:147]
    v_mul_f32 v130, s49, v130
    v_mul_f32 v131, s49, v131
    v_mfma_f32_16x16x32_bf16 v[148:151], a[92:95], a[228:231], v[148:151]
    buffer_load_dwordx4 v20, s[16:19], s85 offen offset:2048 nt lds
    v_mfma_f32_16x16x32_bf16 v[148:151], a[96:99], a[244:247], v[148:151]
    v_mul_f32 v156, s49, v156
    v_mul_f32 v157, s49, v157
    v_mfma_f32_16x16x32_bf16 v[152:155], a[96:99], a[248:251], v[152:155]
    ds_read_b64_tr_b16 a[96:97], v114 offset:51208
    ds_read_b64_tr_b16 a[98:99], v114 offset:51720
    v_mfma_f32_16x16x32_bf16 v[152:155], a[92:95], a[232:235], v[152:155]
    ds_read_b64_tr_b16 a[92:93], v114 offset:49160
    ds_read_b64_tr_b16 a[94:95], v114 offset:49672
    v_mfma_f32_16x16x32_bf16 v[172:175], a[100:103], a[236:239], v[172:175]
    v_mul_f32 v158, s49, v158
    v_mul_f32 v159, s49, v159
    v_mfma_f32_16x16x32_bf16 v[172:175], a[104:107], a[252:255], v[172:175]
    v_cvt_pk_bf16_f32 v142, v156, v157
    v_cvt_pk_bf16_f32 v143, v158, v159
    v_mfma_f32_16x16x32_bf16 v[160:163], a[104:107], a[240:243], v[160:163]
    ds_write_b128 v22, v[140:143] offset:0
    v_mfma_f32_16x16x32_bf16 v[160:163], a[100:103], a[224:227], v[160:163]
    v_cvt_pk_bf16_f32 v128, v128, v129
    v_cvt_pk_bf16_f32 v129, v130, v131
    v_mfma_f32_16x16x32_bf16 v[164:167], a[100:103], a[228:231], v[164:167]
    v_mul_f32 v172, s49, v172
    v_mul_f32 v173, s49, v173
    v_mfma_f32_16x16x32_bf16 v[164:167], a[104:107], a[244:247], v[164:167]
    buffer_load_dwordx4 v21, s[16:19], s85 offen offset:3072 nt lds
    v_mfma_f32_16x16x32_bf16 v[168:171], a[104:107], a[248:251], v[168:171]
    buffer_load_dword v33, v31, s[24:27], s63 offen
    v_mfma_f32_16x16x32_bf16 v[168:171], a[100:103], a[232:235], v[168:171]
    s_waitcnt lgkmcnt(1)
    v_mul_f32 v174, s49, v174
    v_mul_f32 v175, s49, v175
    v_mfma_f32_16x16x32_bf16 v[188:191], a[108:111], a[236:239], v[188:191]
    v_cvt_pk_bf16_f32 v172, v172, v173
    v_cvt_pk_bf16_f32 v173, v174, v175
    v_mfma_f32_16x16x32_bf16 v[188:191], a[112:115], a[252:255], v[188:191]
    ds_read_b64_tr_b16 a[100:101], v115 offset:49152
    ds_read_b64_tr_b16 a[102:103], v115 offset:49664
    v_mfma_f32_16x16x32_bf16 v[176:179], a[112:115], a[240:243], v[176:179]
    ds_read_b64_tr_b16 a[104:105], v115 offset:51200
    ds_read_b64_tr_b16 a[106:107], v115 offset:51712
    v_mfma_f32_16x16x32_bf16 v[176:179], a[108:111], a[224:227], v[176:179]
    v_mul_f32 v144, s49, v144
    v_mul_f32 v145, s49, v145
    v_mfma_f32_16x16x32_bf16 v[180:183], a[108:111], a[228:231], v[180:183]
    v_mul_f32 v188, s49, v188
    v_mul_f32 v189, s49, v189
    v_mfma_f32_16x16x32_bf16 v[180:183], a[112:115], a[244:247], v[180:183]
    v_mul_f32 v190, s49, v190
    v_mul_f32 v191, s49, v191
    v_mfma_f32_16x16x32_bf16 v[184:187], a[112:115], a[248:251], v[184:187]
    v_cvt_pk_bf16_f32 v174, v188, v189
    v_cvt_pk_bf16_f32 v175, v190, v191
    v_mfma_f32_16x16x32_bf16 v[184:187], a[108:111], a[232:235], v[184:187]
    ds_read_b64_tr_b16 a[108:109], v115 offset:49160
    ds_read_b64_tr_b16 a[110:111], v115 offset:49672
    v_mfma_f32_16x16x32_bf16 v[192:195], a[84:87], a[224:227], v[192:195]
    ds_read_b64_tr_b16 a[112:113], v115 offset:51208
    ds_read_b64_tr_b16 a[114:115], v115 offset:51720
    v_mfma_f32_16x16x32_bf16 v[192:195], a[88:91], a[240:243], v[192:195]
    ds_write_b128 v22, v[172:175] offset:1024
    v_mfma_f32_16x16x32_bf16 v[196:199], a[88:91], a[244:247], v[196:199]
    v_mul_f32 v146, s49, v146
    v_mul_f32 v147, s49, v147
    v_mfma_f32_16x16x32_bf16 v[196:199], a[84:87], a[228:231], v[196:199]
    v_cvt_pk_bf16_f32 v130, v144, v145
    v_cvt_pk_bf16_f32 v131, v146, v147
    v_mfma_f32_16x16x32_bf16 v[200:203], a[84:87], a[232:235], v[200:203]
    v_mul_f32 v132, s49, v132
    v_mul_f32 v133, s49, v133
    v_mfma_f32_16x16x32_bf16 v[200:203], a[88:91], a[248:251], v[200:203]
    s_waitcnt vmcnt(9) lgkmcnt(0)
    s_barrier
    s_add_u32 m0, s44, 32768
    v_mfma_f32_16x16x32_bf16 v[208:211], a[92:95], a[224:227], v[208:211]
    buffer_load_dwordx4 v14, s[12:15], s86 offen offset:0 nt lds
    v_mfma_f32_16x16x32_bf16 v[208:211], a[96:99], a[240:243], v[208:211]
    ds_read_b128 a[84:87], v2 offset:0
    ds_read_b128 a[88:91], v3 offset:0
    v_mfma_f32_16x16x32_bf16 v[212:215], a[96:99], a[244:247], v[212:215]
    v_mul_f32 v134, s49, v134
    v_mul_f32 v135, s49, v135
    v_mfma_f32_16x16x32_bf16 v[212:215], a[92:95], a[228:231], v[212:215]
    v_cvt_pk_bf16_f32 v132, v132, v133
    v_cvt_pk_bf16_f32 v133, v134, v135
    v_mfma_f32_16x16x32_bf16 v[216:219], a[92:95], a[232:235], v[216:219]
    ds_read_b128 a[92:95], v48 offset:0
    ds_read_b128 a[60:63], v23 offset:1024
    v_mfma_f32_16x16x32_bf16 v[216:219], a[96:99], a[248:251], v[216:219]
    v_mul_f32 v148, s49, v148
    v_mul_f32 v149, s49, v149
    v_mfma_f32_16x16x32_bf16 v[224:227], a[100:103], a[224:227], v[224:227]
    v_mul_f32 v150, s49, v150
    v_mul_f32 v151, s49, v151
    v_mfma_f32_16x16x32_bf16 v[224:227], a[104:107], a[240:243], v[224:227]
    v_cvt_pk_bf16_f32 v134, v148, v149
    v_cvt_pk_bf16_f32 v135, v150, v151
    v_mfma_f32_16x16x32_bf16 v[228:231], a[104:107], a[244:247], v[228:231]
L_s1:
    s_cbranch_execz L_s5
    v_mul_f32 v136, s49, v136
    v_mul_f32 v137, s49, v137
    v_mfma_f32_16x16x32_bf16 v[228:231], a[100:103], a[228:231], v[228:231]
    v_mul_f32 v138, s49, v138
    v_mul_f32 v139, s49, v139
    v_mfma_f32_16x16x32_bf16 v[232:235], a[100:103], a[232:235], v[232:235]
    buffer_load_dwordx4 v15, s[12:15], s86 offen offset:1024 nt lds
    v_mfma_f32_16x16x32_bf16 v[232:235], a[104:107], a[248:251], v[232:235]
    v_cvt_pk_bf16_f32 v136, v136, v137
    v_cvt_pk_bf16_f32 v137, v138, v139
    v_mfma_f32_16x16x32_bf16 v[240:243], a[108:111], a[224:227], v[240:243]
    v_mul_f32 v152, s49, v152
    v_mul_f32 v153, s49, v153
    v_mfma_f32_16x16x32_bf16 v[240:243], a[112:115], a[240:243], v[240:243]
    v_mul_f32 v154, s49, v154
    v_mul_f32 v155, s49, v155
    v_mfma_f32_16x16x32_bf16 v[244:247], a[112:115], a[244:247], v[244:247]
    ds_read_b128 a[96:99], v49 offset:0
    v_cvt_pk_bf16_f32 v138, v152, v153
    v_mfma_f32_16x16x32_bf16 v[244:247], a[108:111], a[228:231], v[244:247]
    v_cvt_pk_bf16_f32 v139, v154, v155
    ds_read_b128 a[100:103], v2 offset:512
    v_mfma_f32_16x16x32_bf16 v[248:251], a[108:111], a[232:235], v[248:251]
    s_waitcnt lgkmcnt(2)
    v_mul_f32 v160, s49, v160
    v_mul_f32 v161, s49, v161
    v_mfma_f32_16x16x32_bf16 v[248:251], a[112:115], a[248:251], v[248:251]
    v_mul_f32 v162, s49, v162
    v_mul_f32 v163, s49, v163
    v_mfma_f32_16x16x32_bf16 v[64:67], a[84:87], v[128:131], 0
    v_cvt_pk_bf16_f32 v160, v160, v161
    v_cvt_pk_bf16_f32 v161, v162, v163
    v_mfma_f32_16x16x32_bf16 v[68:71], a[84:87], v[132:135], 0
    v_mul_f32 v176, s49, v176
    v_mul_f32 v177, s49, v177
    v_mfma_f32_16x16x32_bf16 v[72:75], a[84:87], v[136:139], 0
    buffer_load_dwordx4 v16, s[12:15], s86 offen offset:2048 nt lds
    v_mul_f32 v178, s49, v178
    v_mul_f32 v179, s49, v179
    v_cvt_pk_bf16_f32 v162, v176, v177
    v_cvt_pk_bf16_f32 v163, v178, v179
    v_pk_mul_f32 v[164:165], v[164:165], v[30:31] op_sel_hi:[1,0]
    v_pk_mul_f32 v[166:167], v[166:167], v[30:31] op_sel_hi:[1,0]
    v_mfma_f32_16x16x32_bf16 v[64:67], a[88:91], v[160:163], v[64:67]
    v_cvt_pk_bf16_f32 v164, v164, v165
    v_mul_f32 v180, s49, v180
    v_mul_f32 v181, s49, v181
    v_mul_f32 v182, s49, v182
    v_mul_f32 v183, s49, v183
    v_cvt_pk_bf16_f32 v165, v166, v167
    v_cvt_pk_bf16_f32 v166, v180, v181
    v_cvt_pk_bf16_f32 v167, v182, v183
    v_pk_mul_f32 v[168:169], v[168:169], v[30:31] op_sel_hi:[1,0]
    v_pk_mul_f32 v[170:171], v[170:171], v[30:31] op_sel_hi:[1,0]
    v_mfma_f32_16x16x32_bf16 v[68:71], a[88:91], v[164:167], v[68:71]
    v_cvt_pk_bf16_f32 v168, v168, v169
    v_mul_f32 v184, s49, v184
    v_mul_f32 v185, s49, v185
    v_mul_f32 v186, s49, v186
    v_mul_f32 v187, s49, v187
    v_cvt_pk_bf16_f32 v169, v170, v171
    v_cvt_pk_bf16_f32 v170, v184, v185
    v_cvt_pk_bf16_f32 v171, v186, v187
    v_pk_mul_f32 v[192:193], v[192:193], v[30:31] op_sel_hi:[1,0]
    v_pk_mul_f32 v[194:195], v[194:195], v[30:31] op_sel_hi:[1,0]
    v_mfma_f32_16x16x32_bf16 v[72:75], a[88:91], v[168:171], v[72:75]
    v_cvt_pk_bf16_f32 v192, v192, v193
    v_mul_f32 v208, s49, v208
    v_mul_f32 v209, s49, v209
    v_mul_f32 v210, s49, v210
    v_mul_f32 v211, s49, v211
    v_cvt_pk_bf16_f32 v193, v194, v195
    v_cvt_pk_bf16_f32 v194, v208, v209
    v_cvt_pk_bf16_f32 v195, v210, v211
    v_pk_mul_f32 v[196:197], v[196:197], v[30:31] op_sel_hi:[1,0]
    v_pk_mul_f32 v[198:199], v[198:199], v[30:31] op_sel_hi:[1,0]
    v_mfma_f32_16x16x32_bf16 v[64:67], a[92:95], v[192:195], v[64:67]
    v_cvt_pk_bf16_f32 v196, v196, v197
    v_mul_f32 v212, s49, v212
    v_mul_f32 v213, s49, v213
    v_mul_f32 v214, s49, v214
    v_mul_f32 v215, s49, v215
    v_cvt_pk_bf16_f32 v197, v198, v199
    v_cvt_pk_bf16_f32 v198, v212, v213
    v_cvt_pk_bf16_f32 v199, v214, v215
    v_pk_mul_f32 v[200:201], v[200:201], v[30:31] op_sel_hi:[1,0]
    v_pk_mul_f32 v[202:203], v[202:203], v[30:31] op_sel_hi:[1,0]
    v_mfma_f32_16x16x32_bf16 v[68:71], a[92:95], v[196:199], v[68:71]
    s_waitcnt lgkmcnt(0)
    v_cvt_pk_bf16_f32 v200, v200, v201
    v_mul_f32 v216, s49, v216
    v_mul_f32 v217, s49, v217
    v_mul_f32 v218, s49, v218
    v_mul_f32 v219, s49, v219
    v_cvt_pk_bf16_f32 v201, v202, v203
    ds_read_b128 a[104:107], v3 offset:512
    v_cvt_pk_bf16_f32 v202, v216, v217
    v_cvt_pk_bf16_f32 v203, v218, v219
    v_pk_mul_f32 v[224:225], v[224:225], v[30:31] op_sel_hi:[1,0]
    v_pk_mul_f32 v[226:227], v[226:227], v[30:31] op_sel_hi:[1,0]
    v_mfma_f32_16x16x32_bf16 v[72:75], a[92:95], v[200:203], v[72:75]
    v_cvt_pk_bf16_f32 v224, v224, v225
    v_mul_f32 v240, s49, v240
    v_mul_f32 v241, s49, v241
    v_mul_f32 v242, s49, v242
    v_mul_f32 v243, s49, v243
    v_cvt_pk_bf16_f32 v225, v226, v227
    v_cvt_pk_bf16_f32 v226, v240, v241
    v_cvt_pk_bf16_f32 v227, v242, v243
    v_pk_mul_f32 v[228:229], v[228:229], v[30:31] op_sel_hi:[1,0]
    v_pk_mul_f32 v[230:231], v[230:231], v[30:31] op_sel_hi:[1,0]
    v_mfma_f32_16x16x32_bf16 v[64:67], a[96:99], v[224:227], v[64:67]
    v_cvt_pk_bf16_f32 v228, v228, v229
    v_mul_f32 v244, s49, v244
    v_mul_f32 v245, s49, v245
    v_mul_f32 v246, s49, v246
    v_mul_f32 v247, s49, v247
    v_cvt_pk_bf16_f32 v229, v230, v231
    v_cvt_pk_bf16_f32 v230, v244, v245
    v_cvt_pk_bf16_f32 v231, v246, v247
    v_pk_mul_f32 v[232:233], v[232:233], v[30:31] op_sel_hi:[1,0]
    buffer_load_dwordx4 v17, s[12:15], s86 offen offset:3072 nt lds
    v_mfma_f32_16x16x32_bf16 v[68:71], a[96:99], v[228:231], v[68:71]
    s_add_u32 m0, s44, 147456
    v_mul_f32 v234, s49, v234
    v_mul_f32 v235, s49, v235
    v_cvt_pk_bf16_f32 v232, v232, v233
    v_mul_f32 v248, s49, v248
    v_mul_f32 v249, s49, v249
    v_pk_mul_f32 v[250:251], v[250:251], v[30:31] op_sel_hi:[1,0]
    v_cvt_pk_bf16_f32 v233, v234, v235
    ds_read_b128 a[108:111], v48 offset:512
    v_cvt_pk_bf16_f32 v234, v248, v249
    v_cvt_pk_bf16_f32 v235, v250, v251
    ds_read_b128 a[112:115], v49 offset:512
    ds_read_b128 a[84:87], v4 offset:0
    v_mfma_f32_16x16x32_bf16 v[72:75], a[96:99], v[232:235], v[72:75]
    s_lshr_b32 s46, s40, 1
    ds_read_b128 a[88:91], v5 offset:0
    ds_read_b128 a[92:95], v50 offset:0
    v_mfma_f32_16x16x32_bf16 v[80:83], a[100:103], v[128:131], 0
    s_mul_i32 s46, s46, 98304
    ds_read_b128 a[96:99], v51 offset:0
    ds_read_b128 a[56:59], v23 offset:0
    v_mfma_f32_16x16x32_bf16 v[84:87], a[100:103], v[132:135], 0
    s_waitcnt lgkmcnt(7)
    v_exp_f32 v64, v64
    v_mfma_f32_16x16x32_bf16 v[88:91], a[100:103], v[136:139], 0
    s_lshl_b32 s47, s41, 13
    v_exp_f32 v65, v65
    v_mfma_f32_16x16x32_bf16 v[80:83], a[104:107], v[160:163], v[80:83]
    s_add_u32 s46, s46, s47
    v_exp_f32 v66, v66
    v_mfma_f32_16x16x32_bf16 v[84:87], a[104:107], v[164:167], v[84:87]
    s_add_u32 s46, s46, 49152
    buffer_load_dwordx4 v18, s[16:19], s86 offen offset:0 nt lds
    v_mfma_f32_16x16x32_bf16 v[88:91], a[104:107], v[168:171], v[88:91]
    s_waitcnt lgkmcnt(6)
    v_exp_f32 v67, v67
    v_mfma_f32_16x16x32_bf16 v[80:83], a[108:111], v[192:195], v[80:83]
    s_lshl_b32 s47, s41, 7
    v_cvt_pk_bf16_f32 v96, v64, v65
    v_cvt_pk_bf16_f32 v97, v66, v67
    v_mfma_f32_16x16x32_bf16 v[84:87], a[108:111], v[196:199], v[84:87]
    s_waitcnt lgkmcnt(4)
    v_exp_f32 v68, v68
    v_mfma_f32_16x16x32_bf16 v[88:91], a[108:111], v[200:203], v[88:91]
    v_exp_f32 v69, v69
    v_mfma_f32_16x16x32_bf16 v[80:83], a[112:115], v[224:227], v[80:83]
    v_exp_f32 v70, v70
    v_mfma_f32_16x16x32_bf16 v[84:87], a[112:115], v[228:231], v[84:87]
    v_exp_f32 v71, v71
    v_mfma_f32_16x16x32_bf16 v[88:91], a[112:115], v[232:235], v[88:91]
    s_waitcnt lgkmcnt(0)
    v_cvt_pk_bf16_f32 v100, v68, v69
    v_cvt_pk_bf16_f32 v101, v70, v71
    v_mfma_f32_16x16x32_bf16 v[64:67], a[84:87], v[128:131], 0
    ds_read_b128 a[52:55], v22 offset:1024
    ds_read_b128 a[48:51], v22 offset:0
    v_mfma_f32_16x16x32_bf16 v[64:67], a[88:91], v[160:163], v[64:67]
    v_exp_f32 v72, v72
    v_mfma_f32_16x16x32_bf16 v[64:67], a[92:95], v[192:195], v[64:67]
    buffer_load_dwordx4 v19, s[16:19], s86 offen offset:1024 nt lds
    v_mfma_f32_16x16x32_bf16 v[64:67], a[96:99], v[224:227], v[64:67]
    v_exp_f32 v73, v73
    v_mfma_f32_16x16x32_bf16 v[68:71], a[96:99], v[228:231], 0
    v_exp_f32 v74, v74
    v_mfma_f32_16x16x32_bf16 v[68:71], a[92:95], v[196:199], v[68:71]
    v_exp_f32 v75, v75
    v_mfma_f32_16x16x32_bf16 v[68:71], a[88:91], v[164:167], v[68:71]
    v_cvt_pk_bf16_f32 v104, v72, v73
    v_cvt_pk_bf16_f32 v105, v74, v75
    v_mfma_f32_16x16x32_bf16 v[68:71], a[84:87], v[132:135], v[68:71]
    ds_read_b128 a[100:103], v4 offset:512
    ds_read_b128 a[104:107], v5 offset:512
    v_mfma_f32_16x16x32_bf16 v[72:75], a[84:87], v[136:139], 0
    ds_read_b128 a[108:111], v50 offset:512
    ds_read_b128 a[112:115], v51 offset:512
    v_mfma_f32_16x16x32_bf16 v[72:75], a[88:91], v[168:171], v[72:75]
    v_exp_f32 v80, v80
    v_mfma_f32_16x16x32_bf16 v[72:75], a[92:95], v[200:203], v[72:75]
    v_exp_f32 v81, v81
    v_mfma_f32_16x16x32_bf16 v[72:75], a[96:99], v[232:235], v[72:75]
    v_exp_f32 v82, v82
    v_mfma_f32_16x16x32_bf16 v[76:79], a[96:99], a[60:63], 0
    s_waitcnt lgkmcnt(4)
    buffer_load_dwordx4 v20, s[16:19], s86 offen offset:2048 nt lds
    v_mfma_f32_16x16x32_bf16 v[76:79], a[92:95], a[56:59], v[76:79]
    v_exp_f32 v83, v83
    v_mfma_f32_16x16x32_bf16 v[76:79], a[88:91], a[52:55], v[76:79]
    ds_write_b128 v29, a[148:151] offset:16384
    v_mfma_f32_16x16x32_bf16 v[76:79], a[84:87], a[48:51], v[76:79]
    s_waitcnt lgkmcnt(3)
    v_cvt_pk_bf16_f32 v98, v80, v81
    v_cvt_pk_bf16_f32 v99, v82, v83
    v_mfma_f32_16x16x32_bf16 v[80:83], a[100:103], v[128:131], 0
    s_waitcnt lgkmcnt(1)
    ds_write_b128 v29, a[152:155] offset:17408
    v_mfma_f32_16x16x32_bf16 v[80:83], a[104:107], v[160:163], v[80:83]
    ds_write_b128 v29, a[156:159] offset:18432
    v_mfma_f32_16x16x32_bf16 v[80:83], a[108:111], v[192:195], v[80:83]
    v_exp_f32 v84, v84
    v_mfma_f32_16x16x32_bf16 v[80:83], a[112:115], v[224:227], v[80:83]
    v_exp_f32 v85, v85
    v_exp_f32 v86, v86
    v_exp_f32 v87, v87
    ds_write_b128 v29, a[160:163] offset:19456
    v_cvt_pk_bf16_f32 v102, v84, v85
    v_cvt_pk_bf16_f32 v103, v86, v87
    v_mfma_f32_16x16x32_bf16 v[84:87], a[112:115], v[228:231], 0
    buffer_load_dwordx4 v21, s[16:19], s86 offen offset:3072 nt lds
    v_mfma_f32_16x16x32_bf16 v[84:87], a[108:111], v[196:199], v[84:87]
    v_exp_f32 v88, v88
    v_mfma_f32_16x16x32_bf16 v[84:87], a[104:107], v[164:167], v[84:87]
    v_exp_f32 v89, v89
    v_mfma_f32_16x16x32_bf16 v[84:87], a[100:103], v[132:135], v[84:87]
    v_exp_f32 v90, v90
    v_exp_f32 v91, v91
    s_waitcnt vmcnt(13) lgkmcnt(0)
    s_barrier
    v_cvt_pk_bf16_f32 v106, v88, v89
    v_cvt_pk_bf16_f32 v107, v90, v91
    v_mfma_f32_16x16x32_bf16 v[88:91], a[100:103], v[136:139], 0
    ds_read_b128 a[84:87], v2 offset:16384
    ds_read_b128 a[88:91], v3 offset:16384
    v_mfma_f32_16x16x32_bf16 v[88:91], a[104:107], v[168:171], v[88:91]
    ds_read_b128 a[92:95], v48 offset:16384
    ds_read_b128 a[96:99], v49 offset:16384
    v_mfma_f32_16x16x32_bf16 v[88:91], a[108:111], v[200:203], v[88:91]
    v_exp_f32 v64, v64
    v_mfma_f32_16x16x32_bf16 v[88:91], a[112:115], v[232:235], v[88:91]
    v_exp_f32 v65, v65
    v_mfma_f32_16x16x32_bf16 v[92:95], a[112:115], a[60:63], 0
    v_exp_f32 v66, v66
    v_mfma_f32_16x16x32_bf16 v[92:95], a[108:111], a[56:59], v[92:95]
    v_exp_f32 v67, v67
    v_mfma_f32_16x16x32_bf16 v[92:95], a[104:107], a[52:55], v[92:95]
    v_cvt_pk_bf16_f32 v112, v64, v65
    v_cvt_pk_bf16_f32 v113, v66, v67
    v_mfma_f32_16x16x32_bf16 v[92:95], a[100:103], a[48:51], v[92:95]
    v_exp_f32 v68, v68
    v_lshlrev_b32 v22, 4, v1
    s_waitcnt lgkmcnt(3)
    v_mfma_f32_16x16x32_bf16 v[64:67], a[84:87], v[128:131], 0
    s_waitcnt lgkmcnt(2)
    v_exp_f32 v69, v69
    v_mfma_f32_16x16x32_bf16 v[64:67], a[88:91], v[160:163], v[64:67]
    s_waitcnt lgkmcnt(0)
    v_exp_f32 v70, v70
    v_mfma_f32_16x16x32_bf16 v[64:67], a[92:95], v[192:195], v[64:67]
    v_exp_f32 v71, v71
    v_mfma_f32_16x16x32_bf16 v[64:67], a[96:99], v[224:227], v[64:67]
    v_cvt_pk_bf16_f32 v116, v68, v69
    v_cvt_pk_bf16_f32 v117, v70, v71
    v_mfma_f32_16x16x32_bf16 v[68:71], a[96:99], v[228:231], 0
    v_exp_f32 v72, v72
    v_mfma_f32_16x16x32_bf16 v[68:71], a[92:95], v[196:199], v[68:71]
    v_exp_f32 v73, v73
    v_mfma_f32_16x16x32_bf16 v[68:71], a[88:91], v[164:167], v[68:71]
    v_exp_f32 v74, v74
    v_mfma_f32_16x16x32_bf16 v[68:71], a[84:87], v[132:135], v[68:71]
    v_exp_f32 v75, v75
    v_cvt_pk_bf16_f32 v120, v72, v73
    v_cvt_pk_bf16_f32 v121, v74, v75
    v_mfma_f32_16x16x32_bf16 v[72:75], a[84:87], v[136:139], 0
    ds_read_b128 a[100:103], v2 offset:16896
    ds_read_b128 a[104:107], v3 offset:16896
    v_mfma_f32_16x16x32_bf16 v[72:75], a[88:91], v[168:171], v[72:75]
    buffer_store_dwordx4 v[56:59], v28, s[28:31], 0 offen sc1
    v_mfma_f32_16x16x32_bf16 v[72:75], a[92:95], v[200:203], v[72:75]
    ds_read_b128 a[108:111], v48 offset:16896
    ds_read_b128 a[112:115], v49 offset:16896
    v_mfma_f32_16x16x32_bf16 v[72:75], a[96:99], v[232:235], v[72:75]
    v_exp_f32 v76, v76
    v_exp_f32 v77, v77
    v_exp_f32 v78, v78
    v_exp_f32 v79, v79
    v_cvt_pk_bf16_f32 v124, v76, v77
    v_cvt_pk_bf16_f32 v125, v78, v79
    v_mfma_f32_16x16x32_bf16 v[76:79], a[96:99], a[60:63], 0
    v_exp_f32 v80, v80
    v_mfma_f32_16x16x32_bf16 v[76:79], a[92:95], a[56:59], v[76:79]
    v_exp_f32 v81, v81
    v_mfma_f32_16x16x32_bf16 v[76:79], a[88:91], a[52:55], v[76:79]
    s_waitcnt lgkmcnt(2)
    v_exp_f32 v82, v82
    v_mfma_f32_16x16x32_bf16 v[76:79], a[84:87], a[48:51], v[76:79]
    v_exp_f32 v83, v83
    v_cvt_pk_bf16_f32 v114, v80, v81
    v_cvt_pk_bf16_f32 v115, v82, v83
    v_mfma_f32_16x16x32_bf16 v[80:83], a[100:103], v[128:131], 0
    s_waitcnt lgkmcnt(0)
    v_exp_f32 v84, v84
    v_mfma_f32_16x16x32_bf16 v[80:83], a[104:107], v[160:163], v[80:83]
    v_exp_f32 v85, v85
    v_mfma_f32_16x16x32_bf16 v[80:83], a[108:111], v[192:195], v[80:83]
    v_exp_f32 v86, v86
    v_mfma_f32_16x16x32_bf16 v[80:83], a[112:115], v[224:227], v[80:83]
    v_exp_f32 v87, v87
    v_cvt_pk_bf16_f32 v118, v84, v85
    v_cvt_pk_bf16_f32 v119, v86, v87
    v_mfma_f32_16x16x32_bf16 v[84:87], a[112:115], v[228:231], 0
    v_exp_f32 v88, v88
    v_mfma_f32_16x16x32_bf16 v[84:87], a[108:111], v[196:199], v[84:87]
    v_exp_f32 v89, v89
    v_mfma_f32_16x16x32_bf16 v[84:87], a[104:107], v[164:167], v[84:87]
    v_exp_f32 v90, v90
    v_mfma_f32_16x16x32_bf16 v[84:87], a[100:103], v[132:135], v[84:87]
    v_exp_f32 v91, v91
    v_cvt_pk_bf16_f32 v122, v88, v89
    v_cvt_pk_bf16_f32 v123, v90, v91
    v_mfma_f32_16x16x32_bf16 v[88:91], a[100:103], v[136:139], 0
    v_exp_f32 v92, v92
    v_mfma_f32_16x16x32_bf16 v[88:91], a[104:107], v[168:171], v[88:91]
    v_exp_f32 v93, v93
    v_mfma_f32_16x16x32_bf16 v[88:91], a[108:111], v[200:203], v[88:91]
    v_exp_f32 v94, v94
    v_mfma_f32_16x16x32_bf16 v[88:91], a[112:115], v[232:235], v[88:91]
    v_exp_f32 v95, v95
    v_cvt_pk_bf16_f32 v126, v92, v93
    v_cvt_pk_bf16_f32 v127, v94, v95
    v_mfma_f32_16x16x32_bf16 v[92:95], a[112:115], a[60:63], 0
    v_add_u32 v22, s46, v22
    ds_read_b64_tr_b16 a[84:85], v6 offset:16384
    v_mfma_f32_16x16x32_bf16 v[92:95], a[108:111], a[56:59], v[92:95]
    s_add_u32 s46, s46, s47
    ds_read_b64_tr_b16 a[86:87], v6 offset:16896
    ds_read_b64_tr_b16 a[88:89], v10 offset:16384
    v_mfma_f32_16x16x32_bf16 v[92:95], a[104:107], a[52:55], v[92:95]
    s_add_u32 m0, s44, 49152
    ds_read_b64_tr_b16 a[90:91], v10 offset:16896
    buffer_load_dwordx4 v14, s[12:15], s87 offen offset:0 nt lds
    v_mfma_f32_16x16x32_bf16 v[92:95], a[100:103], a[48:51], v[92:95]
    ds_read_b64_tr_b16 a[92:93], v11 offset:16384
    ds_read_b64_tr_b16 a[94:95], v11 offset:16896
    v_mfma_f32_16x16x32_bf16 a[76:79], a[80:83], v[124:127], 0
    ds_read_b64_tr_b16 a[96:97], v7 offset:16384
    ds_read_b64_tr_b16 a[98:99], v7 offset:16896
    v_mfma_f32_16x16x32_bf16 a[64:67], a[80:83], v[112:115], 0
    ds_read_b64_tr_b16 a[100:101], v8 offset:16384
    ds_read_b64_tr_b16 a[102:103], v8 offset:16896
    v_mfma_f32_16x16x32_bf16 a[64:67], a[80:83], v[96:99], a[64:67]
    ds_read_b64_tr_b16 a[104:105], v12 offset:16384
    ds_read_b64_tr_b16 a[106:107], v12 offset:16896
    v_mfma_f32_16x16x32_bf16 a[68:71], a[80:83], v[100:103], 0
    ds_read_b64_tr_b16 a[108:109], v13 offset:16384
    ds_read_b64_tr_b16 a[110:111], v13 offset:16896
    v_mfma_f32_16x16x32_bf16 a[68:71], a[80:83], v[116:119], a[68:71]
    ds_read_b64_tr_b16 a[112:113], v9 offset:16384
    ds_read_b64_tr_b16 a[114:115], v9 offset:16896
    v_mfma_f32_16x16x32_bf16 a[72:75], a[80:83], v[120:123], 0
    s_waitcnt lgkmcnt(14)
    v_exp_f32 v64, v64
    v_mfma_f32_16x16x32_bf16 a[72:75], a[80:83], v[104:107], a[72:75]
    s_waitcnt lgkmcnt(12)
    v_exp_f32 v65, v65
    v_mfma_f32_16x16x32_bf16 a[32:35], a[84:87], v[104:107], 0
    v_exp_f32 v66, v66
    v_mfma_f32_16x16x32_bf16 a[32:35], a[88:91], v[120:123], a[32:35]
    v_exp_f32 v67, v67
    v_mfma_f32_16x16x32_bf16 a[16:19], a[88:91], v[116:119], 0
    v_cvt_pk_bf16_f32 v140, v64, v65
    v_cvt_pk_bf16_f32 v141, v66, v67
    v_mfma_f32_16x16x32_bf16 a[16:19], a[84:87], v[100:103], a[16:19]
    v_exp_f32 v68, v68
    v_mfma_f32_16x16x32_bf16 a[0:3], a[84:87], v[96:99], 0
    ds_read_b128 a[84:87], v4 offset:16384
    v_mov_b32 v28, 1
    v_mfma_f32_16x16x32_bf16 a[0:3], a[88:91], v[112:115], a[0:3]
    s_waitcnt lgkmcnt(3)
    v_exp_f32 v69, v69
    v_mfma_f32_16x16x32_bf16 a[224:227], a[88:91], v[124:127], 0
    ds_read_b128 a[88:91], v5 offset:16384
    v_cvt_pk_bf16_f32 v156, v68, v69
    v_mfma_f32_16x16x32_bf16 a[228:231], a[92:95], v[124:127], 0
    v_exp_f32 v70, v70
    v_mfma_f32_16x16x32_bf16 v[144:147], a[92:95], v[112:115], 0
    v_exp_f32 v71, v71
    v_mfma_f32_16x16x32_bf16 v[144:147], a[96:99], v[96:99], v[144:147]
    v_cvt_pk_bf16_f32 v157, v70, v71
    v_and_b32 v23, 0x37, v1
    v_mfma_f32_16x16x32_bf16 v[148:151], a[96:99], v[100:103], 0
    v_exp_f32 v72, v72
    v_mfma_f32_16x16x32_bf16 v[148:151], a[92:95], v[116:119], v[148:151]
    buffer_load_dwordx4 v15, s[12:15], s87 offen offset:1024 nt lds
    v_mfma_f32_16x16x32_bf16 v[152:155], a[92:95], v[120:123], 0
    ds_read_b128 a[92:95], v50 offset:16384
    v_lshlrev_b32 v23, 4, v23
    v_mfma_f32_16x16x32_bf16 v[152:155], a[96:99], v[104:107], v[152:155]
    ds_read_b128 a[96:99], v51 offset:16384
    v_add_u32 v23, s46, v23
    v_mfma_f32_16x16x32_bf16 a[36:39], a[100:103], v[104:107], 0
    v_exp_f32 v73, v73
    v_mfma_f32_16x16x32_bf16 a[36:39], a[104:107], v[120:123], a[36:39]
    v_exp_f32 v74, v74
    v_mfma_f32_16x16x32_bf16 a[20:23], a[104:107], v[116:119], 0
    v_exp_f32 v75, v75
    v_mfma_f32_16x16x32_bf16 a[20:23], a[100:103], v[100:103], a[20:23]
    v_cvt_pk_bf16_f32 v172, v72, v73
    v_cvt_pk_bf16_f32 v173, v74, v75
    v_mfma_f32_16x16x32_bf16 a[4:7], a[100:103], v[96:99], 0
    ds_read_b128 a[100:103], v4 offset:16896
    v_and_b32 v30, 8, v1
    v_mfma_f32_16x16x32_bf16 a[4:7], a[104:107], v[112:115], a[4:7]
    v_exp_f32 v80, v80
    v_mfma_f32_16x16x32_bf16 a[232:235], a[104:107], v[124:127], 0
    ds_read_b128 a[104:107], v5 offset:16896
    v_lshl_add_u32 v23, v30, 8, v23
    v_mfma_f32_16x16x32_bf16 a[236:239], a[108:111], v[124:127], 0
    s_waitcnt lgkmcnt(3)
    v_exp_f32 v81, v81
    v_mfma_f32_16x16x32_bf16 v[176:179], a[108:111], v[112:115], 0
    v_exp_f32 v82, v82
    v_mfma_f32_16x16x32_bf16 v[176:179], a[112:115], v[96:99], v[176:179]
    v_exp_f32 v83, v83
    v_mfma_f32_16x16x32_bf16 v[180:183], a[112:115], v[100:103], 0
    v_cvt_pk_bf16_f32 v142, v80, v81
    v_cvt_pk_bf16_f32 v143, v82, v83
    v_mfma_f32_16x16x32_bf16 v[180:183], a[108:111], v[116:119], v[180:183]
    v_exp_f32 v84, v84
    v_mfma_f32_16x16x32_bf16 v[184:187], a[108:111], v[120:123], 0
    ds_read_b128 a[108:111], v50 offset:16896
    v_xor_b32 v29, 0x2000, v23
    v_mfma_f32_16x16x32_bf16 v[184:187], a[112:115], v[104:107], v[184:187]
    ds_read_b128 a[112:115], v51 offset:16896
    v_mfma_f32_16x16x32_bf16 v[64:67], a[84:87], v[128:131], 0
    v_exp_f32 v85, v85
    v_mfma_f32_16x16x32_bf16 v[64:67], a[88:91], v[160:163], v[64:67]
    s_waitcnt lgkmcnt(2)
    v_exp_f32 v86, v86
    v_mfma_f32_16x16x32_bf16 v[64:67], a[92:95], v[192:195], v[64:67]
    v_exp_f32 v87, v87
    v_mfma_f32_16x16x32_bf16 v[64:67], a[96:99], v[224:227], v[64:67]
    buffer_load_dwordx4 v16, s[12:15], s87 offen offset:2048 nt lds
    v_mfma_f32_16x16x32_bf16 v[68:71], a[96:99], v[228:231], 0
    v_cvt_pk_bf16_f32 v158, v84, v85
    v_cvt_pk_bf16_f32 v159, v86, v87
    v_mfma_f32_16x16x32_bf16 v[68:71], a[92:95], v[196:199], v[68:71]
    v_exp_f32 v88, v88
    v_mfma_f32_16x16x32_bf16 v[68:71], a[88:91], v[164:167], v[68:71]
    v_exp_f32 v89, v89
    v_mfma_f32_16x16x32_bf16 v[68:71], a[84:87], v[132:135], v[68:71]
    v_exp_f32 v90, v90
    v_mfma_f32_16x16x32_bf16 v[72:75], a[84:87], v[136:139], 0
    ds_read_b64_tr_b16 a[84:85], v6 offset:17408
    ds_read_b64_tr_b16 a[86:87], v6 offset:17920
    v_mfma_f32_16x16x32_bf16 v[72:75], a[88:91], v[168:171], v[72:75]
    ds_read_b64_tr_b16 a[88:89], v10 offset:17408
    ds_read_b64_tr_b16 a[90:91], v10 offset:17920
    v_mfma_f32_16x16x32_bf16 v[72:75], a[92:95], v[200:203], v[72:75]
    v_exp_f32 v91, v91
    v_mfma_f32_16x16x32_bf16 v[72:75], a[96:99], v[232:235], v[72:75]
    v_cvt_pk_bf16_f32 v174, v88, v89
    v_cvt_pk_bf16_f32 v175, v90, v91
    v_mfma_f32_16x16x32_bf16 v[80:83], a[100:103], v[128:131], 0
    s_waitcnt lgkmcnt(4)
    ds_read_b64_tr_b16 a[92:93], v11 offset:17408
    ds_read_b64_tr_b16 a[94:95], v11 offset:17920
    v_mfma_f32_16x16x32_bf16 v[80:83], a[104:107], v[160:163], v[80:83]
    ds_read_b64_tr_b16 a[96:97], v7 offset:17408
    ds_read_b64_tr_b16 a[98:99], v7 offset:17920
    v_mfma_f32_16x16x32_bf16 v[80:83], a[108:111], v[192:195], v[80:83]
    v_exp_f32 v64, v64
    v_mfma_f32_16x16x32_bf16 v[80:83], a[112:115], v[224:227], v[80:83]
    v_exp_f32 v65, v65
    v_mfma_f32_16x16x32_bf16 v[84:87], a[112:115], v[228:231], 0
    v_exp_f32 v66, v66
    v_mfma_f32_16x16x32_bf16 v[84:87], a[108:111], v[196:199], v[84:87]
    v_exp_f32 v67, v67
    v_mfma_f32_16x16x32_bf16 v[84:87], a[104:107], v[164:167], v[84:87]
    v_cvt_pk_bf16_f32 v204, v64, v65
    v_cvt_pk_bf16_f32 v205, v66, v67
    v_mfma_f32_16x16x32_bf16 v[84:87], a[100:103], v[132:135], v[84:87]
    v_exp_f32 v68, v68
    v_mfma_f32_16x16x32_bf16 v[88:91], a[100:103], v[136:139], 0
    ds_read_b64_tr_b16 a[100:101], v8 offset:17408
    ds_read_b64_tr_b16 a[102:103], v8 offset:17920
    v_mfma_f32_16x16x32_bf16 v[88:91], a[104:107], v[168:171], v[88:91]
    ds_read_b64_tr_b16 a[104:105], v12 offset:17408
    ds_read_b64_tr_b16 a[106:107], v12 offset:17920
    v_mfma_f32_16x16x32_bf16 v[88:91], a[108:111], v[200:203], v[88:91]
    s_waitcnt lgkmcnt(4)
    ds_read_b64_tr_b16 a[108:109], v13 offset:17408
    ds_read_b64_tr_b16 a[110:111], v13 offset:17920
    v_mfma_f32_16x16x32_bf16 v[88:91], a[112:115], v[232:235], v[88:91]
    buffer_load_dwordx4 v17, s[12:15], s87 offen offset:3072 nt lds
    v_mfma_f32_16x16x32_bf16 a[40:43], a[84:87], v[104:107], 0
    s_add_u32 m0, s44, 98304
    ds_read_b64_tr_b16 a[112:113], v9 offset:17408
    ds_read_b64_tr_b16 a[114:115], v9 offset:17920
    v_mfma_f32_16x16x32_bf16 a[40:43], a[88:91], v[120:123], a[40:43]
    v_exp_f32 v69, v69
    v_mfma_f32_16x16x32_bf16 a[24:27], a[88:91], v[116:119], 0
    v_exp_f32 v70, v70
    v_mfma_f32_16x16x32_bf16 a[24:27], a[84:87], v[100:103], a[24:27]
    v_exp_f32 v71, v71
    v_mfma_f32_16x16x32_bf16 a[8:11], a[84:87], v[96:99], 0
    v_cvt_pk_bf16_f32 v220, v68, v69
    v_cvt_pk_bf16_f32 v221, v70, v71
    v_mfma_f32_16x16x32_bf16 a[8:11], a[88:91], v[112:115], a[8:11]
    v_exp_f32 v72, v72
    v_mfma_f32_16x16x32_bf16 a[240:243], a[88:91], v[124:127], 0
    v_exp_f32 v73, v73
    v_mfma_f32_16x16x32_bf16 a[244:247], a[92:95], v[124:127], 0
    v_exp_f32 v74, v74
    v_mfma_f32_16x16x32_bf16 v[208:211], a[92:95], v[112:115], 0
    v_exp_f32 v75, v75
    v_mfma_f32_16x16x32_bf16 v[208:211], a[96:99], v[96:99], v[208:211]
    v_cvt_pk_bf16_f32 v236, v72, v73
    v_cvt_pk_bf16_f32 v237, v74, v75
    v_mfma_f32_16x16x32_bf16 v[212:215], a[96:99], v[100:103], 0
    v_exp_f32 v76, v76
    v_mfma_f32_16x16x32_bf16 v[212:215], a[92:95], v[116:119], v[212:215]
    v_exp_f32 v77, v77
    v_mfma_f32_16x16x32_bf16 v[216:219], a[92:95], v[120:123], 0
    s_waitcnt lgkmcnt(0)
    v_exp_f32 v78, v78
    v_mfma_f32_16x16x32_bf16 v[216:219], a[96:99], v[104:107], v[216:219]
    v_exp_f32 v79, v79
    v_mfma_f32_16x16x32_bf16 a[44:47], a[100:103], v[104:107], 0
    v_cvt_pk_bf16_f32 v188, v76, v77
    v_cvt_pk_bf16_f32 v189, v78, v79
    v_mfma_f32_16x16x32_bf16 a[44:47], a[104:107], v[120:123], a[44:47]
    v_exp_f32 v80, v80
    v_mfma_f32_16x16x32_bf16 a[28:31], a[104:107], v[116:119], 0
    v_exp_f32 v81, v81
    v_mfma_f32_16x16x32_bf16 a[28:31], a[100:103], v[100:103], a[28:31]
    v_exp_f32 v82, v82
    v_mfma_f32_16x16x32_bf16 a[12:15], a[100:103], v[96:99], 0
    v_exp_f32 v83, v83
    v_mfma_f32_16x16x32_bf16 a[12:15], a[104:107], v[112:115], a[12:15]
    buffer_load_dwordx4 v18, s[16:19], s87 offen offset:0 nt lds
    v_mfma_f32_16x16x32_bf16 a[248:251], a[104:107], v[124:127], 0
    s_waitcnt vmcnt(10) lgkmcnt(0)
    s_barrier
    ds_read_b128 a[84:87], v2 offset:32768
    v_mfma_f32_16x16x32_bf16 a[252:255], a[108:111], v[124:127], 0
    s_add_u32 m0, s44, 98304
    ds_read_b128 a[88:91], v3 offset:32768
    ds_read_b128 a[92:95], v48 offset:32768
    v_mfma_f32_16x16x32_bf16 v[240:243], a[108:111], v[112:115], 0
    ds_read_b128 a[96:99], v49 offset:32768
    ds_read_b128 a[100:103], v2 offset:33280
    v_mfma_f32_16x16x32_bf16 v[240:243], a[112:115], v[96:99], v[240:243]
    ds_read_b128 a[104:107], v3 offset:33280
    v_cvt_pk_bf16_f32 v206, v80, v81
    v_mfma_f32_16x16x32_bf16 v[244:247], a[112:115], v[100:103], 0
    v_cvt_pk_bf16_f32 v207, v82, v83
    v_mfma_f32_16x16x32_bf16 v[244:247], a[108:111], v[116:119], v[244:247]
    v_exp_f32 v84, v84
    v_mfma_f32_16x16x32_bf16 v[248:251], a[108:111], v[120:123], 0
    ds_read_b128 a[108:111], v48 offset:33280
    v_mfma_f32_16x16x32_bf16 v[248:251], a[112:115], v[104:107], v[248:251]
    ds_read_b128 a[112:115], v49 offset:33280
    v_exp_f32 v85, v85
    s_waitcnt lgkmcnt(7)
    v_mfma_f32_16x16x32_bf16 v[64:67], a[84:87], v[128:131], 0
    s_waitcnt lgkmcnt(6)
    v_exp_f32 v86, v86
    v_mfma_f32_16x16x32_bf16 v[64:67], a[88:91], v[160:163], v[64:67]
    s_waitcnt lgkmcnt(5)
    v_exp_f32 v87, v87
    v_mfma_f32_16x16x32_bf16 v[64:67], a[92:95], v[192:195], v[64:67]
    s_waitcnt lgkmcnt(3)
    v_cvt_pk_bf16_f32 v222, v84, v85
    v_cvt_pk_bf16_f32 v223, v86, v87
    v_mfma_f32_16x16x32_bf16 v[64:67], a[96:99], v[224:227], v[64:67]
    v_exp_f32 v88, v88
    v_mfma_f32_16x16x32_bf16 v[68:71], a[96:99], v[228:231], 0
    v_exp_f32 v89, v89
    v_mfma_f32_16x16x32_bf16 v[68:71], a[92:95], v[196:199], v[68:71]
    v_exp_f32 v90, v90
    v_mfma_f32_16x16x32_bf16 v[68:71], a[88:91], v[164:167], v[68:71]
    v_exp_f32 v91, v91
    v_mfma_f32_16x16x32_bf16 v[68:71], a[84:87], v[132:135], v[68:71]
    v_cvt_pk_bf16_f32 v238, v88, v89
    v_cvt_pk_bf16_f32 v239, v90, v91
    v_mfma_f32_16x16x32_bf16 v[72:75], a[84:87], v[136:139], 0
    buffer_load_dwordx4 v19, s[16:19], s87 offen offset:1024 nt lds
    v_mfma_f32_16x16x32_bf16 v[72:75], a[88:91], v[168:171], v[72:75]
    v_exp_f32 v92, v92
    v_mfma_f32_16x16x32_bf16 v[72:75], a[92:95], v[200:203], v[72:75]
    v_exp_f32 v93, v93
    v_mfma_f32_16x16x32_bf16 v[72:75], a[96:99], v[232:235], v[72:75]
    v_exp_f32 v94, v94
    v_mfma_f32_16x16x32_bf16 v[76:79], a[96:99], a[60:63], 0
    v_exp_f32 v95, v95
    v_mfma_f32_16x16x32_bf16 v[76:79], a[92:95], a[56:59], v[76:79]
    v_cvt_pk_bf16_f32 v190, v92, v93
    v_cvt_pk_bf16_f32 v191, v94, v95
    v_mfma_f32_16x16x32_bf16 v[76:79], a[88:91], a[52:55], v[76:79]
L_s2:
    s_cbranch_execz L_s6
    ds_read_b64_tr_b16 a[88:89], v6 offset:32768
    ds_read_b64_tr_b16 a[90:91], v6 offset:33280
    v_mfma_f32_16x16x32_bf16 v[76:79], a[84:87], a[48:51], v[76:79]
    s_waitcnt lgkmcnt(2)
    ds_read_b64_tr_b16 a[84:85], v10 offset:32768
    ds_read_b64_tr_b16 a[86:87], v10 offset:33280
    v_mfma_f32_16x16x32_bf16 v[80:83], a[100:103], v[128:131], 0
    ds_read_b64_tr_b16 a[92:93], v7 offset:32768
    ds_read_b64_tr_b16 a[94:95], v7 offset:33280
    v_mfma_f32_16x16x32_bf16 v[80:83], a[104:107], v[160:163], v[80:83]
    ds_read_b64_tr_b16 a[96:97], v11 offset:32768
    ds_read_b64_tr_b16 a[98:99], v11 offset:33280
    v_mfma_f32_16x16x32_bf16 v[80:83], a[108:111], v[192:195], v[80:83]
    v_exp_f32 v64, v64
    v_mfma_f32_16x16x32_bf16 v[80:83], a[112:115], v[224:227], v[80:83]
    v_exp_f32 v65, v65
    v_mfma_f32_16x16x32_bf16 v[84:87], a[112:115], v[228:231], 0
    v_exp_f32 v66, v66
    v_mfma_f32_16x16x32_bf16 v[84:87], a[108:111], v[196:199], v[84:87]
    v_exp_f32 v67, v67
    v_mfma_f32_16x16x32_bf16 v[84:87], a[104:107], v[164:167], v[84:87]
    v_cvt_pk_bf16_f32 v96, v64, v65
    v_cvt_pk_bf16_f32 v97, v66, v67
    v_mfma_f32_16x16x32_bf16 v[84:87], a[100:103], v[132:135], v[84:87]
    buffer_load_dwordx4 v20, s[16:19], s87 offen offset:2048 nt lds
    v_mfma_f32_16x16x32_bf16 v[88:91], a[100:103], v[136:139], 0
    v_exp_f32 v68, v68
    v_mfma_f32_16x16x32_bf16 v[88:91], a[104:107], v[168:171], v[88:91]
    v_exp_f32 v69, v69
    v_mfma_f32_16x16x32_bf16 v[88:91], a[108:111], v[200:203], v[88:91]
    v_exp_f32 v70, v70
    v_mfma_f32_16x16x32_bf16 v[88:91], a[112:115], v[232:235], v[88:91]
    v_exp_f32 v71, v71
    v_mfma_f32_16x16x32_bf16 v[92:95], a[112:115], a[60:63], 0
    ds_read_b64_tr_b16 a[112:113], v13 offset:32768
    ds_read_b64_tr_b16 a[114:115], v13 offset:33280
    v_mfma_f32_16x16x32_bf16 v[92:95], a[108:111], a[56:59], v[92:95]
    ds_read_b64_tr_b16 a[108:109], v9 offset:32768
    ds_read_b64_tr_b16 a[110:111], v9 offset:33280
    v_mfma_f32_16x16x32_bf16 v[92:95], a[104:107], a[52:55], v[92:95]
    ds_read_b64_tr_b16 a[104:105], v8 offset:32768
    ds_read_b64_tr_b16 a[106:107], v8 offset:33280
    v_mfma_f32_16x16x32_bf16 v[92:95], a[100:103], a[48:51], v[92:95]
    ds_read_b64_tr_b16 a[100:101], v12 offset:32768
    ds_read_b64_tr_b16 a[102:103], v12 offset:33280
    v_mfma_f32_16x16x32_bf16 a[76:79], a[80:83], v[188:191], a[76:79]
    v_cvt_pk_bf16_f32 v100, v68, v69
    v_cvt_pk_bf16_f32 v101, v70, v71
    v_mfma_f32_16x16x32_bf16 a[64:67], a[80:83], v[140:143], a[64:67]
    v_exp_f32 v72, v72
    v_mfma_f32_16x16x32_bf16 a[64:67], a[80:83], v[204:207], a[64:67]
    v_exp_f32 v73, v73
    v_mfma_f32_16x16x32_bf16 a[68:71], a[80:83], v[220:223], a[68:71]
    v_exp_f32 v74, v74
    v_mfma_f32_16x16x32_bf16 a[68:71], a[80:83], v[156:159], a[68:71]
    v_exp_f32 v75, v75
    v_mfma_f32_16x16x32_bf16 a[72:75], a[80:83], v[172:175], a[72:75]
    s_waitcnt lgkmcnt(6)
    v_cvt_pk_bf16_f32 v104, v72, v73
    v_cvt_pk_bf16_f32 v105, v74, v75
    v_mfma_f32_16x16x32_bf16 a[72:75], a[80:83], v[236:239], a[72:75]
    buffer_load_dwordx4 v21, s[16:19], s87 offen offset:3072 nt lds
    v_mfma_f32_16x16x32_bf16 a[32:35], a[84:87], v[236:239], a[32:35]
    s_add_u32 m0, s44, 0
    v_exp_f32 v80, v80
    v_mfma_f32_16x16x32_bf16 a[32:35], a[88:91], v[172:175], a[32:35]
    v_exp_f32 v81, v81
    v_mfma_f32_16x16x32_bf16 a[16:19], a[88:91], v[156:159], a[16:19]
    v_exp_f32 v82, v82
    v_mfma_f32_16x16x32_bf16 a[16:19], a[84:87], v[220:223], a[16:19]
    v_exp_f32 v83, v83
    v_mfma_f32_16x16x32_bf16 a[0:3], a[84:87], v[204:207], a[0:3]
    ds_read_b128 a[84:87], v4 offset:32768
    v_cvt_pk_bf16_f32 v98, v80, v81
    v_mfma_f32_16x16x32_bf16 a[0:3], a[88:91], v[140:143], a[0:3]
    v_cvt_pk_bf16_f32 v99, v82, v83
    v_mfma_f32_16x16x32_bf16 a[224:227], a[88:91], v[188:191], a[224:227]
    ds_read_b128 a[88:91], v5 offset:32768
    v_mfma_f32_16x16x32_bf16 a[228:231], a[92:95], v[188:191], a[228:231]
    v_exp_f32 v84, v84
    v_mfma_f32_16x16x32_bf16 v[144:147], a[92:95], v[140:143], v[144:147]
    v_exp_f32 v85, v85
    v_mfma_f32_16x16x32_bf16 v[144:147], a[96:99], v[204:207], v[144:147]
    v_exp_f32 v86, v86
    v_mfma_f32_16x16x32_bf16 v[148:151], a[96:99], v[220:223], v[148:151]
    v_exp_f32 v87, v87
    v_mfma_f32_16x16x32_bf16 v[148:151], a[92:95], v[156:159], v[148:151]
    v_cvt_pk_bf16_f32 v102, v84, v85
    v_cvt_pk_bf16_f32 v103, v86, v87
    v_mfma_f32_16x16x32_bf16 v[152:155], a[92:95], v[172:175], v[152:155]
    s_waitcnt lgkmcnt(2)
    ds_read_b128 a[92:95], v50 offset:32768
    v_mfma_f32_16x16x32_bf16 v[152:155], a[96:99], v[236:239], v[152:155]
    ds_read_b128 a[96:99], v51 offset:32768
    v_mfma_f32_16x16x32_bf16 a[36:39], a[100:103], v[236:239], a[36:39]
    buffer_load_dwordx4 v14, s[12:15], s88 offen offset:0 nt lds
    v_mfma_f32_16x16x32_bf16 a[36:39], a[104:107], v[172:175], a[36:39]
    v_exp_f32 v88, v88
    v_mfma_f32_16x16x32_bf16 a[20:23], a[104:107], v[156:159], a[20:23]
    v_exp_f32 v89, v89
    v_mfma_f32_16x16x32_bf16 a[20:23], a[100:103], v[220:223], a[20:23]
    v_exp_f32 v90, v90
    v_mfma_f32_16x16x32_bf16 a[4:7], a[100:103], v[204:207], a[4:7]
    ds_read_b128 a[100:103], v4 offset:33280
    v_cvt_pk_bf16_f32 v106, v88, v89
    v_mfma_f32_16x16x32_bf16 a[4:7], a[104:107], v[140:143], a[4:7]
    v_exp_f32 v91, v91
    v_mfma_f32_16x16x32_bf16 a[232:235], a[104:107], v[188:191], a[232:235]
    ds_read_b128 a[104:107], v5 offset:33280
    v_cvt_pk_bf16_f32 v107, v90, v91
    v_mfma_f32_16x16x32_bf16 a[236:239], a[108:111], v[188:191], a[236:239]
    v_exp_f32 v76, v76
    v_mfma_f32_16x16x32_bf16 v[176:179], a[108:111], v[140:143], v[176:179]
    v_exp_f32 v77, v77
    v_mfma_f32_16x16x32_bf16 v[176:179], a[112:115], v[204:207], v[176:179]
    v_exp_f32 v78, v78
    v_mfma_f32_16x16x32_bf16 v[180:183], a[112:115], v[220:223], v[180:183]
    v_exp_f32 v79, v79
    v_mfma_f32_16x16x32_bf16 v[180:183], a[108:111], v[156:159], v[180:183]
    v_cvt_pk_bf16_f32 v108, v76, v77
    v_cvt_pk_bf16_f32 v109, v78, v79
    v_mfma_f32_16x16x32_bf16 v[184:187], a[108:111], v[172:175], v[184:187]
    s_waitcnt lgkmcnt(2)
    ds_read_b128 a[108:111], v50 offset:33280
    v_mfma_f32_16x16x32_bf16 v[184:187], a[112:115], v[236:239], v[184:187]
    ds_read_b128 a[112:115], v51 offset:33280
    v_mfma_f32_16x16x32_bf16 v[64:67], a[84:87], v[128:131], 0
    v_exp_f32 v92, v92
    v_mfma_f32_16x16x32_bf16 v[64:67], a[88:91], v[160:163], v[64:67]
    buffer_load_dwordx4 v15, s[12:15], s88 offen offset:1024 nt lds
    v_mfma_f32_16x16x32_bf16 v[64:67], a[92:95], v[192:195], v[64:67]
    v_exp_f32 v93, v93
    v_mfma_f32_16x16x32_bf16 v[64:67], a[96:99], v[224:227], v[64:67]
    v_exp_f32 v94, v94
    v_mfma_f32_16x16x32_bf16 v[68:71], a[96:99], v[228:231], 0
    v_exp_f32 v95, v95
    v_mfma_f32_16x16x32_bf16 v[68:71], a[92:95], v[196:199], v[68:71]
    v_cvt_pk_bf16_f32 v110, v92, v93
    v_cvt_pk_bf16_f32 v111, v94, v95
    v_mfma_f32_16x16x32_bf16 v[68:71], a[88:91], v[164:167], v[68:71]
    v_mfma_f32_16x16x32_bf16 v[68:71], a[84:87], v[132:135], v[68:71]
    v_exp_f32 v64, v64
    v_mfma_f32_16x16x32_bf16 v[72:75], a[84:87], v[136:139], 0
    ds_read_b64_tr_b16 a[84:85], v10 offset:33792
    ds_read_b64_tr_b16 a[86:87], v10 offset:34304
    v_mfma_f32_16x16x32_bf16 v[72:75], a[88:91], v[168:171], v[72:75]
    ds_read_b64_tr_b16 a[88:89], v6 offset:33792
    ds_read_b64_tr_b16 a[90:91], v6 offset:34304
    v_mfma_f32_16x16x32_bf16 v[72:75], a[92:95], v[200:203], v[72:75]
    s_waitcnt lgkmcnt(4)
    ds_read_b64_tr_b16 a[92:93], v7 offset:33792
    ds_read_b64_tr_b16 a[94:95], v7 offset:34304
    v_mfma_f32_16x16x32_bf16 v[72:75], a[96:99], v[232:235], v[72:75]
    ds_read_b64_tr_b16 a[96:97], v11 offset:33792
    ds_read_b64_tr_b16 a[98:99], v11 offset:34304
    v_mfma_f32_16x16x32_bf16 v[80:83], a[100:103], v[128:131], 0
    v_exp_f32 v65, v65
    v_mfma_f32_16x16x32_bf16 v[80:83], a[104:107], v[160:163], v[80:83]
    v_exp_f32 v66, v66
    v_mfma_f32_16x16x32_bf16 v[80:83], a[108:111], v[192:195], v[80:83]
    v_exp_f32 v67, v67
    v_mfma_f32_16x16x32_bf16 v[80:83], a[112:115], v[224:227], v[80:83]
    v_cvt_pk_bf16_f32 v112, v64, v65
    v_cvt_pk_bf16_f32 v113, v66, v67
    v_mfma_f32_16x16x32_bf16 v[84:87], a[112:115], v[228:231], 0
    buffer_load_dwordx4 v16, s[12:15], s88 offen offset:2048 nt lds
    v_mfma_f32_16x16x32_bf16 v[84:87], a[108:111], v[196:199], v[84:87]
    v_exp_f32 v68, v68
    v_mfma_f32_16x16x32_bf16 v[84:87], a[104:107], v[164:167], v[84:87]
    v_exp_f32 v69, v69
    v_mfma_f32_16x16x32_bf16 v[84:87], a[100:103], v[132:135], v[84:87]
    v_exp_f32 v70, v70
    v_mfma_f32_16x16x32_bf16 v[88:91], a[100:103], v[136:139], 0
    ds_read_b64_tr_b16 a[100:101], v12 offset:33792
    ds_read_b64_tr_b16 a[102:103], v12 offset:34304
    v_mfma_f32_16x16x32_bf16 v[88:91], a[104:107], v[168:171], v[88:91]
    ds_read_b64_tr_b16 a[104:105], v8 offset:33792
    ds_read_b64_tr_b16 a[106:107], v8 offset:34304
    v_mfma_f32_16x16x32_bf16 v[88:91], a[108:111], v[200:203], v[88:91]
    s_waitcnt lgkmcnt(4)
    ds_read_b64_tr_b16 a[108:109], v9 offset:33792
    ds_read_b64_tr_b16 a[110:111], v9 offset:34304
    v_mfma_f32_16x16x32_bf16 v[88:91], a[112:115], v[232:235], v[88:91]
    ds_read_b64_tr_b16 a[112:113], v13 offset:33792
    ds_read_b64_tr_b16 a[114:115], v13 offset:34304
    v_mfma_f32_16x16x32_bf16 a[40:43], a[84:87], v[236:239], a[40:43]
    v_exp_f32 v71, v71
    v_mfma_f32_16x16x32_bf16 a[40:43], a[88:91], v[172:175], a[40:43]
    v_cvt_pk_bf16_f32 v116, v68, v69
    v_cvt_pk_bf16_f32 v117, v70, v71
    v_mfma_f32_16x16x32_bf16 a[24:27], a[88:91], v[156:159], a[24:27]
    v_exp_f32 v72, v72
    v_mfma_f32_16x16x32_bf16 a[24:27], a[84:87], v[220:223], a[24:27]
    v_exp_f32 v73, v73
    v_mfma_f32_16x16x32_bf16 a[8:11], a[84:87], v[204:207], a[8:11]
    v_exp_f32 v74, v74
    v_mfma_f32_16x16x32_bf16 a[8:11], a[88:91], v[140:143], a[8:11]
    v_exp_f32 v75, v75
    v_mfma_f32_16x16x32_bf16 a[240:243], a[88:91], v[188:191], a[240:243]
    v_cvt_pk_bf16_f32 v120, v72, v73
    v_cvt_pk_bf16_f32 v121, v74, v75
    v_mfma_f32_16x16x32_bf16 a[244:247], a[92:95], v[188:191], a[244:247]
    buffer_load_dwordx4 v17, s[12:15], s88 offen offset:3072 nt lds
    v_mfma_f32_16x16x32_bf16 v[208:211], a[92:95], v[140:143], v[208:211]
    v_exp_f32 v80, v80
    v_mfma_f32_16x16x32_bf16 v[208:211], a[96:99], v[204:207], v[208:211]
    v_exp_f32 v81, v81
    v_mfma_f32_16x16x32_bf16 v[212:215], a[96:99], v[220:223], v[212:215]
    v_exp_f32 v82, v82
    v_mfma_f32_16x16x32_bf16 v[212:215], a[92:95], v[156:159], v[212:215]
    v_exp_f32 v83, v83
    v_mfma_f32_16x16x32_bf16 v[216:219], a[92:95], v[172:175], v[216:219]
    s_waitcnt lgkmcnt(0)
    v_cvt_pk_bf16_f32 v114, v80, v81
    v_cvt_pk_bf16_f32 v115, v82, v83
    v_mfma_f32_16x16x32_bf16 v[216:219], a[96:99], v[236:239], v[216:219]
    v_exp_f32 v84, v84
    v_mfma_f32_16x16x32_bf16 a[44:47], a[100:103], v[236:239], a[44:47]
    v_exp_f32 v85, v85
    v_mfma_f32_16x16x32_bf16 a[44:47], a[104:107], v[172:175], a[44:47]
    s_waitcnt vmcnt(8) lgkmcnt(0)
    s_barrier
    ds_read_b128 a[84:87], v2 offset:49152
    v_mfma_f32_16x16x32_bf16 a[28:31], a[104:107], v[156:159], a[28:31]
    s_add_u32 m0, s44, 114688
    ds_read_b128 a[88:91], v3 offset:49152
    ds_read_b128 a[92:95], v48 offset:49152
    v_mfma_f32_16x16x32_bf16 a[28:31], a[100:103], v[220:223], a[28:31]
    ds_read_b128 a[96:99], v49 offset:49152
    v_cvt_pk_bf16_f32 v118, v84, v85
    v_mfma_f32_16x16x32_bf16 a[12:15], a[100:103], v[204:207], a[12:15]
    ds_read_b128 a[100:103], v2 offset:49664
    v_mfma_f32_16x16x32_bf16 a[12:15], a[104:107], v[140:143], a[12:15]
    buffer_store_dword v28, v25, s[32:35], 0 offen sc1
    v_mfma_f32_16x16x32_bf16 a[248:251], a[104:107], v[188:191], a[248:251]
    ds_read_b128 a[104:107], v3 offset:49664
    v_lshlrev_b32 v25, 2, v1
    v_mfma_f32_16x16x32_bf16 a[252:255], a[108:111], v[188:191], a[252:255]
    v_exp_f32 v86, v86
    v_mfma_f32_16x16x32_bf16 v[240:243], a[108:111], v[140:143], v[240:243]
    v_exp_f32 v87, v87
    v_mfma_f32_16x16x32_bf16 v[240:243], a[112:115], v[204:207], v[240:243]
    v_cvt_pk_bf16_f32 v119, v86, v87
    v_mfma_f32_16x16x32_bf16 v[244:247], a[112:115], v[220:223], v[244:247]
    v_exp_f32 v88, v88
    v_mfma_f32_16x16x32_bf16 v[244:247], a[108:111], v[156:159], v[244:247]
    v_exp_f32 v89, v89
    v_mfma_f32_16x16x32_bf16 v[248:251], a[108:111], v[172:175], v[248:251]
    s_waitcnt lgkmcnt(2)
    ds_read_b128 a[108:111], v48 offset:49664
    v_cvt_pk_bf16_f32 v122, v88, v89
    v_mfma_f32_16x16x32_bf16 v[248:251], a[112:115], v[236:239], v[248:251]
    ds_read_b128 a[112:115], v49 offset:49664
    v_mfma_f32_16x16x32_bf16 v[64:67], a[84:87], v[128:131], 0
    v_exp_f32 v90, v90
    v_mfma_f32_16x16x32_bf16 v[64:67], a[88:91], v[160:163], v[64:67]
    v_exp_f32 v91, v91
    v_mfma_f32_16x16x32_bf16 v[64:67], a[92:95], v[192:195], v[64:67]
    v_cvt_pk_bf16_f32 v123, v90, v91
    v_mfma_f32_16x16x32_bf16 v[64:67], a[96:99], v[224:227], v[64:67]
    v_mfma_f32_16x16x32_bf16 v[68:71], a[96:99], v[228:231], 0
    buffer_load_dwordx4 v18, s[16:19], s88 offen offset:0 nt lds
    v_mfma_f32_16x16x32_bf16 v[68:71], a[92:95], v[196:199], v[68:71]
    v_mfma_f32_16x16x32_bf16 v[68:71], a[88:91], v[164:167], v[68:71]
    v_mfma_f32_16x16x32_bf16 v[68:71], a[84:87], v[132:135], v[68:71]
    v_mfma_f32_16x16x32_bf16 v[72:75], a[84:87], v[136:139], 0
    v_mfma_f32_16x16x32_bf16 v[72:75], a[88:91], v[168:171], v[72:75]
    v_mfma_f32_16x16x32_bf16 v[72:75], a[92:95], v[200:203], v[72:75]
    v_exp_f32 v64, v64
    v_mfma_f32_16x16x32_bf16 v[72:75], a[96:99], v[232:235], v[72:75]
    v_exp_f32 v65, v65
    v_mfma_f32_16x16x32_bf16 v[76:79], a[96:99], a[60:63], 0
    ds_read_b64_tr_b16 a[96:97], v11 offset:49152
    ds_read_b64_tr_b16 a[98:99], v11 offset:49664
    v_mfma_f32_16x16x32_bf16 v[76:79], a[92:95], a[56:59], v[76:79]
    ds_read_b64_tr_b16 a[92:93], v7 offset:49152
    ds_read_b64_tr_b16 a[94:95], v7 offset:49664
    v_mfma_f32_16x16x32_bf16 v[76:79], a[88:91], a[52:55], v[76:79]
    s_waitcnt lgkmcnt(4)
    ds_read_b64_tr_b16 a[88:89], v6 offset:49152
    ds_read_b64_tr_b16 a[90:91], v6 offset:49664
    v_mfma_f32_16x16x32_bf16 v[76:79], a[84:87], a[48:51], v[76:79]
    ds_read_b64_tr_b16 a[84:85], v10 offset:49152
    ds_read_b64_tr_b16 a[86:87], v10 offset:49664
    v_mfma_f32_16x16x32_bf16 v[80:83], a[100:103], v[128:131], 0
    v_exp_f32 v66, v66
    v_mfma_f32_16x16x32_bf16 v[80:83], a[104:107], v[160:163], v[80:83]
    buffer_load_dwordx4 v19, s[16:19], s88 offen offset:1024 nt lds
    v_mfma_f32_16x16x32_bf16 v[80:83], a[108:111], v[192:195], v[80:83]
    v_exp_f32 v67, v67
    v_mfma_f32_16x16x32_bf16 v[80:83], a[112:115], v[224:227], v[80:83]
    v_cvt_pk_bf16_f32 v140, v64, v65
    v_cvt_pk_bf16_f32 v141, v66, v67
    v_mfma_f32_16x16x32_bf16 v[84:87], a[112:115], v[228:231], 0
    v_exp_f32 v68, v68
    v_mfma_f32_16x16x32_bf16 v[84:87], a[108:111], v[196:199], v[84:87]
    v_exp_f32 v69, v69
    v_mfma_f32_16x16x32_bf16 v[84:87], a[104:107], v[164:167], v[84:87]
    v_exp_f32 v70, v70
    v_mfma_f32_16x16x32_bf16 v[84:87], a[100:103], v[132:135], v[84:87]
    v_exp_f32 v71, v71
    v_mfma_f32_16x16x32_bf16 v[88:91], a[100:103], v[136:139], 0
    v_cvt_pk_bf16_f32 v156, v68, v69
    v_cvt_pk_bf16_f32 v157, v70, v71
    v_mfma_f32_16x16x32_bf16 v[88:91], a[104:107], v[168:171], v[88:91]
    v_exp_f32 v72, v72
    v_mfma_f32_16x16x32_bf16 v[88:91], a[108:111], v[200:203], v[88:91]
    v_exp_f32 v73, v73
    v_mfma_f32_16x16x32_bf16 v[88:91], a[112:115], v[232:235], v[88:91]
    v_exp_f32 v74, v74
    v_mfma_f32_16x16x32_bf16 v[92:95], a[112:115], a[60:63], 0
    ds_read_b64_tr_b16 a[112:113], v13 offset:49152
    ds_read_b64_tr_b16 a[114:115], v13 offset:49664
    v_mfma_f32_16x16x32_bf16 v[92:95], a[108:111], a[56:59], v[92:95]
    ds_read_b64_tr_b16 a[108:109], v9 offset:49152
    ds_read_b64_tr_b16 a[110:111], v9 offset:49664
    v_mfma_f32_16x16x32_bf16 v[92:95], a[104:107], a[52:55], v[92:95]
    ds_read_b64_tr_b16 a[104:105], v8 offset:49152
    ds_read_b64_tr_b16 a[106:107], v8 offset:49664
    v_mfma_f32_16x16x32_bf16 v[92:95], a[100:103], a[48:51], v[92:95]
    ds_read_b64_tr_b16 a[100:101], v12 offset:49152
    ds_read_b64_tr_b16 a[102:103], v12 offset:49664
    v_mfma_f32_16x16x32_bf16 a[76:79], a[80:83], v[108:111], a[76:79]
    buffer_load_dwordx4 v20, s[16:19], s88 offen offset:2048 nt lds
    v_mfma_f32_16x16x32_bf16 a[64:67], a[80:83], v[96:99], a[64:67]
    v_exp_f32 v75, v75
    v_mfma_f32_16x16x32_bf16 a[64:67], a[80:83], v[112:115], a[64:67]
    v_cvt_pk_bf16_f32 v172, v72, v73
    v_cvt_pk_bf16_f32 v173, v74, v75
    v_mfma_f32_16x16x32_bf16 a[68:71], a[80:83], v[116:119], a[68:71]
    v_exp_f32 v80, v80
    v_mfma_f32_16x16x32_bf16 a[68:71], a[80:83], v[100:103], a[68:71]
    v_exp_f32 v81, v81
    v_mfma_f32_16x16x32_bf16 a[72:75], a[80:83], v[104:107], a[72:75]
    s_waitcnt lgkmcnt(6)
    v_exp_f32 v82, v82
    v_mfma_f32_16x16x32_bf16 a[72:75], a[80:83], v[120:123], a[72:75]
    v_exp_f32 v83, v83
    v_mfma_f32_16x16x32_bf16 a[32:35], a[84:87], v[120:123], a[32:35]
    v_cvt_pk_bf16_f32 v142, v80, v81
    v_cvt_pk_bf16_f32 v143, v82, v83
    v_mfma_f32_16x16x32_bf16 a[32:35], a[88:91], v[104:107], a[32:35]
    v_exp_f32 v84, v84
    v_mfma_f32_16x16x32_bf16 a[16:19], a[88:91], v[100:103], a[16:19]
    v_exp_f32 v85, v85
    v_mfma_f32_16x16x32_bf16 a[16:19], a[84:87], v[116:119], a[16:19]
    v_exp_f32 v86, v86
    v_mfma_f32_16x16x32_bf16 a[0:3], a[84:87], v[112:115], a[0:3]
    ds_read_b128 a[84:87], v4 offset:49152
    v_cvt_pk_bf16_f32 v158, v84, v85
    v_mfma_f32_16x16x32_bf16 a[0:3], a[88:91], v[96:99], a[0:3]
    v_exp_f32 v87, v87
    v_mfma_f32_16x16x32_bf16 a[224:227], a[88:91], v[108:111], a[224:227]
    buffer_load_dwordx4 v21, s[16:19], s88 offen offset:3072 nt lds
    v_mfma_f32_16x16x32_bf16 a[228:231], a[92:95], v[108:111], a[228:231]
    s_add_u32 m0, s44, 16384
    ds_read_b128 a[88:91], v5 offset:49152
    v_cvt_pk_bf16_f32 v159, v86, v87
    v_mfma_f32_16x16x32_bf16 v[144:147], a[92:95], v[96:99], v[144:147]
    v_exp_f32 v88, v88
    v_mfma_f32_16x16x32_bf16 v[144:147], a[96:99], v[112:115], v[144:147]
    v_exp_f32 v89, v89
    v_mfma_f32_16x16x32_bf16 v[148:151], a[96:99], v[116:119], v[148:151]
    v_exp_f32 v90, v90
    v_mfma_f32_16x16x32_bf16 v[148:151], a[92:95], v[100:103], v[148:151]
    v_exp_f32 v91, v91
    v_mfma_f32_16x16x32_bf16 v[152:155], a[92:95], v[104:107], v[152:155]
    s_waitcnt lgkmcnt(2)
    ds_read_b128 a[92:95], v50 offset:49152
    v_cvt_pk_bf16_f32 v174, v88, v89
    v_mfma_f32_16x16x32_bf16 v[152:155], a[96:99], v[120:123], v[152:155]
    ds_read_b128 a[96:99], v51 offset:49152
    v_cvt_pk_bf16_f32 v175, v90, v91
    v_mfma_f32_16x16x32_bf16 a[36:39], a[100:103], v[120:123], a[36:39]
    v_exp_f32 v76, v76
    v_mfma_f32_16x16x32_bf16 a[36:39], a[104:107], v[104:107], a[36:39]
    v_exp_f32 v77, v77
    v_mfma_f32_16x16x32_bf16 a[20:23], a[104:107], v[100:103], a[20:23]
    v_exp_f32 v78, v78
    v_mfma_f32_16x16x32_bf16 a[20:23], a[100:103], v[116:119], a[20:23]
    v_exp_f32 v79, v79
    v_mfma_f32_16x16x32_bf16 a[4:7], a[100:103], v[112:115], a[4:7]
    ds_read_b128 a[100:103], v4 offset:49664
    v_cvt_pk_bf16_f32 v188, v76, v77
    v_mfma_f32_16x16x32_bf16 a[4:7], a[104:107], v[96:99], a[4:7]
    buffer_load_dwordx4 v14, s[12:15], s89 offen offset:0 nt lds
    v_mfma_f32_16x16x32_bf16 a[232:235], a[104:107], v[108:111], a[232:235]
    ds_read_b128 a[104:107], v5 offset:49664
    v_cvt_pk_bf16_f32 v189, v78, v79
    v_mfma_f32_16x16x32_bf16 a[236:239], a[108:111], v[108:111], a[236:239]
    v_exp_f32 v92, v92
    v_mfma_f32_16x16x32_bf16 v[176:179], a[108:111], v[96:99], v[176:179]
    v_exp_f32 v93, v93
    v_mfma_f32_16x16x32_bf16 v[176:179], a[112:115], v[112:115], v[176:179]
    v_exp_f32 v94, v94
    v_mfma_f32_16x16x32_bf16 v[180:183], a[112:115], v[116:119], v[180:183]
    v_exp_f32 v95, v95
    v_mfma_f32_16x16x32_bf16 v[180:183], a[108:111], v[100:103], v[180:183]
    v_cvt_pk_bf16_f32 v190, v92, v93
    v_cvt_pk_bf16_f32 v191, v94, v95
    v_mfma_f32_16x16x32_bf16 v[184:187], a[108:111], v[104:107], v[184:187]
    s_waitcnt lgkmcnt(2)
    ds_read_b128 a[108:111], v50 offset:49664
    v_mfma_f32_16x16x32_bf16 v[184:187], a[112:115], v[120:123], v[184:187]
    ds_read_b128 a[112:115], v51 offset:49664
    v_mfma_f32_16x16x32_bf16 v[64:67], a[84:87], v[128:131], 0
    v_mfma_f32_16x16x32_bf16 v[64:67], a[88:91], v[160:163], v[64:67]
    v_mfma_f32_16x16x32_bf16 v[64:67], a[92:95], v[192:195], v[64:67]
    v_mfma_f32_16x16x32_bf16 v[64:67], a[96:99], v[224:227], v[64:67]
    v_mfma_f32_16x16x32_bf16 v[68:71], a[96:99], v[228:231], 0
    buffer_load_dwordx4 v15, s[12:15], s89 offen offset:1024 nt lds
    v_mfma_f32_16x16x32_bf16 v[68:71], a[92:95], v[196:199], v[68:71]
    v_mfma_f32_16x16x32_bf16 v[68:71], a[88:91], v[164:167], v[68:71]
    v_mfma_f32_16x16x32_bf16 v[68:71], a[84:87], v[132:135], v[68:71]
    v_mfma_f32_16x16x32_bf16 v[72:75], a[84:87], v[136:139], 0
    ds_read_b64_tr_b16 a[84:85], v10 offset:50176
    ds_read_b64_tr_b16 a[86:87], v10 offset:50688
    v_mfma_f32_16x16x32_bf16 v[72:75], a[88:91], v[168:171], v[72:75]
    ds_read_b64_tr_b16 a[88:89], v6 offset:50176
    ds_read_b64_tr_b16 a[90:91], v6 offset:50688
    v_mfma_f32_16x16x32_bf16 v[72:75], a[92:95], v[200:203], v[72:75]
    s_waitcnt lgkmcnt(4)
    ds_read_b64_tr_b16 a[92:93], v7 offset:50176
    ds_read_b64_tr_b16 a[94:95], v7 offset:50688
    v_mfma_f32_16x16x32_bf16 v[72:75], a[96:99], v[232:235], v[72:75]
    ds_read_b64_tr_b16 a[96:97], v11 offset:50176
    ds_read_b64_tr_b16 a[98:99], v11 offset:50688
    v_mfma_f32_16x16x32_bf16 v[80:83], a[100:103], v[128:131], 0
    v_exp_f32 v64, v64
    v_mfma_f32_16x16x32_bf16 v[80:83], a[104:107], v[160:163], v[80:83]
    v_exp_f32 v65, v65
    v_mfma_f32_16x16x32_bf16 v[80:83], a[108:111], v[192:195], v[80:83]
    v_exp_f32 v66, v66
    v_mfma_f32_16x16x32_bf16 v[80:83], a[112:115], v[224:227], v[80:83]
    v_exp_f32 v67, v67
    v_mfma_f32_16x16x32_bf16 v[84:87], a[112:115], v[228:231], 0
    v_cvt_pk_bf16_f32 v204, v64, v65
    v_cvt_pk_bf16_f32 v205, v66, v67
    v_mfma_f32_16x16x32_bf16 v[84:87], a[108:111], v[196:199], v[84:87]
    buffer_load_dwordx4 v16, s[12:15], s89 offen offset:2048 nt lds
    v_mfma_f32_16x16x32_bf16 v[84:87], a[104:107], v[164:167], v[84:87]
    v_exp_f32 v68, v68
    v_mfma_f32_16x16x32_bf16 v[84:87], a[100:103], v[132:135], v[84:87]
    v_exp_f32 v69, v69
    v_mfma_f32_16x16x32_bf16 v[88:91], a[100:103], v[136:139], 0
    ds_read_b64_tr_b16 a[100:101], v12 offset:50176
    ds_read_b64_tr_b16 a[102:103], v12 offset:50688
    v_mfma_f32_16x16x32_bf16 v[88:91], a[104:107], v[168:171], v[88:91]
    ds_read_b64_tr_b16 a[104:105], v8 offset:50176
    ds_read_b64_tr_b16 a[106:107], v8 offset:50688
    v_mfma_f32_16x16x32_bf16 v[88:91], a[108:111], v[200:203], v[88:91]
    s_waitcnt lgkmcnt(4)
    ds_read_b64_tr_b16 a[108:109], v9 offset:50176
    ds_read_b64_tr_b16 a[110:111], v9 offset:50688
    v_mfma_f32_16x16x32_bf16 v[88:91], a[112:115], v[232:235], v[88:91]
    ds_read_b64_tr_b16 a[112:113], v13 offset:50176
    ds_read_b64_tr_b16 a[114:115], v13 offset:50688
    v_mfma_f32_16x16x32_bf16 a[40:43], a[84:87], v[120:123], a[40:43]
    v_exp_f32 v70, v70
    v_mfma_f32_16x16x32_bf16 a[40:43], a[88:91], v[104:107], a[40:43]
    v_exp_f32 v71, v71
    v_mfma_f32_16x16x32_bf16 a[24:27], a[88:91], v[100:103], a[24:27]
    v_cvt_pk_bf16_f32 v220, v68, v69
    v_cvt_pk_bf16_f32 v221, v70, v71
    v_mfma_f32_16x16x32_bf16 a[24:27], a[84:87], v[116:119], a[24:27]
    v_exp_f32 v72, v72
    v_mfma_f32_16x16x32_bf16 a[8:11], a[84:87], v[112:115], a[8:11]
    v_exp_f32 v73, v73
    v_mfma_f32_16x16x32_bf16 a[8:11], a[88:91], v[96:99], a[8:11]
    v_exp_f32 v74, v74
    v_mfma_f32_16x16x32_bf16 a[240:243], a[88:91], v[108:111], a[240:243]
    buffer_load_dwordx4 v17, s[12:15], s89 offen offset:3072 nt lds
    v_mfma_f32_16x16x32_bf16 a[244:247], a[92:95], v[108:111], a[244:247]
    v_exp_f32 v75, v75
    v_mfma_f32_16x16x32_bf16 v[208:211], a[92:95], v[96:99], v[208:211]
    v_cvt_pk_bf16_f32 v236, v72, v73
    v_cvt_pk_bf16_f32 v237, v74, v75
    v_mfma_f32_16x16x32_bf16 v[208:211], a[96:99], v[112:115], v[208:211]
    v_exp_f32 v80, v80
    v_mfma_f32_16x16x32_bf16 v[212:215], a[96:99], v[116:119], v[212:215]
    v_exp_f32 v81, v81
    v_mfma_f32_16x16x32_bf16 v[212:215], a[92:95], v[100:103], v[212:215]
    v_exp_f32 v82, v82
    v_mfma_f32_16x16x32_bf16 v[216:219], a[92:95], v[104:107], v[216:219]
    s_waitcnt lgkmcnt(0)
    v_exp_f32 v83, v83
    v_mfma_f32_16x16x32_bf16 v[216:219], a[96:99], v[120:123], v[216:219]
    v_cvt_pk_bf16_f32 v206, v80, v81
    v_cvt_pk_bf16_f32 v207, v82, v83
    v_mfma_f32_16x16x32_bf16 a[44:47], a[100:103], v[120:123], a[44:47]
    v_exp_f32 v84, v84
    v_mfma_f32_16x16x32_bf16 a[44:47], a[104:107], v[104:107], a[44:47]
    s_waitcnt vmcnt(9) lgkmcnt(0)
    s_barrier
    ds_read_b128 a[84:87], v2 offset:0
    v_mfma_f32_16x16x32_bf16 a[28:31], a[104:107], v[100:103], a[28:31]
    s_add_u32 m0, s44, 131072
    ds_read_b128 a[88:91], v3 offset:0
    ds_read_b128 a[92:95], v48 offset:0
    v_mfma_f32_16x16x32_bf16 a[28:31], a[100:103], v[116:119], a[28:31]
    ds_read_b128 a[96:99], v49 offset:0
    v_mfma_f32_16x16x32_bf16 a[12:15], a[100:103], v[112:115], a[12:15]
    ds_read_b128 a[100:103], v2 offset:512
    v_mfma_f32_16x16x32_bf16 a[12:15], a[104:107], v[96:99], a[12:15]
    v_exp_f32 v85, v85
    v_mfma_f32_16x16x32_bf16 a[248:251], a[104:107], v[108:111], a[248:251]
    ds_read_b128 a[104:107], v3 offset:512
    v_cvt_pk_bf16_f32 v222, v84, v85
    v_mfma_f32_16x16x32_bf16 a[252:255], a[108:111], v[108:111], a[252:255]
    v_exp_f32 v86, v86
    v_mfma_f32_16x16x32_bf16 v[240:243], a[108:111], v[96:99], v[240:243]
    v_exp_f32 v87, v87
    v_mfma_f32_16x16x32_bf16 v[240:243], a[112:115], v[112:115], v[240:243]
    v_cvt_pk_bf16_f32 v223, v86, v87
    v_mfma_f32_16x16x32_bf16 v[244:247], a[112:115], v[116:119], v[244:247]
    buffer_load_dwordx4 v18, s[16:19], s89 offen offset:0 nt lds
    v_mfma_f32_16x16x32_bf16 v[244:247], a[108:111], v[100:103], v[244:247]
    v_exp_f32 v88, v88
    v_mfma_f32_16x16x32_bf16 v[248:251], a[108:111], v[104:107], v[248:251]
    s_waitcnt lgkmcnt(2)
    ds_read_b128 a[108:111], v48 offset:512
    v_mfma_f32_16x16x32_bf16 v[248:251], a[112:115], v[120:123], v[248:251]
    ds_read_b128 a[112:115], v49 offset:512
    v_mfma_f32_16x16x32_bf16 v[64:67], a[84:87], v[128:131], 0
    v_exp_f32 v89, v89
    v_mfma_f32_16x16x32_bf16 v[64:67], a[88:91], v[160:163], v[64:67]
    v_exp_f32 v90, v90
    v_mfma_f32_16x16x32_bf16 v[64:67], a[92:95], v[192:195], v[64:67]
    v_exp_f32 v91, v91
    v_mfma_f32_16x16x32_bf16 v[64:67], a[96:99], v[224:227], v[64:67]
    v_cvt_pk_bf16_f32 v238, v88, v89
    v_cvt_pk_bf16_f32 v239, v90, v91
    v_mfma_f32_16x16x32_bf16 v[68:71], a[96:99], v[228:231], 0
    v_mfma_f32_16x16x32_bf16 v[68:71], a[92:95], v[196:199], v[68:71]
    v_mfma_f32_16x16x32_bf16 v[68:71], a[88:91], v[164:167], v[68:71]
    v_mfma_f32_16x16x32_bf16 v[68:71], a[84:87], v[132:135], v[68:71]
    v_mfma_f32_16x16x32_bf16 v[72:75], a[84:87], v[136:139], 0
    v_mfma_f32_16x16x32_bf16 v[72:75], a[88:91], v[168:171], v[72:75]
    buffer_load_dwordx4 v19, s[16:19], s89 offen offset:1024 nt lds
    v_mfma_f32_16x16x32_bf16 v[72:75], a[92:95], v[200:203], v[72:75]
    v_exp_f32 v64, v64
    v_mfma_f32_16x16x32_bf16 v[72:75], a[96:99], v[232:235], v[72:75]
    v_exp_f32 v65, v65
    v_mfma_f32_16x16x32_bf16 v[76:79], a[96:99], a[60:63], 0
    ds_read_b64_tr_b16 a[96:97], v11 offset:0
    ds_read_b64_tr_b16 a[98:99], v11 offset:512
    v_mfma_f32_16x16x32_bf16 v[76:79], a[92:95], a[56:59], v[76:79]
    ds_read_b64_tr_b16 a[92:93], v7 offset:0
    ds_read_b64_tr_b16 a[94:95], v7 offset:512
    v_mfma_f32_16x16x32_bf16 v[76:79], a[88:91], a[52:55], v[76:79]
    s_waitcnt lgkmcnt(4)
    ds_read_b64_tr_b16 a[88:89], v6 offset:0
    ds_read_b64_tr_b16 a[90:91], v6 offset:512
    v_mfma_f32_16x16x32_bf16 v[76:79], a[84:87], a[48:51], v[76:79]
    ds_read_b64_tr_b16 a[84:85], v10 offset:0
    ds_read_b64_tr_b16 a[86:87], v10 offset:512
    v_mfma_f32_16x16x32_bf16 v[80:83], a[100:103], v[128:131], 0
    v_exp_f32 v66, v66
    v_mfma_f32_16x16x32_bf16 v[80:83], a[104:107], v[160:163], v[80:83]
    v_exp_f32 v67, v67
    v_mfma_f32_16x16x32_bf16 v[80:83], a[108:111], v[192:195], v[80:83]
    v_cvt_pk_bf16_f32 v96, v64, v65
    v_cvt_pk_bf16_f32 v97, v66, v67
    v_mfma_f32_16x16x32_bf16 v[80:83], a[112:115], v[224:227], v[80:83]
    v_exp_f32 v68, v68
    v_mfma_f32_16x16x32_bf16 v[84:87], a[112:115], v[228:231], 0
    v_exp_f32 v69, v69
    v_mfma_f32_16x16x32_bf16 v[84:87], a[108:111], v[196:199], v[84:87]
    v_exp_f32 v70, v70
    v_mfma_f32_16x16x32_bf16 v[84:87], a[104:107], v[164:167], v[84:87]
    buffer_load_dwordx4 v20, s[16:19], s89 offen offset:2048 nt lds
    v_mfma_f32_16x16x32_bf16 v[84:87], a[100:103], v[132:135], v[84:87]
    v_exp_f32 v71, v71
    v_mfma_f32_16x16x32_bf16 v[88:91], a[100:103], v[136:139], 0
    v_cvt_pk_bf16_f32 v100, v68, v69
    v_cvt_pk_bf16_f32 v101, v70, v71
    v_mfma_f32_16x16x32_bf16 v[88:91], a[104:107], v[168:171], v[88:91]
    v_exp_f32 v72, v72
    v_mfma_f32_16x16x32_bf16 v[88:91], a[108:111], v[200:203], v[88:91]
    v_exp_f32 v73, v73
    v_mfma_f32_16x16x32_bf16 v[88:91], a[112:115], v[232:235], v[88:91]
    v_exp_f32 v74, v74
    v_mfma_f32_16x16x32_bf16 v[92:95], a[112:115], a[60:63], 0
    ds_read_b64_tr_b16 a[112:113], v13 offset:0
    ds_read_b64_tr_b16 a[114:115], v13 offset:512
    v_mfma_f32_16x16x32_bf16 v[92:95], a[108:111], a[56:59], v[92:95]
L_s3:
    s_cbranch_execz L_s7
    ds_read_b64_tr_b16 a[108:109], v9 offset:0
    ds_read_b64_tr_b16 a[110:111], v9 offset:512
    v_mfma_f32_16x16x32_bf16 v[92:95], a[104:107], a[52:55], v[92:95]
    ds_read_b64_tr_b16 a[104:105], v8 offset:0
    ds_read_b64_tr_b16 a[106:107], v8 offset:512
    v_mfma_f32_16x16x32_bf16 v[92:95], a[100:103], a[48:51], v[92:95]
    ds_read_b64_tr_b16 a[100:101], v12 offset:0
    ds_read_b64_tr_b16 a[102:103], v12 offset:512
    v_mfma_f32_16x16x32_bf16 a[76:79], a[80:83], v[188:191], a[76:79]
    v_exp_f32 v75, v75
    v_mfma_f32_16x16x32_bf16 a[64:67], a[80:83], v[140:143], a[64:67]
    v_cvt_pk_bf16_f32 v104, v72, v73
    v_cvt_pk_bf16_f32 v105, v74, v75
    v_mfma_f32_16x16x32_bf16 a[64:67], a[80:83], v[204:207], a[64:67]
    v_exp_f32 v80, v80
    v_mfma_f32_16x16x32_bf16 a[68:71], a[80:83], v[220:223], a[68:71]
    buffer_load_dwordx4 v21, s[16:19], s89 offen offset:3072 nt lds
    v_mfma_f32_16x16x32_bf16 a[68:71], a[80:83], v[156:159], a[68:71]
    s_add_u32 m0, s44, 32768
    v_exp_f32 v81, v81
    v_mfma_f32_16x16x32_bf16 a[72:75], a[80:83], v[172:175], a[72:75]
    s_waitcnt lgkmcnt(6)
    v_exp_f32 v82, v82
    v_mfma_f32_16x16x32_bf16 a[72:75], a[80:83], v[236:239], a[72:75]
    v_exp_f32 v83, v83
    v_mfma_f32_16x16x32_bf16 a[32:35], a[84:87], v[236:239], a[32:35]
    v_cvt_pk_bf16_f32 v98, v80, v81
    v_cvt_pk_bf16_f32 v99, v82, v83
    v_mfma_f32_16x16x32_bf16 a[32:35], a[88:91], v[172:175], a[32:35]
    v_exp_f32 v84, v84
    v_mfma_f32_16x16x32_bf16 a[16:19], a[88:91], v[156:159], a[16:19]
    v_exp_f32 v85, v85
    v_mfma_f32_16x16x32_bf16 a[16:19], a[84:87], v[220:223], a[16:19]
    v_exp_f32 v86, v86
    v_mfma_f32_16x16x32_bf16 a[0:3], a[84:87], v[204:207], a[0:3]
    ds_read_b128 a[84:87], v4 offset:0
    v_cvt_pk_bf16_f32 v102, v84, v85
    v_mfma_f32_16x16x32_bf16 a[0:3], a[88:91], v[140:143], a[0:3]
    v_exp_f32 v87, v87
    v_mfma_f32_16x16x32_bf16 a[224:227], a[88:91], v[188:191], a[224:227]
    ds_read_b128 a[88:91], v5 offset:0
    v_cvt_pk_bf16_f32 v103, v86, v87
    v_mfma_f32_16x16x32_bf16 a[228:231], a[92:95], v[188:191], a[228:231]
    v_exp_f32 v88, v88
    v_mfma_f32_16x16x32_bf16 v[144:147], a[92:95], v[140:143], v[144:147]
    v_exp_f32 v89, v89
    v_mfma_f32_16x16x32_bf16 v[144:147], a[96:99], v[204:207], v[144:147]
    buffer_load_dwordx4 v14, s[12:15], s90 offen offset:0 nt lds
    v_mfma_f32_16x16x32_bf16 v[148:151], a[96:99], v[220:223], v[148:151]
    v_exp_f32 v90, v90
    v_mfma_f32_16x16x32_bf16 v[148:151], a[92:95], v[156:159], v[148:151]
    v_exp_f32 v91, v91
    v_mfma_f32_16x16x32_bf16 v[152:155], a[92:95], v[172:175], v[152:155]
    s_waitcnt lgkmcnt(2)
    ds_read_b128 a[92:95], v50 offset:0
    v_cvt_pk_bf16_f32 v106, v88, v89
    v_mfma_f32_16x16x32_bf16 v[152:155], a[96:99], v[236:239], v[152:155]
    ds_read_b128 a[96:99], v51 offset:0
    v_cvt_pk_bf16_f32 v107, v90, v91
    v_mfma_f32_16x16x32_bf16 a[36:39], a[100:103], v[236:239], a[36:39]
    v_exp_f32 v76, v76
    v_mfma_f32_16x16x32_bf16 a[36:39], a[104:107], v[172:175], a[36:39]
    v_exp_f32 v77, v77
    v_mfma_f32_16x16x32_bf16 a[20:23], a[104:107], v[156:159], a[20:23]
    v_exp_f32 v78, v78
    v_mfma_f32_16x16x32_bf16 a[20:23], a[100:103], v[220:223], a[20:23]
    v_exp_f32 v79, v79
    v_mfma_f32_16x16x32_bf16 a[4:7], a[100:103], v[204:207], a[4:7]
    ds_read_b128 a[100:103], v4 offset:512
    v_cvt_pk_bf16_f32 v108, v76, v77
    v_mfma_f32_16x16x32_bf16 a[4:7], a[104:107], v[140:143], a[4:7]
    v_cvt_pk_bf16_f32 v109, v78, v79
    v_mfma_f32_16x16x32_bf16 a[232:235], a[104:107], v[188:191], a[232:235]
    ds_read_b128 a[104:107], v5 offset:512
    v_mfma_f32_16x16x32_bf16 a[236:239], a[108:111], v[188:191], a[236:239]
    v_exp_f32 v92, v92
    v_mfma_f32_16x16x32_bf16 v[176:179], a[108:111], v[140:143], v[176:179]
    buffer_load_dwordx4 v15, s[12:15], s90 offen offset:1024 nt lds
    v_mfma_f32_16x16x32_bf16 v[176:179], a[112:115], v[204:207], v[176:179]
    v_exp_f32 v93, v93
    v_mfma_f32_16x16x32_bf16 v[180:183], a[112:115], v[220:223], v[180:183]
    v_exp_f32 v94, v94
    v_mfma_f32_16x16x32_bf16 v[180:183], a[108:111], v[156:159], v[180:183]
    v_exp_f32 v95, v95
    v_mfma_f32_16x16x32_bf16 v[184:187], a[108:111], v[172:175], v[184:187]
    s_waitcnt lgkmcnt(2)
    ds_read_b128 a[108:111], v50 offset:512
    v_cvt_pk_bf16_f32 v110, v92, v93
    v_mfma_f32_16x16x32_bf16 v[184:187], a[112:115], v[236:239], v[184:187]
    ds_read_b128 a[112:115], v51 offset:512
    v_cvt_pk_bf16_f32 v111, v94, v95
    v_mfma_f32_16x16x32_bf16 v[64:67], a[84:87], v[128:131], 0
    v_mfma_f32_16x16x32_bf16 v[64:67], a[88:91], v[160:163], v[64:67]
    v_mfma_f32_16x16x32_bf16 v[64:67], a[92:95], v[192:195], v[64:67]
    v_mfma_f32_16x16x32_bf16 v[64:67], a[96:99], v[224:227], v[64:67]
    v_mfma_f32_16x16x32_bf16 v[68:71], a[96:99], v[228:231], 0
    v_mfma_f32_16x16x32_bf16 v[68:71], a[92:95], v[196:199], v[68:71]
    v_mfma_f32_16x16x32_bf16 v[68:71], a[88:91], v[164:167], v[68:71]
    v_mfma_f32_16x16x32_bf16 v[68:71], a[84:87], v[132:135], v[68:71]
    buffer_load_dwordx4 v16, s[12:15], s90 offen offset:2048 nt lds
    v_mfma_f32_16x16x32_bf16 v[72:75], a[84:87], v[136:139], 0
    ds_read_b64_tr_b16 a[84:85], v10 offset:1024
    ds_read_b64_tr_b16 a[86:87], v10 offset:1536
    v_mfma_f32_16x16x32_bf16 v[72:75], a[88:91], v[168:171], v[72:75]
    ds_read_b64_tr_b16 a[88:89], v6 offset:1024
    ds_read_b64_tr_b16 a[90:91], v6 offset:1536
    v_mfma_f32_16x16x32_bf16 v[72:75], a[92:95], v[200:203], v[72:75]
    s_waitcnt lgkmcnt(4)
    ds_read_b64_tr_b16 a[92:93], v7 offset:1024
    ds_read_b64_tr_b16 a[94:95], v7 offset:1536
    v_mfma_f32_16x16x32_bf16 v[72:75], a[96:99], v[232:235], v[72:75]
    ds_read_b64_tr_b16 a[96:97], v11 offset:1024
    ds_read_b64_tr_b16 a[98:99], v11 offset:1536
    v_mfma_f32_16x16x32_bf16 v[80:83], a[100:103], v[128:131], 0
    v_exp_f32 v64, v64
    v_mfma_f32_16x16x32_bf16 v[80:83], a[104:107], v[160:163], v[80:83]
    v_exp_f32 v65, v65
    v_mfma_f32_16x16x32_bf16 v[80:83], a[108:111], v[192:195], v[80:83]
    v_exp_f32 v66, v66
    v_mfma_f32_16x16x32_bf16 v[80:83], a[112:115], v[224:227], v[80:83]
    v_exp_f32 v67, v67
    v_mfma_f32_16x16x32_bf16 v[84:87], a[112:115], v[228:231], 0
    v_cvt_pk_bf16_f32 v112, v64, v65
    v_cvt_pk_bf16_f32 v113, v66, v67
    v_mfma_f32_16x16x32_bf16 v[84:87], a[108:111], v[196:199], v[84:87]
    v_exp_f32 v68, v68
    v_mfma_f32_16x16x32_bf16 v[84:87], a[104:107], v[164:167], v[84:87]
    v_exp_f32 v69, v69
    v_mfma_f32_16x16x32_bf16 v[84:87], a[100:103], v[132:135], v[84:87]
    v_exp_f32 v70, v70
    v_mfma_f32_16x16x32_bf16 v[88:91], a[100:103], v[136:139], 0
    ds_read_b64_tr_b16 a[100:101], v12 offset:1024
    ds_read_b64_tr_b16 a[102:103], v12 offset:1536
    v_mfma_f32_16x16x32_bf16 v[88:91], a[104:107], v[168:171], v[88:91]
    ds_read_b64_tr_b16 a[104:105], v8 offset:1024
    ds_read_b64_tr_b16 a[106:107], v8 offset:1536
    v_mfma_f32_16x16x32_bf16 v[88:91], a[108:111], v[200:203], v[88:91]
    s_waitcnt lgkmcnt(4)
    ds_read_b64_tr_b16 a[108:109], v9 offset:1024
    ds_read_b64_tr_b16 a[110:111], v9 offset:1536
    v_mfma_f32_16x16x32_bf16 v[88:91], a[112:115], v[232:235], v[88:91]
    ds_read_b64_tr_b16 a[112:113], v13 offset:1024
    ds_read_b64_tr_b16 a[114:115], v13 offset:1536
    v_mfma_f32_16x16x32_bf16 a[40:43], a[84:87], v[236:239], a[40:43]
    buffer_load_dwordx4 v17, s[12:15], s90 offen offset:3072 nt lds
    v_mfma_f32_16x16x32_bf16 a[40:43], a[88:91], v[172:175], a[40:43]
    v_exp_f32 v71, v71
    v_mfma_f32_16x16x32_bf16 a[24:27], a[88:91], v[156:159], a[24:27]
    v_cvt_pk_bf16_f32 v116, v68, v69
    v_cvt_pk_bf16_f32 v117, v70, v71
    v_mfma_f32_16x16x32_bf16 a[24:27], a[84:87], v[220:223], a[24:27]
    v_exp_f32 v72, v72
    v_mfma_f32_16x16x32_bf16 a[8:11], a[84:87], v[204:207], a[8:11]
    v_exp_f32 v73, v73
    v_mfma_f32_16x16x32_bf16 a[8:11], a[88:91], v[140:143], a[8:11]
    v_exp_f32 v74, v74
    v_mfma_f32_16x16x32_bf16 a[240:243], a[88:91], v[188:191], a[240:243]
    v_exp_f32 v75, v75
    v_mfma_f32_16x16x32_bf16 a[244:247], a[92:95], v[188:191], a[244:247]
    v_cvt_pk_bf16_f32 v120, v72, v73
    v_cvt_pk_bf16_f32 v121, v74, v75
    v_mfma_f32_16x16x32_bf16 v[208:211], a[92:95], v[140:143], v[208:211]
    v_exp_f32 v80, v80
    v_mfma_f32_16x16x32_bf16 v[208:211], a[96:99], v[204:207], v[208:211]
    v_exp_f32 v81, v81
    v_mfma_f32_16x16x32_bf16 v[212:215], a[96:99], v[220:223], v[212:215]
    v_exp_f32 v82, v82
    v_mfma_f32_16x16x32_bf16 v[212:215], a[92:95], v[156:159], v[212:215]
    v_exp_f32 v83, v83
    v_mfma_f32_16x16x32_bf16 v[216:219], a[92:95], v[172:175], v[216:219]
    s_waitcnt lgkmcnt(0)
    v_cvt_pk_bf16_f32 v114, v80, v81
    v_cvt_pk_bf16_f32 v115, v82, v83
    v_mfma_f32_16x16x32_bf16 v[216:219], a[96:99], v[236:239], v[216:219]
    v_exp_f32 v84, v84
    v_mfma_f32_16x16x32_bf16 a[44:47], a[100:103], v[236:239], a[44:47]
    v_exp_f32 v85, v85
    v_mfma_f32_16x16x32_bf16 a[44:47], a[104:107], v[172:175], a[44:47]
    s_waitcnt vmcnt(8) lgkmcnt(0)
    s_barrier
    ds_read_b128 a[84:87], v2 offset:16384
    v_mfma_f32_16x16x32_bf16 a[28:31], a[104:107], v[156:159], a[28:31]
    s_add_u32 m0, s44, 147456
    ds_read_b128 a[88:91], v3 offset:16384
    ds_read_b128 a[92:95], v48 offset:16384
    v_mfma_f32_16x16x32_bf16 a[28:31], a[100:103], v[220:223], a[28:31]
    ds_read_b128 a[96:99], v49 offset:16384
    v_cvt_pk_bf16_f32 v118, v84, v85
    v_mfma_f32_16x16x32_bf16 a[12:15], a[100:103], v[204:207], a[12:15]
    ds_read_b128 a[100:103], v2 offset:16896
    v_mfma_f32_16x16x32_bf16 a[12:15], a[104:107], v[140:143], a[12:15]
    v_exp_f32 v86, v86
    v_mfma_f32_16x16x32_bf16 a[248:251], a[104:107], v[188:191], a[248:251]
    ds_read_b128 a[104:107], v3 offset:16896
    v_mfma_f32_16x16x32_bf16 a[252:255], a[108:111], v[188:191], a[252:255]
    v_exp_f32 v87, v87
    v_mfma_f32_16x16x32_bf16 v[240:243], a[108:111], v[140:143], v[240:243]
    v_cvt_pk_bf16_f32 v119, v86, v87
    v_mfma_f32_16x16x32_bf16 v[240:243], a[112:115], v[204:207], v[240:243]
    buffer_load_dwordx4 v18, s[16:19], s90 offen offset:0 nt lds
    v_mfma_f32_16x16x32_bf16 v[244:247], a[112:115], v[220:223], v[244:247]
    v_exp_f32 v88, v88
    v_mfma_f32_16x16x32_bf16 v[244:247], a[108:111], v[156:159], v[244:247]
    v_exp_f32 v89, v89
    v_mfma_f32_16x16x32_bf16 v[248:251], a[108:111], v[172:175], v[248:251]
    s_waitcnt lgkmcnt(2)
    ds_read_b128 a[108:111], v48 offset:16896
    v_cvt_pk_bf16_f32 v122, v88, v89
    v_mfma_f32_16x16x32_bf16 v[248:251], a[112:115], v[236:239], v[248:251]
    ds_read_b128 a[112:115], v49 offset:16896
    v_mfma_f32_16x16x32_bf16 v[64:67], a[84:87], v[128:131], 0
    v_exp_f32 v90, v90
    v_mfma_f32_16x16x32_bf16 v[64:67], a[88:91], v[160:163], v[64:67]
    v_exp_f32 v91, v91
    v_mfma_f32_16x16x32_bf16 v[64:67], a[92:95], v[192:195], v[64:67]
    v_cvt_pk_bf16_f32 v123, v90, v91
    v_mfma_f32_16x16x32_bf16 v[64:67], a[96:99], v[224:227], v[64:67]
    v_mfma_f32_16x16x32_bf16 v[68:71], a[96:99], v[228:231], 0
    v_mfma_f32_16x16x32_bf16 v[68:71], a[92:95], v[196:199], v[68:71]
    v_mfma_f32_16x16x32_bf16 v[68:71], a[88:91], v[164:167], v[68:71]
    v_mfma_f32_16x16x32_bf16 v[68:71], a[84:87], v[132:135], v[68:71]
    v_mfma_f32_16x16x32_bf16 v[72:75], a[84:87], v[136:139], 0
    buffer_load_dwordx4 v19, s[16:19], s90 offen offset:1024 nt lds
    v_mfma_f32_16x16x32_bf16 v[72:75], a[88:91], v[168:171], v[72:75]
    v_mfma_f32_16x16x32_bf16 v[72:75], a[92:95], v[200:203], v[72:75]
    v_exp_f32 v64, v64
    v_mfma_f32_16x16x32_bf16 v[72:75], a[96:99], v[232:235], v[72:75]
    v_exp_f32 v65, v65
    v_mfma_f32_16x16x32_bf16 v[76:79], a[96:99], a[60:63], 0
    ds_read_b64_tr_b16 a[96:97], v11 offset:16384
    ds_read_b64_tr_b16 a[98:99], v11 offset:16896
    v_mfma_f32_16x16x32_bf16 v[76:79], a[92:95], a[56:59], v[76:79]
    ds_read_b64_tr_b16 a[92:93], v7 offset:16384
    ds_read_b64_tr_b16 a[94:95], v7 offset:16896
    v_mfma_f32_16x16x32_bf16 v[76:79], a[88:91], a[52:55], v[76:79]
    s_waitcnt lgkmcnt(4)
    ds_read_b64_tr_b16 a[88:89], v6 offset:16384
    ds_read_b64_tr_b16 a[90:91], v6 offset:16896
    v_mfma_f32_16x16x32_bf16 v[76:79], a[84:87], a[48:51], v[76:79]
    ds_read_b64_tr_b16 a[84:85], v10 offset:16384
    ds_read_b64_tr_b16 a[86:87], v10 offset:16896
    v_mfma_f32_16x16x32_bf16 v[80:83], a[100:103], v[128:131], 0
    v_exp_f32 v66, v66
    v_mfma_f32_16x16x32_bf16 v[80:83], a[104:107], v[160:163], v[80:83]
    v_exp_f32 v67, v67
    v_mfma_f32_16x16x32_bf16 v[80:83], a[108:111], v[192:195], v[80:83]
    v_cvt_pk_bf16_f32 v140, v64, v65
    v_cvt_pk_bf16_f32 v141, v66, v67
    v_mfma_f32_16x16x32_bf16 v[80:83], a[112:115], v[224:227], v[80:83]
    v_exp_f32 v68, v68
    v_mfma_f32_16x16x32_bf16 v[84:87], a[112:115], v[228:231], 0
    v_exp_f32 v69, v69
    v_mfma_f32_16x16x32_bf16 v[84:87], a[108:111], v[196:199], v[84:87]
    buffer_load_dwordx4 v20, s[16:19], s90 offen offset:2048 nt lds
    v_mfma_f32_16x16x32_bf16 v[84:87], a[104:107], v[164:167], v[84:87]
    v_exp_f32 v70, v70
    v_mfma_f32_16x16x32_bf16 v[84:87], a[100:103], v[132:135], v[84:87]
    v_exp_f32 v71, v71
    v_mfma_f32_16x16x32_bf16 v[88:91], a[100:103], v[136:139], 0
    v_cvt_pk_bf16_f32 v156, v68, v69
    v_cvt_pk_bf16_f32 v157, v70, v71
    v_mfma_f32_16x16x32_bf16 v[88:91], a[104:107], v[168:171], v[88:91]
    v_exp_f32 v72, v72
    v_mfma_f32_16x16x32_bf16 v[88:91], a[108:111], v[200:203], v[88:91]
    v_exp_f32 v73, v73
    v_mfma_f32_16x16x32_bf16 v[88:91], a[112:115], v[232:235], v[88:91]
    v_exp_f32 v74, v74
    v_mfma_f32_16x16x32_bf16 v[92:95], a[112:115], a[60:63], 0
    ds_read_b64_tr_b16 a[112:113], v13 offset:16384
    ds_read_b64_tr_b16 a[114:115], v13 offset:16896
    v_mfma_f32_16x16x32_bf16 v[92:95], a[108:111], a[56:59], v[92:95]
    ds_read_b64_tr_b16 a[108:109], v9 offset:16384
    ds_read_b64_tr_b16 a[110:111], v9 offset:16896
    v_mfma_f32_16x16x32_bf16 v[92:95], a[104:107], a[52:55], v[92:95]
    ds_read_b64_tr_b16 a[104:105], v8 offset:16384
    ds_read_b64_tr_b16 a[106:107], v8 offset:16896
    v_mfma_f32_16x16x32_bf16 v[92:95], a[100:103], a[48:51], v[92:95]
    ds_read_b64_tr_b16 a[100:101], v12 offset:16384
    ds_read_b64_tr_b16 a[102:103], v12 offset:16896
    v_mfma_f32_16x16x32_bf16 a[76:79], a[80:83], v[108:111], a[76:79]
    v_exp_f32 v75, v75
    v_mfma_f32_16x16x32_bf16 a[64:67], a[80:83], v[96:99], a[64:67]
    v_cvt_pk_bf16_f32 v172, v72, v73
    v_cvt_pk_bf16_f32 v173, v74, v75
    v_mfma_f32_16x16x32_bf16 a[64:67], a[80:83], v[112:115], a[64:67]
    buffer_load_dwordx4 v21, s[16:19], s90 offen offset:3072 nt lds
    v_mfma_f32_16x16x32_bf16 a[68:71], a[80:83], v[116:119], a[68:71]
    s_add_u32 m0, s44, 49152
    v_exp_f32 v80, v80
    v_mfma_f32_16x16x32_bf16 a[68:71], a[80:83], v[100:103], a[68:71]
    v_exp_f32 v81, v81
    v_mfma_f32_16x16x32_bf16 a[72:75], a[80:83], v[104:107], a[72:75]
    s_waitcnt lgkmcnt(6)
    v_exp_f32 v82, v82
    v_mfma_f32_16x16x32_bf16 a[72:75], a[80:83], v[120:123], a[72:75]
    v_exp_f32 v83, v83
    v_mfma_f32_16x16x32_bf16 a[32:35], a[84:87], v[120:123], a[32:35]
    v_cvt_pk_bf16_f32 v142, v80, v81
    v_cvt_pk_bf16_f32 v143, v82, v83
    v_mfma_f32_16x16x32_bf16 a[32:35], a[88:91], v[104:107], a[32:35]
    v_exp_f32 v84, v84
    v_mfma_f32_16x16x32_bf16 a[16:19], a[88:91], v[100:103], a[16:19]
    v_exp_f32 v85, v85
    v_mfma_f32_16x16x32_bf16 a[16:19], a[84:87], v[116:119], a[16:19]
    v_exp_f32 v86, v86
    v_mfma_f32_16x16x32_bf16 a[0:3], a[84:87], v[112:115], a[0:3]
    ds_read_b128 a[84:87], v4 offset:16384
    v_cvt_pk_bf16_f32 v158, v84, v85
    v_mfma_f32_16x16x32_bf16 a[0:3], a[88:91], v[96:99], a[0:3]
    v_exp_f32 v87, v87
    v_mfma_f32_16x16x32_bf16 a[224:227], a[88:91], v[108:111], a[224:227]
    ds_read_b128 a[88:91], v5 offset:16384
    v_cvt_pk_bf16_f32 v159, v86, v87
    v_mfma_f32_16x16x32_bf16 a[228:231], a[92:95], v[108:111], a[228:231]
    v_exp_f32 v88, v88
    v_mfma_f32_16x16x32_bf16 v[144:147], a[92:95], v[96:99], v[144:147]
    buffer_load_dwordx4 v14, s[12:15], s91 offen offset:0 nt lds
    v_mfma_f32_16x16x32_bf16 v[144:147], a[96:99], v[112:115], v[144:147]
    v_exp_f32 v89, v89
    v_mfma_f32_16x16x32_bf16 v[148:151], a[96:99], v[116:119], v[148:151]
    v_exp_f32 v90, v90
    v_mfma_f32_16x16x32_bf16 v[148:151], a[92:95], v[100:103], v[148:151]
    v_exp_f32 v91, v91
    v_mfma_f32_16x16x32_bf16 v[152:155], a[92:95], v[104:107], v[152:155]
    s_waitcnt lgkmcnt(2)
    ds_read_b128 a[92:95], v50 offset:16384
    v_cvt_pk_bf16_f32 v174, v88, v89
    v_mfma_f32_16x16x32_bf16 v[152:155], a[96:99], v[120:123], v[152:155]
    ds_read_b128 a[96:99], v51 offset:16384
    v_cvt_pk_bf16_f32 v175, v90, v91
    v_mfma_f32_16x16x32_bf16 a[36:39], a[100:103], v[120:123], a[36:39]
    v_exp_f32 v76, v76
    v_mfma_f32_16x16x32_bf16 a[36:39], a[104:107], v[104:107], a[36:39]
    v_exp_f32 v77, v77
    v_mfma_f32_16x16x32_bf16 a[20:23], a[104:107], v[100:103], a[20:23]
    v_exp_f32 v78, v78
    v_mfma_f32_16x16x32_bf16 a[20:23], a[100:103], v[116:119], a[20:23]
    v_exp_f32 v79, v79
    v_mfma_f32_16x16x32_bf16 a[4:7], a[100:103], v[112:115], a[4:7]
    ds_read_b128 a[100:103], v4 offset:16896
    v_cvt_pk_bf16_f32 v188, v76, v77
    v_mfma_f32_16x16x32_bf16 a[4:7], a[104:107], v[96:99], a[4:7]
    v_cvt_pk_bf16_f32 v189, v78, v79
    v_mfma_f32_16x16x32_bf16 a[232:235], a[104:107], v[108:111], a[232:235]
    ds_read_b128 a[104:107], v5 offset:16896
    v_mfma_f32_16x16x32_bf16 a[236:239], a[108:111], v[108:111], a[236:239]
    buffer_load_dwordx4 v15, s[12:15], s91 offen offset:1024 nt lds
    v_mfma_f32_16x16x32_bf16 v[176:179], a[108:111], v[96:99], v[176:179]
    v_exp_f32 v92, v92
    v_mfma_f32_16x16x32_bf16 v[176:179], a[112:115], v[112:115], v[176:179]
    v_exp_f32 v93, v93
    v_mfma_f32_16x16x32_bf16 v[180:183], a[112:115], v[116:119], v[180:183]
    v_exp_f32 v94, v94
    v_mfma_f32_16x16x32_bf16 v[180:183], a[108:111], v[100:103], v[180:183]
    v_exp_f32 v95, v95
    v_mfma_f32_16x16x32_bf16 v[184:187], a[108:111], v[104:107], v[184:187]
    s_waitcnt lgkmcnt(2)
    ds_read_b128 a[108:111], v50 offset:16896
    v_cvt_pk_bf16_f32 v190, v92, v93
    v_mfma_f32_16x16x32_bf16 v[184:187], a[112:115], v[120:123], v[184:187]
    ds_read_b128 a[112:115], v51 offset:16896
    v_cvt_pk_bf16_f32 v191, v94, v95
    v_mfma_f32_16x16x32_bf16 v[64:67], a[84:87], v[128:131], 0
    v_mfma_f32_16x16x32_bf16 v[64:67], a[88:91], v[160:163], v[64:67]
    v_mfma_f32_16x16x32_bf16 v[64:67], a[92:95], v[192:195], v[64:67]
    v_mfma_f32_16x16x32_bf16 v[64:67], a[96:99], v[224:227], v[64:67]
    v_mfma_f32_16x16x32_bf16 v[68:71], a[96:99], v[228:231], 0
    v_mfma_f32_16x16x32_bf16 v[68:71], a[92:95], v[196:199], v[68:71]
    v_mfma_f32_16x16x32_bf16 v[68:71], a[88:91], v[164:167], v[68:71]
    buffer_load_dwordx4 v16, s[12:15], s91 offen offset:2048 nt lds
    v_mfma_f32_16x16x32_bf16 v[68:71], a[84:87], v[132:135], v[68:71]
    v_mfma_f32_16x16x32_bf16 v[72:75], a[84:87], v[136:139], 0
    ds_read_b64_tr_b16 a[84:85], v10 offset:17408
    ds_read_b64_tr_b16 a[86:87], v10 offset:17920
    v_mfma_f32_16x16x32_bf16 v[72:75], a[88:91], v[168:171], v[72:75]
    ds_read_b64_tr_b16 a[88:89], v6 offset:17408
    ds_read_b64_tr_b16 a[90:91], v6 offset:17920
    v_mfma_f32_16x16x32_bf16 v[72:75], a[92:95], v[200:203], v[72:75]
    s_waitcnt lgkmcnt(4)
    ds_read_b64_tr_b16 a[92:93], v7 offset:17408
    ds_read_b64_tr_b16 a[94:95], v7 offset:17920
    v_mfma_f32_16x16x32_bf16 v[72:75], a[96:99], v[232:235], v[72:75]
    ds_read_b64_tr_b16 a[96:97], v11 offset:17408
    ds_read_b64_tr_b16 a[98:99], v11 offset:17920
    v_mfma_f32_16x16x32_bf16 v[80:83], a[100:103], v[128:131], 0
    v_exp_f32 v64, v64
    v_mfma_f32_16x16x32_bf16 v[80:83], a[104:107], v[160:163], v[80:83]
    v_exp_f32 v65, v65
    v_mfma_f32_16x16x32_bf16 v[80:83], a[108:111], v[192:195], v[80:83]
    v_exp_f32 v66, v66
    v_mfma_f32_16x16x32_bf16 v[80:83], a[112:115], v[224:227], v[80:83]
    v_exp_f32 v67, v67
    v_mfma_f32_16x16x32_bf16 v[84:87], a[112:115], v[228:231], 0
    v_cvt_pk_bf16_f32 v204, v64, v65
    v_cvt_pk_bf16_f32 v205, v66, v67
    v_mfma_f32_16x16x32_bf16 v[84:87], a[108:111], v[196:199], v[84:87]
    v_exp_f32 v68, v68
    v_mfma_f32_16x16x32_bf16 v[84:87], a[104:107], v[164:167], v[84:87]
    v_exp_f32 v69, v69
    v_mfma_f32_16x16x32_bf16 v[84:87], a[100:103], v[132:135], v[84:87]
    buffer_load_dwordx4 v17, s[12:15], s91 offen offset:3072 nt lds
    v_mfma_f32_16x16x32_bf16 v[88:91], a[100:103], v[136:139], 0
    ds_read_b64_tr_b16 a[100:101], v12 offset:17408
    ds_read_b64_tr_b16 a[102:103], v12 offset:17920
    v_mfma_f32_16x16x32_bf16 v[88:91], a[104:107], v[168:171], v[88:91]
    ds_read_b64_tr_b16 a[104:105], v8 offset:17408
    ds_read_b64_tr_b16 a[106:107], v8 offset:17920
    v_mfma_f32_16x16x32_bf16 v[88:91], a[108:111], v[200:203], v[88:91]
    s_waitcnt lgkmcnt(4)
    ds_read_b64_tr_b16 a[108:109], v9 offset:17408
    ds_read_b64_tr_b16 a[110:111], v9 offset:17920
    v_mfma_f32_16x16x32_bf16 v[88:91], a[112:115], v[232:235], v[88:91]
    ds_read_b64_tr_b16 a[112:113], v13 offset:17408
    ds_read_b64_tr_b16 a[114:115], v13 offset:17920
    v_mfma_f32_16x16x32_bf16 a[40:43], a[84:87], v[120:123], a[40:43]
    v_exp_f32 v70, v70
    v_mfma_f32_16x16x32_bf16 a[40:43], a[88:91], v[104:107], a[40:43]
    v_exp_f32 v71, v71
    v_mfma_f32_16x16x32_bf16 a[24:27], a[88:91], v[100:103], a[24:27]
    v_cvt_pk_bf16_f32 v220, v68, v69
    v_cvt_pk_bf16_f32 v221, v70, v71
    v_mfma_f32_16x16x32_bf16 a[24:27], a[84:87], v[116:119], a[24:27]
    v_exp_f32 v72, v72
    v_mfma_f32_16x16x32_bf16 a[8:11], a[84:87], v[112:115], a[8:11]
    v_exp_f32 v73, v73
    v_mfma_f32_16x16x32_bf16 a[8:11], a[88:91], v[96:99], a[8:11]
    v_exp_f32 v74, v74
    v_mfma_f32_16x16x32_bf16 a[240:243], a[88:91], v[108:111], a[240:243]
    v_exp_f32 v75, v75
    v_mfma_f32_16x16x32_bf16 a[244:247], a[92:95], v[108:111], a[244:247]
    v_cvt_pk_bf16_f32 v236, v72, v73
    v_cvt_pk_bf16_f32 v237, v74, v75
    v_mfma_f32_16x16x32_bf16 v[208:211], a[92:95], v[96:99], v[208:211]
    v_exp_f32 v80, v80
    v_mfma_f32_16x16x32_bf16 v[208:211], a[96:99], v[112:115], v[208:211]
    v_exp_f32 v81, v81
    v_mfma_f32_16x16x32_bf16 v[212:215], a[96:99], v[116:119], v[212:215]
    v_exp_f32 v82, v82
    v_mfma_f32_16x16x32_bf16 v[212:215], a[92:95], v[100:103], v[212:215]
    v_exp_f32 v83, v83
    v_mfma_f32_16x16x32_bf16 v[216:219], a[92:95], v[104:107], v[216:219]
    s_waitcnt lgkmcnt(0)
    v_cvt_pk_bf16_f32 v206, v80, v81
    v_cvt_pk_bf16_f32 v207, v82, v83
    v_mfma_f32_16x16x32_bf16 v[216:219], a[96:99], v[120:123], v[216:219]
    v_exp_f32 v84, v84
    v_mfma_f32_16x16x32_bf16 a[44:47], a[100:103], v[120:123], a[44:47]
    v_exp_f32 v85, v85
    v_mfma_f32_16x16x32_bf16 a[44:47], a[104:107], v[104:107], a[44:47]
    s_waitcnt vmcnt(8) lgkmcnt(0)
    s_barrier
    ds_read_b128 a[84:87], v2 offset:32768
    v_mfma_f32_16x16x32_bf16 a[28:31], a[104:107], v[100:103], a[28:31]
    s_add_u32 m0, s44, 98304
    ds_read_b128 a[88:91], v3 offset:32768
    ds_read_b128 a[92:95], v48 offset:32768
    v_mfma_f32_16x16x32_bf16 a[28:31], a[100:103], v[116:119], a[28:31]
    s_add_u32 s58, s72, 0
    ds_read_b128 a[96:99], v49 offset:32768
    v_cvt_pk_bf16_f32 v222, v84, v85
    v_mfma_f32_16x16x32_bf16 a[12:15], a[100:103], v[112:115], a[12:15]
    ds_read_b128 a[100:103], v2 offset:33280
    v_mfma_f32_16x16x32_bf16 a[12:15], a[104:107], v[96:99], a[12:15]
    buffer_load_dwordx4 v18, s[16:19], s91 offen offset:0 nt lds
    v_mfma_f32_16x16x32_bf16 a[248:251], a[104:107], v[108:111], a[248:251]
    ds_read_b128 a[104:107], v3 offset:33280
    v_mfma_f32_16x16x32_bf16 a[252:255], a[108:111], v[108:111], a[252:255]
    v_exp_f32 v86, v86
    v_mfma_f32_16x16x32_bf16 v[240:243], a[108:111], v[96:99], v[240:243]
    v_exp_f32 v87, v87
    v_mfma_f32_16x16x32_bf16 v[240:243], a[112:115], v[112:115], v[240:243]
    v_cvt_pk_bf16_f32 v223, v86, v87
    v_mfma_f32_16x16x32_bf16 v[244:247], a[112:115], v[116:119], v[244:247]
    v_exp_f32 v88, v88
    v_mfma_f32_16x16x32_bf16 v[244:247], a[108:111], v[100:103], v[244:247]
    v_exp_f32 v89, v89
    v_mfma_f32_16x16x32_bf16 v[248:251], a[108:111], v[104:107], v[248:251]
    s_waitcnt lgkmcnt(2)
    ds_read_b128 a[108:111], v48 offset:33280
    v_cvt_pk_bf16_f32 v238, v88, v89
    v_mfma_f32_16x16x32_bf16 v[248:251], a[112:115], v[120:123], v[248:251]
    ds_read_b128 a[112:115], v49 offset:33280
    v_mfma_f32_16x16x32_bf16 v[64:67], a[84:87], v[128:131], 0
    v_exp_f32 v90, v90
    v_mfma_f32_16x16x32_bf16 v[64:67], a[88:91], v[160:163], v[64:67]
    v_exp_f32 v91, v91
    v_mfma_f32_16x16x32_bf16 v[64:67], a[92:95], v[192:195], v[64:67]
    v_cvt_pk_bf16_f32 v239, v90, v91
    v_mfma_f32_16x16x32_bf16 v[64:67], a[96:99], v[224:227], v[64:67]
    buffer_load_dwordx4 v19, s[16:19], s91 offen offset:1024 nt lds
    v_mfma_f32_16x16x32_bf16 v[68:71], a[96:99], v[228:231], 0
    v_mfma_f32_16x16x32_bf16 v[68:71], a[92:95], v[196:199], v[68:71]
    v_mfma_f32_16x16x32_bf16 v[68:71], a[88:91], v[164:167], v[68:71]
    v_mfma_f32_16x16x32_bf16 v[68:71], a[84:87], v[132:135], v[68:71]
    v_mfma_f32_16x16x32_bf16 v[72:75], a[84:87], v[136:139], 0
    v_mfma_f32_16x16x32_bf16 v[72:75], a[88:91], v[168:171], v[72:75]
    v_mfma_f32_16x16x32_bf16 v[72:75], a[92:95], v[200:203], v[72:75]
    v_exp_f32 v64, v64
    v_mfma_f32_16x16x32_bf16 v[72:75], a[96:99], v[232:235], v[72:75]
    v_exp_f32 v65, v65
    v_mfma_f32_16x16x32_bf16 v[76:79], a[96:99], a[60:63], 0
    buffer_load_dwordx4 v20, s[16:19], s91 offen offset:2048 nt lds
    v_mfma_f32_16x16x32_bf16 v[76:79], a[92:95], a[56:59], v[76:79]
    ds_read_b64_tr_b16 a[92:93], v7 offset:32768
    ds_read_b64_tr_b16 a[94:95], v7 offset:33280
    v_mfma_f32_16x16x32_bf16 v[76:79], a[88:91], a[52:55], v[76:79]
    s_waitcnt lgkmcnt(2)
    ds_read_b64_tr_b16 a[88:89], v6 offset:32768
    ds_read_b64_tr_b16 a[90:91], v6 offset:33280
    v_mfma_f32_16x16x32_bf16 v[76:79], a[84:87], a[48:51], v[76:79]
    ds_read_b64_tr_b16 a[84:85], v10 offset:32768
    ds_read_b64_tr_b16 a[86:87], v10 offset:33280
    v_mfma_f32_16x16x32_bf16 v[80:83], a[100:103], v[128:131], 0
    ds_read_b64_tr_b16 a[96:97], v11 offset:32768
    ds_read_b64_tr_b16 a[98:99], v11 offset:33280
    v_mfma_f32_16x16x32_bf16 v[80:83], a[104:107], v[160:163], v[80:83]
    v_exp_f32 v66, v66
    v_mfma_f32_16x16x32_bf16 v[80:83], a[108:111], v[192:195], v[80:83]
    v_exp_f32 v67, v67
    v_mfma_f32_16x16x32_bf16 v[80:83], a[112:115], v[224:227], v[80:83]
    v_cvt_pk_bf16_f32 v96, v64, v65
    v_cvt_pk_bf16_f32 v97, v66, v67
    v_mfma_f32_16x16x32_bf16 v[84:87], a[112:115], v[228:231], 0
    v_exp_f32 v68, v68
    v_mfma_f32_16x16x32_bf16 v[84:87], a[108:111], v[196:199], v[84:87]
    buffer_load_dwordx4 v21, s[16:19], s91 offen offset:3072 nt lds
    v_mfma_f32_16x16x32_bf16 v[84:87], a[104:107], v[164:167], v[84:87]
    s_add_u32 m0, s44, 114688
    v_exp_f32 v69, v69
    v_mfma_f32_16x16x32_bf16 v[84:87], a[100:103], v[132:135], v[84:87]
    v_exp_f32 v70, v70
    v_mfma_f32_16x16x32_bf16 v[88:91], a[100:103], v[136:139], 0
    v_exp_f32 v71, v71
    v_mfma_f32_16x16x32_bf16 v[88:91], a[104:107], v[168:171], v[88:91]
    v_cvt_pk_bf16_f32 v100, v68, v69
    v_cvt_pk_bf16_f32 v101, v70, v71
    v_mfma_f32_16x16x32_bf16 v[88:91], a[108:111], v[200:203], v[88:91]
    v_exp_f32 v72, v72
    v_mfma_f32_16x16x32_bf16 v[88:91], a[112:115], v[232:235], v[88:91]
    v_exp_f32 v73, v73
    v_mfma_f32_16x16x32_bf16 v[92:95], a[112:115], a[60:63], 0
    ds_read_b64_tr_b16 a[112:113], v13 offset:32768
    ds_read_b64_tr_b16 a[114:115], v13 offset:33280
    v_mfma_f32_16x16x32_bf16 v[92:95], a[108:111], a[56:59], v[92:95]
    ds_read_b64_tr_b16 a[108:109], v9 offset:32768
    ds_read_b64_tr_b16 a[110:111], v9 offset:33280
    v_mfma_f32_16x16x32_bf16 v[92:95], a[104:107], a[52:55], v[92:95]
    ds_read_b64_tr_b16 a[104:105], v8 offset:32768
    ds_read_b64_tr_b16 a[106:107], v8 offset:33280
    v_mfma_f32_16x16x32_bf16 v[92:95], a[100:103], a[48:51], v[92:95]
    ds_read_b64_tr_b16 a[100:101], v12 offset:32768
    ds_read_b64_tr_b16 a[102:103], v12 offset:33280
    v_mfma_f32_16x16x32_bf16 a[76:79], a[80:83], v[188:191], a[76:79]
    buffer_load_dwordx4 v44, s[24:27], s58 offen offset:0 lds
    v_mfma_f32_16x16x32_bf16 a[64:67], a[80:83], v[140:143], a[64:67]
    v_exp_f32 v74, v74
    v_mfma_f32_16x16x32_bf16 a[64:67], a[80:83], v[204:207], a[64:67]
    v_exp_f32 v75, v75
    v_mfma_f32_16x16x32_bf16 a[68:71], a[80:83], v[220:223], a[68:71]
    v_cvt_pk_bf16_f32 v104, v72, v73
    v_cvt_pk_bf16_f32 v105, v74, v75
    v_mfma_f32_16x16x32_bf16 a[68:71], a[80:83], v[156:159], a[68:71]
    v_exp_f32 v80, v80
    v_mfma_f32_16x16x32_bf16 a[72:75], a[80:83], v[172:175], a[72:75]
    s_waitcnt lgkmcnt(6)
    v_exp_f32 v81, v81
    v_mfma_f32_16x16x32_bf16 a[72:75], a[80:83], v[236:239], a[72:75]
    v_exp_f32 v82, v82
    v_mfma_f32_16x16x32_bf16 a[32:35], a[84:87], v[236:239], a[32:35]
    v_exp_f32 v83, v83
    v_mfma_f32_16x16x32_bf16 a[32:35], a[88:91], v[172:175], a[32:35]
    v_cvt_pk_bf16_f32 v98, v80, v81
    v_cvt_pk_bf16_f32 v99, v82, v83
    v_mfma_f32_16x16x32_bf16 a[16:19], a[88:91], v[156:159], a[16:19]
    buffer_load_dwordx4 v45, s[24:27], s58 offen offset:1024 lds
    v_mfma_f32_16x16x32_bf16 a[16:19], a[84:87], v[220:223], a[16:19]
    v_exp_f32 v84, v84
    v_mfma_f32_16x16x32_bf16 a[0:3], a[84:87], v[204:207], a[0:3]
    ds_read_b128 a[84:87], v4 offset:32768
    v_mfma_f32_16x16x32_bf16 a[0:3], a[88:91], v[140:143], a[0:3]
L_s4:
    s_cbranch_execz L_back
    v_exp_f32 v85, v85
    v_mfma_f32_16x16x32_bf16 a[224:227], a[88:91], v[188:191], a[224:227]
    ds_read_b128 a[88:91], v5 offset:32768
    v_cvt_pk_bf16_f32 v102, v84, v85
    v_mfma_f32_16x16x32_bf16 a[228:231], a[92:95], v[188:191], a[228:231]
    v_exp_f32 v86, v86
    v_mfma_f32_16x16x32_bf16 v[144:147], a[92:95], v[140:143], v[144:147]
    v_exp_f32 v87, v87
    v_mfma_f32_16x16x32_bf16 v[144:147], a[96:99], v[204:207], v[144:147]
    v_cvt_pk_bf16_f32 v103, v86, v87
    v_mfma_f32_16x16x32_bf16 v[148:151], a[96:99], v[220:223], v[148:151]
    v_exp_f32 v88, v88
    v_mfma_f32_16x16x32_bf16 v[148:151], a[92:95], v[156:159], v[148:151]
    buffer_load_dwordx4 v46, s[24:27], s58 offen offset:2048 lds
    v_mfma_f32_16x16x32_bf16 v[152:155], a[92:95], v[172:175], v[152:155]
    s_waitcnt lgkmcnt(2)
    ds_read_b128 a[92:95], v50 offset:32768
    v_mfma_f32_16x16x32_bf16 v[152:155], a[96:99], v[236:239], v[152:155]
    ds_read_b128 a[96:99], v51 offset:32768
    v_mfma_f32_16x16x32_bf16 a[36:39], a[100:103], v[236:239], a[36:39]
    v_exp_f32 v89, v89
    v_mfma_f32_16x16x32_bf16 a[36:39], a[104:107], v[172:175], a[36:39]
    v_exp_f32 v90, v90
    v_mfma_f32_16x16x32_bf16 a[20:23], a[104:107], v[156:159], a[20:23]
    v_exp_f32 v91, v91
    v_mfma_f32_16x16x32_bf16 a[20:23], a[100:103], v[220:223], a[20:23]
    v_cvt_pk_bf16_f32 v106, v88, v89
    v_cvt_pk_bf16_f32 v107, v90, v91
    v_mfma_f32_16x16x32_bf16 a[4:7], a[100:103], v[204:207], a[4:7]
    ds_read_b128 a[100:103], v4 offset:33280
    v_mfma_f32_16x16x32_bf16 a[4:7], a[104:107], v[140:143], a[4:7]
    v_exp_f32 v76, v76
    v_mfma_f32_16x16x32_bf16 a[232:235], a[104:107], v[188:191], a[232:235]
    ds_read_b128 a[104:107], v5 offset:33280
    v_mfma_f32_16x16x32_bf16 a[236:239], a[108:111], v[188:191], a[236:239]
    buffer_load_dwordx4 v47, s[24:27], s58 offen offset:3072 lds
    v_mfma_f32_16x16x32_bf16 v[176:179], a[108:111], v[140:143], v[176:179]
    s_add_u32 s58, s72, 32768
    v_exp_f32 v77, v77
    v_mfma_f32_16x16x32_bf16 v[176:179], a[112:115], v[204:207], v[176:179]
    s_add_u32 m0, s44, 16384
    v_exp_f32 v78, v78
    v_mfma_f32_16x16x32_bf16 v[180:183], a[112:115], v[220:223], v[180:183]
    v_exp_f32 v79, v79
    v_mfma_f32_16x16x32_bf16 v[180:183], a[108:111], v[156:159], v[180:183]
    v_cvt_pk_bf16_f32 v108, v76, v77
    v_cvt_pk_bf16_f32 v109, v78, v79
    v_mfma_f32_16x16x32_bf16 v[184:187], a[108:111], v[172:175], v[184:187]
    s_waitcnt lgkmcnt(2)
    ds_read_b128 a[108:111], v50 offset:33280
    v_mfma_f32_16x16x32_bf16 v[184:187], a[112:115], v[236:239], v[184:187]
    ds_read_b128 a[112:115], v51 offset:33280
    v_mfma_f32_16x16x32_bf16 v[64:67], a[84:87], v[128:131], 0
    v_exp_f32 v92, v92
    v_mfma_f32_16x16x32_bf16 v[64:67], a[88:91], v[160:163], v[64:67]
    v_exp_f32 v93, v93
    v_mfma_f32_16x16x32_bf16 v[64:67], a[92:95], v[192:195], v[64:67]
    buffer_load_dwordx4 v44, s[24:27], s58 offen offset:0 lds
    v_mfma_f32_16x16x32_bf16 v[64:67], a[96:99], v[224:227], v[64:67]
    v_exp_f32 v94, v94
    v_mfma_f32_16x16x32_bf16 v[68:71], a[96:99], v[228:231], 0
    v_exp_f32 v95, v95
    v_mfma_f32_16x16x32_bf16 v[68:71], a[92:95], v[196:199], v[68:71]
    v_cvt_pk_bf16_f32 v110, v92, v93
    v_cvt_pk_bf16_f32 v111, v94, v95
    v_mfma_f32_16x16x32_bf16 v[68:71], a[88:91], v[164:167], v[68:71]
    v_mfma_f32_16x16x32_bf16 v[68:71], a[84:87], v[132:135], v[68:71]
    v_exp_f32 v64, v64
    v_mfma_f32_16x16x32_bf16 v[72:75], a[84:87], v[136:139], 0
    ds_read_b64_tr_b16 a[84:85], v10 offset:33792
    ds_read_b64_tr_b16 a[86:87], v10 offset:34304
    v_mfma_f32_16x16x32_bf16 v[72:75], a[88:91], v[168:171], v[72:75]
    ds_read_b64_tr_b16 a[88:89], v6 offset:33792
    ds_read_b64_tr_b16 a[90:91], v6 offset:34304
    v_mfma_f32_16x16x32_bf16 v[72:75], a[92:95], v[200:203], v[72:75]
    s_waitcnt lgkmcnt(4)
    ds_read_b64_tr_b16 a[92:93], v7 offset:33792
    ds_read_b64_tr_b16 a[94:95], v7 offset:34304
    v_mfma_f32_16x16x32_bf16 v[72:75], a[96:99], v[232:235], v[72:75]
    ds_read_b64_tr_b16 a[96:97], v11 offset:33792
    ds_read_b64_tr_b16 a[98:99], v11 offset:34304
    v_mfma_f32_16x16x32_bf16 v[80:83], a[100:103], v[128:131], 0
    buffer_load_dwordx4 v45, s[24:27], s58 offen offset:1024 lds
    v_mfma_f32_16x16x32_bf16 v[80:83], a[104:107], v[160:163], v[80:83]
    v_exp_f32 v65, v65
    v_mfma_f32_16x16x32_bf16 v[80:83], a[108:111], v[192:195], v[80:83]
    v_exp_f32 v66, v66
    v_mfma_f32_16x16x32_bf16 v[80:83], a[112:115], v[224:227], v[80:83]
    v_exp_f32 v67, v67
    v_mfma_f32_16x16x32_bf16 v[84:87], a[112:115], v[228:231], 0
    v_cvt_pk_bf16_f32 v112, v64, v65
    v_cvt_pk_bf16_f32 v113, v66, v67
    v_mfma_f32_16x16x32_bf16 v[84:87], a[108:111], v[196:199], v[84:87]
    v_exp_f32 v68, v68
    v_mfma_f32_16x16x32_bf16 v[84:87], a[104:107], v[164:167], v[84:87]
    v_exp_f32 v69, v69
    v_mfma_f32_16x16x32_bf16 v[84:87], a[100:103], v[132:135], v[84:87]
    v_exp_f32 v70, v70
    v_mfma_f32_16x16x32_bf16 v[88:91], a[100:103], v[136:139], 0
    ds_read_b64_tr_b16 a[100:101], v12 offset:33792
    ds_read_b64_tr_b16 a[102:103], v12 offset:34304
    v_mfma_f32_16x16x32_bf16 v[88:91], a[104:107], v[168:171], v[88:91]
    ds_read_b64_tr_b16 a[104:105], v8 offset:33792
    ds_read_b64_tr_b16 a[106:107], v8 offset:34304
    v_mfma_f32_16x16x32_bf16 v[88:91], a[108:111], v[200:203], v[88:91]
    s_waitcnt lgkmcnt(4)
    buffer_load_dwordx4 v46, s[24:27], s58 offen offset:2048 lds
    v_mfma_f32_16x16x32_bf16 v[88:91], a[112:115], v[232:235], v[88:91]
    ds_read_b64_tr_b16 a[108:109], v9 offset:33792
    ds_read_b64_tr_b16 a[110:111], v9 offset:34304
    v_mfma_f32_16x16x32_bf16 a[40:43], a[84:87], v[236:239], a[40:43]
    ds_read_b64_tr_b16 a[112:113], v13 offset:33792
    ds_read_b64_tr_b16 a[114:115], v13 offset:34304
    v_mfma_f32_16x16x32_bf16 a[40:43], a[88:91], v[172:175], a[40:43]
    v_exp_f32 v71, v71
    v_mfma_f32_16x16x32_bf16 a[24:27], a[88:91], v[156:159], a[24:27]
    v_cvt_pk_bf16_f32 v116, v68, v69
    v_cvt_pk_bf16_f32 v117, v70, v71
    v_mfma_f32_16x16x32_bf16 a[24:27], a[84:87], v[220:223], a[24:27]
    v_exp_f32 v72, v72
    v_mfma_f32_16x16x32_bf16 a[8:11], a[84:87], v[204:207], a[8:11]
    v_exp_f32 v73, v73
    v_mfma_f32_16x16x32_bf16 a[8:11], a[88:91], v[140:143], a[8:11]
    v_exp_f32 v74, v74
    v_mfma_f32_16x16x32_bf16 a[240:243], a[88:91], v[188:191], a[240:243]
    v_exp_f32 v75, v75
    v_mfma_f32_16x16x32_bf16 a[244:247], a[92:95], v[188:191], a[244:247]
    buffer_load_dwordx4 v47, s[24:27], s58 offen offset:3072 lds
    v_mfma_f32_16x16x32_bf16 v[208:211], a[92:95], v[140:143], v[208:211]
    v_cvt_pk_bf16_f32 v120, v72, v73
    v_cvt_pk_bf16_f32 v121, v74, v75
    v_mfma_f32_16x16x32_bf16 v[208:211], a[96:99], v[204:207], v[208:211]
    v_exp_f32 v80, v80
    v_mfma_f32_16x16x32_bf16 v[212:215], a[96:99], v[220:223], v[212:215]
    v_exp_f32 v81, v81
    v_mfma_f32_16x16x32_bf16 v[212:215], a[92:95], v[156:159], v[212:215]
    v_exp_f32 v82, v82
    v_mfma_f32_16x16x32_bf16 v[216:219], a[92:95], v[172:175], v[216:219]
    s_waitcnt lgkmcnt(0)
    v_exp_f32 v83, v83
    v_mfma_f32_16x16x32_bf16 v[216:219], a[96:99], v[236:239], v[216:219]
    v_cvt_pk_bf16_f32 v114, v80, v81
    v_cvt_pk_bf16_f32 v115, v82, v83
    v_mfma_f32_16x16x32_bf16 a[44:47], a[100:103], v[236:239], a[44:47]
    v_exp_f32 v84, v84
    v_mfma_f32_16x16x32_bf16 a[44:47], a[104:107], v[172:175], a[44:47]
    s_waitcnt vmcnt(12) lgkmcnt(0)
    s_barrier
    ds_read_b128 a[84:87], v2 offset:49152
    v_mfma_f32_16x16x32_bf16 a[28:31], a[104:107], v[156:159], a[28:31]
    s_add_u32 s58, s72, 65536
    ds_read_b128 a[88:91], v3 offset:49152
    ds_read_b128 a[92:95], v48 offset:49152
    v_mfma_f32_16x16x32_bf16 a[28:31], a[100:103], v[220:223], a[28:31]
    s_add_u32 m0, s44, 32768
    ds_read_b128 a[96:99], v49 offset:49152
    v_mfma_f32_16x16x32_bf16 a[12:15], a[100:103], v[204:207], a[12:15]
    ds_read_b128 a[100:103], v2 offset:49664
    v_mfma_f32_16x16x32_bf16 a[12:15], a[104:107], v[140:143], a[12:15]
    buffer_load_dword v28, v25, s[32:35], 0 offen sc1
    v_mfma_f32_16x16x32_bf16 a[248:251], a[104:107], v[188:191], a[248:251]
    ds_read_b128 a[104:107], v3 offset:49664
    v_mfma_f32_16x16x32_bf16 a[252:255], a[108:111], v[188:191], a[252:255]
    v_exp_f32 v85, v85
    v_mfma_f32_16x16x32_bf16 v[240:243], a[108:111], v[140:143], v[240:243]
    v_exp_f32 v86, v86
    v_mfma_f32_16x16x32_bf16 v[240:243], a[112:115], v[204:207], v[240:243]
    v_exp_f32 v87, v87
    v_mfma_f32_16x16x32_bf16 v[244:247], a[112:115], v[220:223], v[244:247]
    v_cvt_pk_bf16_f32 v118, v84, v85
    v_cvt_pk_bf16_f32 v119, v86, v87
    v_mfma_f32_16x16x32_bf16 v[244:247], a[108:111], v[156:159], v[244:247]
    buffer_load_dwordx4 v44, s[24:27], s58 offen offset:0 lds
    v_mfma_f32_16x16x32_bf16 v[248:251], a[108:111], v[172:175], v[248:251]
    s_waitcnt lgkmcnt(2)
    ds_read_b128 a[108:111], v48 offset:49664
    s_waitcnt vmcnt(6)
    ds_read_b64_tr_b16 a[116:117], v40 offset:49152
    v_mfma_f32_16x16x32_bf16 v[248:251], a[112:115], v[236:239], v[248:251]
    ds_read_b128 a[112:115], v49 offset:49664
    ds_read_b64_tr_b16 a[118:119], v40 offset:51200
    v_mfma_f32_16x16x32_bf16 v[64:67], a[84:87], v[128:131], 0
    v_exp_f32 v88, v88
    v_mfma_f32_16x16x32_bf16 v[64:67], a[88:91], v[160:163], v[64:67]
    v_exp_f32 v89, v89
    v_mfma_f32_16x16x32_bf16 v[64:67], a[92:95], v[192:195], v[64:67]
    v_exp_f32 v90, v90
    v_mfma_f32_16x16x32_bf16 v[64:67], a[96:99], v[224:227], v[64:67]
    v_exp_f32 v91, v91
    v_mfma_f32_16x16x32_bf16 v[68:71], a[96:99], v[228:231], 0
    v_cvt_pk_bf16_f32 v122, v88, v89
    v_cvt_pk_bf16_f32 v123, v90, v91
    v_mfma_f32_16x16x32_bf16 v[68:71], a[92:95], v[196:199], v[68:71]
    buffer_load_dwordx4 v45, s[24:27], s58 offen offset:1024 lds
    v_mfma_f32_16x16x32_bf16 v[68:71], a[88:91], v[164:167], v[68:71]
    ds_read_b64_tr_b16 a[120:121], v41 offset:49152
    ds_read_b64_tr_b16 a[122:123], v41 offset:51200
    v_mfma_f32_16x16x32_bf16 v[68:71], a[84:87], v[132:135], v[68:71]
    v_exp_f32 v64, v64
    v_mfma_f32_16x16x32_bf16 v[72:75], a[84:87], v[136:139], 0
    v_exp_f32 v65, v65
    v_mfma_f32_16x16x32_bf16 v[72:75], a[88:91], v[168:171], v[72:75]
    v_exp_f32 v66, v66
    v_mfma_f32_16x16x32_bf16 v[72:75], a[92:95], v[200:203], v[72:75]
    buffer_load_dwordx4 v46, s[24:27], s58 offen offset:2048 lds
    v_mfma_f32_16x16x32_bf16 v[72:75], a[96:99], v[232:235], v[72:75]
    v_exp_f32 v67, v67
    v_mfma_f32_16x16x32_bf16 v[76:79], a[96:99], a[60:63], 0
    ds_read_b64_tr_b16 a[96:97], v11 offset:49152
    ds_read_b64_tr_b16 a[98:99], v11 offset:49664
    v_mfma_f32_16x16x32_bf16 v[76:79], a[92:95], a[56:59], v[76:79]
    ds_read_b64_tr_b16 a[92:93], v7 offset:49152
    ds_read_b64_tr_b16 a[94:95], v7 offset:49664
    v_mfma_f32_16x16x32_bf16 v[76:79], a[88:91], a[52:55], v[76:79]
    s_waitcnt lgkmcnt(6)
    ds_read_b64_tr_b16 a[88:89], v6 offset:49152
    ds_read_b64_tr_b16 a[90:91], v6 offset:49664
    v_mfma_f32_16x16x32_bf16 v[76:79], a[84:87], a[48:51], v[76:79]
    ds_read_b64_tr_b16 a[84:85], v10 offset:49152
    ds_read_b64_tr_b16 a[86:87], v10 offset:49664
    v_mfma_f32_16x16x32_bf16 v[80:83], a[100:103], v[128:131], 0
    buffer_load_dwordx4 v47, s[24:27], s58 offen offset:3072 lds
    v_mfma_f32_16x16x32_bf16 v[80:83], a[104:107], v[160:163], v[80:83]
    s_add_u32 s58, s72, 98304
    v_cvt_pk_bf16_f32 v140, v64, v65
    v_cvt_pk_bf16_f32 v141, v66, v67
    v_mfma_f32_16x16x32_bf16 v[80:83], a[108:111], v[192:195], v[80:83]
    s_add_u32 m0, s44, 0
    v_exp_f32 v68, v68
    v_mfma_f32_16x16x32_bf16 v[80:83], a[112:115], v[224:227], v[80:83]
    v_exp_f32 v69, v69
    v_mfma_f32_16x16x32_bf16 v[84:87], a[112:115], v[228:231], 0
    v_exp_f32 v70, v70
    v_mfma_f32_16x16x32_bf16 v[84:87], a[108:111], v[196:199], v[84:87]
    buffer_load_dwordx4 v44, s[24:27], s58 offen offset:0 lds
    v_mfma_f32_16x16x32_bf16 v[84:87], a[104:107], v[164:167], v[84:87]
    v_exp_f32 v71, v71
    v_mfma_f32_16x16x32_bf16 v[84:87], a[100:103], v[132:135], v[84:87]
    v_cvt_pk_bf16_f32 v156, v68, v69
    v_cvt_pk_bf16_f32 v157, v70, v71
    v_mfma_f32_16x16x32_bf16 v[88:91], a[100:103], v[136:139], 0
    v_exp_f32 v72, v72
    v_mfma_f32_16x16x32_bf16 v[88:91], a[104:107], v[168:171], v[88:91]
    v_exp_f32 v73, v73
    v_mfma_f32_16x16x32_bf16 v[88:91], a[108:111], v[200:203], v[88:91]
    buffer_load_dwordx4 v45, s[24:27], s58 offen offset:1024 lds
    v_mfma_f32_16x16x32_bf16 v[88:91], a[112:115], v[232:235], v[88:91]
    v_exp_f32 v74, v74
    v_mfma_f32_16x16x32_bf16 v[92:95], a[112:115], a[60:63], 0
    ds_read_b64_tr_b16 a[112:113], v13 offset:49152
    ds_read_b64_tr_b16 a[114:115], v13 offset:49664
    v_mfma_f32_16x16x32_bf16 v[92:95], a[108:111], a[56:59], v[92:95]
    ds_read_b64_tr_b16 a[108:109], v9 offset:49152
    ds_read_b64_tr_b16 a[110:111], v9 offset:49664
    v_mfma_f32_16x16x32_bf16 v[92:95], a[104:107], a[52:55], v[92:95]
    ds_read_b64_tr_b16 a[104:105], v8 offset:49152
    ds_read_b64_tr_b16 a[106:107], v8 offset:49664
    v_mfma_f32_16x16x32_bf16 v[92:95], a[100:103], a[48:51], v[92:95]
    ds_read_b64_tr_b16 a[100:101], v12 offset:49152
    ds_read_b64_tr_b16 a[102:103], v12 offset:49664
    v_mfma_f32_16x16x32_bf16 a[76:79], a[80:83], v[108:111], a[76:79]
    buffer_load_dwordx4 v46, s[24:27], s58 offen offset:2048 lds
    v_mfma_f32_16x16x32_bf16 a[64:67], a[80:83], v[96:99], a[64:67]
    v_exp_f32 v75, v75
    v_mfma_f32_16x16x32_bf16 a[64:67], a[80:83], v[112:115], a[64:67]
    v_cvt_pk_bf16_f32 v172, v72, v73
    v_cvt_pk_bf16_f32 v173, v74, v75
    v_mfma_f32_16x16x32_bf16 a[68:71], a[80:83], v[116:119], a[68:71]
    v_exp_f32 v80, v80
    v_mfma_f32_16x16x32_bf16 a[68:71], a[80:83], v[100:103], a[68:71]
    v_exp_f32 v81, v81
    v_mfma_f32_16x16x32_bf16 a[72:75], a[80:83], v[104:107], a[72:75]
    s_waitcnt lgkmcnt(6)
    buffer_load_dwordx4 v47, s[24:27], s58 offen offset:3072 lds
    v_mfma_f32_16x16x32_bf16 a[72:75], a[80:83], v[120:123], a[72:75]
    s_add_u32 s58, s73, 0
    v_exp_f32 v82, v82
    v_mfma_f32_16x16x32_bf16 a[32:35], a[84:87], v[120:123], a[32:35]
    s_add_u32 m0, s44, 81920
    v_exp_f32 v83, v83
    v_mfma_f32_16x16x32_bf16 a[32:35], a[88:91], v[104:107], a[32:35]
    v_cvt_pk_bf16_f32 v142, v80, v81
    v_cvt_pk_bf16_f32 v143, v82, v83
    v_mfma_f32_16x16x32_bf16 a[16:19], a[88:91], v[100:103], a[16:19]
    v_exp_f32 v84, v84
    v_mfma_f32_16x16x32_bf16 a[16:19], a[84:87], v[116:119], a[16:19]
    buffer_load_dwordx4 v44, s[24:27], s58 offen offset:0 lds
    v_mfma_f32_16x16x32_bf16 a[0:3], a[84:87], v[112:115], a[0:3]
    ds_read_b128 a[84:87], v4 offset:49152
    ds_read_b64_tr_b16 a[124:125], v42 offset:49152
    v_mfma_f32_16x16x32_bf16 a[0:3], a[88:91], v[96:99], a[0:3]
    v_exp_f32 v85, v85
    v_mfma_f32_16x16x32_bf16 a[224:227], a[88:91], v[108:111], a[224:227]
    ds_read_b128 a[88:91], v5 offset:49152
    v_cvt_pk_bf16_f32 v158, v84, v85
    v_mfma_f32_16x16x32_bf16 a[228:231], a[92:95], v[108:111], a[228:231]
    v_exp_f32 v86, v86
    v_mfma_f32_16x16x32_bf16 v[144:147], a[92:95], v[96:99], v[144:147]
    buffer_load_dwordx4 v45, s[24:27], s58 offen offset:1024 lds
    v_mfma_f32_16x16x32_bf16 v[144:147], a[96:99], v[112:115], v[144:147]
    v_exp_f32 v87, v87
    v_mfma_f32_16x16x32_bf16 v[148:151], a[96:99], v[116:119], v[148:151]
    v_cvt_pk_bf16_f32 v159, v86, v87
    ds_read_b64_tr_b16 a[126:127], v42 offset:51200
    v_mfma_f32_16x16x32_bf16 v[148:151], a[92:95], v[100:103], v[148:151]
    v_exp_f32 v88, v88
    v_mfma_f32_16x16x32_bf16 v[152:155], a[92:95], v[104:107], v[152:155]
    s_waitcnt lgkmcnt(4)
    ds_read_b128 a[92:95], v50 offset:49152
    ds_read_b64_tr_b16 a[128:129], v43 offset:49152
    v_mfma_f32_16x16x32_bf16 v[152:155], a[96:99], v[120:123], v[152:155]
    ds_read_b128 a[96:99], v51 offset:49152
    ds_read_b64_tr_b16 a[130:131], v43 offset:51200
    v_mfma_f32_16x16x32_bf16 a[36:39], a[100:103], v[120:123], a[36:39]
    buffer_load_dwordx4 v46, s[24:27], s58 offen offset:2048 lds
    v_mfma_f32_16x16x32_bf16 a[36:39], a[104:107], v[104:107], a[36:39]
    v_exp_f32 v89, v89
    v_mfma_f32_16x16x32_bf16 a[20:23], a[104:107], v[100:103], a[20:23]
    v_exp_f32 v90, v90
    v_mfma_f32_16x16x32_bf16 a[20:23], a[100:103], v[116:119], a[20:23]
    v_exp_f32 v91, v91
    v_mfma_f32_16x16x32_bf16 a[4:7], a[100:103], v[112:115], a[4:7]
    ds_read_b128 a[100:103], v4 offset:49664
    v_cvt_pk_bf16_f32 v174, v88, v89
    v_mfma_f32_16x16x32_bf16 a[4:7], a[104:107], v[96:99], a[4:7]
    buffer_load_dwordx4 v47, s[24:27], s58 offen offset:3072 lds
    v_mfma_f32_16x16x32_bf16 a[232:235], a[104:107], v[108:111], a[232:235]
    s_add_u32 s58, s73, 32768
    ds_read_b128 a[104:107], v5 offset:49664
    v_cvt_pk_bf16_f32 v175, v90, v91
    v_mfma_f32_16x16x32_bf16 a[236:239], a[108:111], v[108:111], a[236:239]
    s_add_u32 m0, s44, 65536
    v_exp_f32 v76, v76
    v_mfma_f32_16x16x32_bf16 v[176:179], a[108:111], v[96:99], v[176:179]
    v_exp_f32 v77, v77
    v_mfma_f32_16x16x32_bf16 v[176:179], a[112:115], v[112:115], v[176:179]
    v_exp_f32 v78, v78
    v_mfma_f32_16x16x32_bf16 v[180:183], a[112:115], v[116:119], v[180:183]
    buffer_load_dwordx4 v44, s[24:27], s58 offen offset:0 lds
    v_mfma_f32_16x16x32_bf16 v[180:183], a[108:111], v[100:103], v[180:183]
    v_exp_f32 v79, v79
    v_mfma_f32_16x16x32_bf16 v[184:187], a[108:111], v[104:107], v[184:187]
    s_waitcnt lgkmcnt(2)
    ds_read_b128 a[108:111], v50 offset:49664
    v_cvt_pk_bf16_f32 v188, v76, v77
    v_mfma_f32_16x16x32_bf16 v[184:187], a[112:115], v[120:123], v[184:187]
    ds_read_b128 a[112:115], v51 offset:49664
    v_cvt_pk_bf16_f32 v189, v78, v79
    v_mfma_f32_16x16x32_bf16 v[64:67], a[84:87], v[128:131], 0
    v_exp_f32 v92, v92
    v_mfma_f32_16x16x32_bf16 v[64:67], a[88:91], v[160:163], v[64:67]
    buffer_load_dwordx4 v45, s[24:27], s58 offen offset:1024 lds
    v_mfma_f32_16x16x32_bf16 v[64:67], a[92:95], v[192:195], v[64:67]
    v_exp_f32 v93, v93
    v_mfma_f32_16x16x32_bf16 v[64:67], a[96:99], v[224:227], v[64:67]
    v_exp_f32 v94, v94
    v_mfma_f32_16x16x32_bf16 v[68:71], a[96:99], v[228:231], 0
    v_exp_f32 v95, v95
    v_mfma_f32_16x16x32_bf16 v[68:71], a[92:95], v[196:199], v[68:71]
    v_cvt_pk_bf16_f32 v190, v92, v93
    v_cvt_pk_bf16_f32 v191, v94, v95
    v_mfma_f32_16x16x32_bf16 v[68:71], a[88:91], v[164:167], v[68:71]
    buffer_load_dwordx4 v46, s[24:27], s58 offen offset:2048 lds
    v_mfma_f32_16x16x32_bf16 v[68:71], a[84:87], v[132:135], v[68:71]
    v_exp_f32 v64, v64
    v_mfma_f32_16x16x32_bf16 v[72:75], a[84:87], v[136:139], 0
    ds_read_b64_tr_b16 a[84:85], v10 offset:50176
    ds_read_b64_tr_b16 a[86:87], v10 offset:50688
    v_mfma_f32_16x16x32_bf16 v[72:75], a[88:91], v[168:171], v[72:75]
    ds_read_b64_tr_b16 a[88:89], v6 offset:50176
    ds_read_b64_tr_b16 a[90:91], v6 offset:50688
    v_mfma_f32_16x16x32_bf16 v[72:75], a[92:95], v[200:203], v[72:75]
    s_waitcnt lgkmcnt(4)
    ds_read_b64_tr_b16 a[92:93], v7 offset:50176
    ds_read_b64_tr_b16 a[94:95], v7 offset:50688
    v_mfma_f32_16x16x32_bf16 v[72:75], a[96:99], v[232:235], v[72:75]
    ds_read_b64_tr_b16 a[96:97], v11 offset:50176
    ds_read_b64_tr_b16 a[98:99], v11 offset:50688
    v_mfma_f32_16x16x32_bf16 v[80:83], a[100:103], v[128:131], 0
    buffer_load_dwordx4 v47, s[24:27], s58 offen offset:3072 lds
    v_mfma_f32_16x16x32_bf16 v[80:83], a[104:107], v[160:163], v[80:83]
    s_add_u32 s58, s73, 65536
    v_exp_f32 v65, v65
    v_mfma_f32_16x16x32_bf16 v[80:83], a[108:111], v[192:195], v[80:83]
    s_add_u32 m0, s44, 114688
    v_exp_f32 v66, v66
    v_mfma_f32_16x16x32_bf16 v[80:83], a[112:115], v[224:227], v[80:83]
    v_exp_f32 v67, v67
    v_mfma_f32_16x16x32_bf16 v[84:87], a[112:115], v[228:231], 0
    v_cvt_pk_bf16_f32 v204, v64, v65
    v_cvt_pk_bf16_f32 v205, v66, v67
    v_mfma_f32_16x16x32_bf16 v[84:87], a[108:111], v[196:199], v[84:87]
    buffer_load_dwordx4 v44, s[24:27], s58 offen offset:0 lds
    v_mfma_f32_16x16x32_bf16 v[84:87], a[104:107], v[164:167], v[84:87]
    v_exp_f32 v68, v68
    v_mfma_f32_16x16x32_bf16 v[84:87], a[100:103], v[132:135], v[84:87]
    v_exp_f32 v80, v80
    v_mfma_f32_16x16x32_bf16 v[88:91], a[100:103], v[136:139], 0
    ds_read_b64_tr_b16 a[100:101], v12 offset:50176
    ds_read_b64_tr_b16 a[102:103], v12 offset:50688
    v_mfma_f32_16x16x32_bf16 v[88:91], a[104:107], v[168:171], v[88:91]
    ds_read_b64_tr_b16 a[104:105], v8 offset:50176
    ds_read_b64_tr_b16 a[106:107], v8 offset:50688
    v_mfma_f32_16x16x32_bf16 v[88:91], a[108:111], v[200:203], v[88:91]
    s_waitcnt lgkmcnt(4)
    ds_read_b64_tr_b16 a[108:109], v9 offset:50176
    ds_read_b64_tr_b16 a[110:111], v9 offset:50688
    v_mfma_f32_16x16x32_bf16 v[88:91], a[112:115], v[232:235], v[88:91]
    ds_read_b64_tr_b16 a[112:113], v13 offset:50176
    ds_read_b64_tr_b16 a[114:115], v13 offset:50688
    v_mfma_f32_16x16x32_bf16 a[40:43], a[84:87], v[120:123], a[40:43]
    buffer_load_dwordx4 v45, s[24:27], s58 offen offset:1024 lds
    v_mfma_f32_16x16x32_bf16 a[40:43], a[88:91], v[104:107], a[40:43]
    v_exp_f32 v81, v81
    v_mfma_f32_16x16x32_bf16 a[24:27], a[88:91], v[100:103], a[24:27]
    v_exp_f32 v82, v82
    v_mfma_f32_16x16x32_bf16 a[24:27], a[84:87], v[116:119], a[24:27]
    v_exp_f32 v83, v83
    v_mfma_f32_16x16x32_bf16 a[8:11], a[84:87], v[112:115], a[8:11]
    v_cvt_pk_bf16_f32 v206, v80, v81
    v_cvt_pk_bf16_f32 v207, v82, v83
    v_mfma_f32_16x16x32_bf16 a[8:11], a[88:91], v[96:99], a[8:11]
    buffer_load_dwordx4 v46, s[24:27], s58 offen offset:2048 lds
    v_mfma_f32_16x16x32_bf16 a[240:243], a[88:91], v[108:111], a[240:243]
    v_exp_f32 v69, v69
    v_mfma_f32_16x16x32_bf16 a[244:247], a[92:95], v[108:111], a[244:247]
    v_exp_f32 v70, v70
    v_mfma_f32_16x16x32_bf16 v[208:211], a[92:95], v[96:99], v[208:211]
    v_exp_f32 v71, v71
    v_mfma_f32_16x16x32_bf16 v[208:211], a[96:99], v[112:115], v[208:211]
    v_exp_f32 v84, v84
    v_mfma_f32_16x16x32_bf16 v[212:215], a[96:99], v[116:119], v[212:215]
    buffer_load_dwordx4 v47, s[24:27], s58 offen offset:3072 lds
    v_mfma_f32_16x16x32_bf16 v[212:215], a[92:95], v[100:103], v[212:215]
    v_exp_f32 v85, v85
    v_mfma_f32_16x16x32_bf16 v[216:219], a[92:95], v[104:107], v[216:219]
    s_waitcnt lgkmcnt(0)
    v_exp_f32 v86, v86
    v_mfma_f32_16x16x32_bf16 v[216:219], a[96:99], v[120:123], v[216:219]
    v_exp_f32 v87, v87
    v_mfma_f32_16x16x32_bf16 a[44:47], a[100:103], v[120:123], a[44:47]
    v_cvt_pk_bf16_f32 v220, v68, v69
    v_cvt_pk_bf16_f32 v221, v70, v71
    v_mfma_f32_16x16x32_bf16 a[44:47], a[104:107], v[104:107], a[44:47]
    s_waitcnt vmcnt(25) lgkmcnt(0)
    s_barrier
    ds_read_b64_tr_b16 a[84:85], v10 offset:0
    v_mfma_f32_16x16x32_bf16 a[28:31], a[104:107], v[100:103], a[28:31]
    s_add_u32 s58, s73, 98304
    ds_read_b64_tr_b16 a[86:87], v10 offset:512
    s_waitcnt vmcnt(21)
    ds_read_b64_tr_b16 a[132:133], v36 offset:16384
    v_mfma_f32_16x16x32_bf16 a[28:31], a[100:103], v[116:119], a[28:31]
    s_add_u32 m0, s44, 16384
    ds_read_b64_tr_b16 a[134:135], v36 offset:18432
    ds_read_b64_tr_b16 a[136:137], v37 offset:16384
    v_mfma_f32_16x16x32_bf16 a[12:15], a[100:103], v[112:115], a[12:15]
    ds_read_b64_tr_b16 a[138:139], v37 offset:18432
    ds_read_b64_tr_b16 a[140:141], v38 offset:16384
    v_mfma_f32_16x16x32_bf16 a[12:15], a[104:107], v[96:99], a[12:15]
    ds_read_b64_tr_b16 a[142:143], v38 offset:18432
    ds_read_b64_tr_b16 a[144:145], v39 offset:16384
    v_mfma_f32_16x16x32_bf16 a[248:251], a[104:107], v[108:111], a[248:251]
    ds_read_b64_tr_b16 a[146:147], v39 offset:18432
    ds_read_b64_tr_b16 a[88:89], v6 offset:0
    v_mfma_f32_16x16x32_bf16 a[252:255], a[108:111], v[108:111], a[252:255]
    ds_read_b64_tr_b16 a[90:91], v6 offset:512
    v_cvt_pk_bf16_f32 v222, v84, v85
    v_mfma_f32_16x16x32_bf16 v[240:243], a[108:111], v[96:99], v[240:243]
    v_cvt_pk_bf16_f32 v223, v86, v87
    ds_read_b64_tr_b16 a[92:93], v7 offset:0
    v_mfma_f32_16x16x32_bf16 v[240:243], a[112:115], v[112:115], v[240:243]
    v_exp_f32 v72, v72
    v_mfma_f32_16x16x32_bf16 v[244:247], a[112:115], v[116:119], v[244:247]
    v_exp_f32 v73, v73
    v_mfma_f32_16x16x32_bf16 v[244:247], a[108:111], v[100:103], v[244:247]
    v_exp_f32 v74, v74
    v_mfma_f32_16x16x32_bf16 v[248:251], a[108:111], v[104:107], v[248:251]
    v_exp_f32 v75, v75
    v_mfma_f32_16x16x32_bf16 v[248:251], a[112:115], v[120:123], v[248:251]
    v_exp_f32 v88, v88
    v_mfma_f32_16x16x32_bf16 a[76:79], a[80:83], v[188:191], a[76:79]
    v_exp_f32 v89, v89
    v_mfma_f32_16x16x32_bf16 a[64:67], a[80:83], v[140:143], a[64:67]
    v_exp_f32 v90, v90
    v_mfma_f32_16x16x32_bf16 a[64:67], a[80:83], v[204:207], a[64:67]
    v_exp_f32 v91, v91
    v_mfma_f32_16x16x32_bf16 a[68:71], a[80:83], v[220:223], a[68:71]
    v_cvt_pk_bf16_f32 v236, v72, v73
    v_cvt_pk_bf16_f32 v237, v74, v75
    v_mfma_f32_16x16x32_bf16 a[68:71], a[80:83], v[156:159], a[68:71]
    v_cvt_pk_bf16_f32 v238, v88, v89
    v_cvt_pk_bf16_f32 v239, v90, v91
    v_mfma_f32_16x16x32_bf16 a[72:75], a[80:83], v[172:175], a[72:75]
    s_waitcnt lgkmcnt(0)
    ds_read_b64_tr_b16 a[94:95], v7 offset:512
    ds_read_b64_tr_b16 a[96:97], v11 offset:0
    v_mfma_f32_16x16x32_bf16 a[72:75], a[80:83], v[236:239], a[72:75]
    buffer_load_dwordx4 v44, s[24:27], s58 offen offset:0 lds
    v_mfma_f32_16x16x32_bf16 a[32:35], a[84:87], v[236:239], a[32:35]
    ds_read_b64_tr_b16 a[98:99], v11 offset:512
    v_accvgpr_read_b32 v124, a64
    v_mfma_f32_16x16x32_bf16 a[32:35], a[88:91], v[172:175], a[32:35]
    v_rcp_f32 v60, v124
    v_mfma_f32_16x16x32_bf16 a[16:19], a[88:91], v[156:159], a[16:19]
    ds_read_b64_tr_b16 a[100:101], v12 offset:0
    ds_read_b64_tr_b16 a[102:103], v12 offset:512
    v_mfma_f32_16x16x32_bf16 a[16:19], a[84:87], v[220:223], a[16:19]
    v_accvgpr_read_b32 v125, a68
    ds_read_b64_tr_b16 a[104:105], v8 offset:0
    v_mfma_f32_16x16x32_bf16 a[0:3], a[84:87], v[204:207], a[0:3]
    buffer_load_dwordx4 v45, s[24:27], s58 offen offset:1024 lds
    v_mfma_f32_16x16x32_bf16 a[0:3], a[88:91], v[140:143], a[0:3]
    v_rcp_f32 v62, v125
    v_mfma_f32_16x16x32_bf16 a[224:227], a[88:91], v[188:191], a[224:227]
    s_waitcnt lgkmcnt(5)
    v_accvgpr_read_b32 v116, a16
    v_accvgpr_read_b32 v117, a17
    v_mfma_f32_16x16x32_bf16 a[228:231], a[92:95], v[188:191], a[228:231]
    ds_read_b64_tr_b16 a[106:107], v8 offset:512
    v_accvgpr_read_b32 v118, a18
    v_mfma_f32_16x16x32_bf16 v[144:147], a[92:95], v[140:143], v[144:147]
    s_waitcnt lgkmcnt(4)
    v_accvgpr_read_b32 v112, a0
    buffer_load_dwordx4 v46, s[24:27], s58 offen offset:2048 lds
    v_mfma_f32_16x16x32_bf16 v[144:147], a[96:99], v[204:207], v[144:147]
    v_accvgpr_read_b32 v113, a1
    v_accvgpr_read_b32 v114, a2
    v_mfma_f32_16x16x32_bf16 v[148:151], a[96:99], v[220:223], v[148:151]
    v_accvgpr_read_b32 v115, a3
    v_mul_f32 v112, v60, v112
    v_mul_f32 v113, v60, v113
    v_mfma_f32_16x16x32_bf16 v[148:151], a[92:95], v[156:159], v[148:151]
    v_mul_f32 v114, v60, v114
    v_mul_f32 v115, v60, v115
    v_mfma_f32_16x16x32_bf16 v[152:155], a[92:95], v[172:175], v[152:155]
    s_waitcnt lgkmcnt(1)
    v_cvt_pk_bf16_f32 v112, v112, v113
    buffer_load_dwordx4 v47, s[24:27], s58 offen offset:3072 lds
    v_mfma_f32_16x16x32_bf16 v[152:155], a[96:99], v[236:239], v[152:155]
    v_mul_f32 v144, v60, v144
    v_mul_f32 v145, v60, v145
    v_mfma_f32_16x16x32_bf16 a[36:39], a[100:103], v[236:239], a[36:39]
    s_waitcnt lgkmcnt(0)
    v_mul_f32 v146, v60, v146
    v_mul_f32 v147, v60, v147
    v_mfma_f32_16x16x32_bf16 a[36:39], a[104:107], v[172:175], a[36:39]
    v_cvt_pk_bf16_f32 v113, v114, v115
    v_cvt_pk_bf16_f32 v114, v144, v145
    v_mfma_f32_16x16x32_bf16 a[20:23], a[104:107], v[156:159], a[20:23]
    v_cvt_pk_bf16_f32 v115, v146, v147
    buffer_store_dwordx4 v[112:115], v24, s[28:31], s54 offen offset:0 sc1
    v_mfma_f32_16x16x32_bf16 a[20:23], a[100:103], v[220:223], a[20:23]
    v_accvgpr_read_b32 v119, a19
    v_mul_f32 v116, v62, v116
    v_mul_f32 v117, v62, v117
    v_mfma_f32_16x16x32_bf16 a[4:7], a[100:103], v[204:207], a[4:7]
    v_mul_f32 v118, v62, v118
    v_mul_f32 v119, v62, v119
    v_mfma_f32_16x16x32_bf16 a[4:7], a[104:107], v[140:143], a[4:7]
    v_cvt_pk_bf16_f32 v116, v116, v117
    v_mul_f32 v148, v62, v148
    v_mul_f32 v149, v62, v149
    v_mfma_f32_16x16x32_bf16 a[232:235], a[104:107], v[188:191], a[232:235]
    v_mul_f32 v150, v62, v150
    v_mul_f32 v151, v62, v151
    v_cvt_pk_bf16_f32 v117, v118, v119
    v_cvt_pk_bf16_f32 v118, v148, v149
    v_cvt_pk_bf16_f32 v119, v150, v151
    buffer_store_dwordx4 v[116:119], v24, s[28:31], s54 offen offset:1024 sc1
    ds_read_b64_tr_b16 a[108:109], v9 offset:0
    ds_read_b64_tr_b16 a[110:111], v9 offset:512
    ds_read_b64_tr_b16 a[112:113], v13 offset:0
    ds_read_b64_tr_b16 a[114:115], v13 offset:512
    v_accvgpr_read_b32 v126, a72
    v_rcp_f32 v30, v126
    v_accvgpr_read_b32 v120, a32
    v_accvgpr_read_b32 v121, a33
    v_accvgpr_read_b32 v122, a34
    v_accvgpr_read_b32 v123, a35
    v_pk_mul_f32 v[120:121], v[120:121], v[30:31] op_sel_hi:[1,0]
    v_pk_mul_f32 v[122:123], v[122:123], v[30:31] op_sel_hi:[1,0]
    v_cvt_pk_bf16_f32 v120, v120, v121
    v_pk_mul_f32 v[152:153], v[152:153], v[30:31] op_sel_hi:[1,0]
    v_pk_mul_f32 v[154:155], v[154:155], v[30:31] op_sel_hi:[1,0]
    v_cvt_pk_bf16_f32 v121, v122, v123
L_s5:
    s_cbranch_execz L_back
    v_cvt_pk_bf16_f32 v122, v152, v153
    v_cvt_pk_bf16_f32 v123, v154, v155
    buffer_store_dwordx4 v[120:123], v24, s[28:31], s54 offen offset:2048 sc1
    v_accvgpr_read_b32 v96, a4
    v_accvgpr_read_b32 v97, a5
    v_accvgpr_read_b32 v98, a6
    v_accvgpr_read_b32 v99, a7
    v_pk_mul_f32 v[96:97], v[96:97], v[60:61] op_sel_hi:[1,0]
    v_pk_mul_f32 v[98:99], v[98:99], v[60:61] op_sel_hi:[1,0]
    v_cvt_pk_bf16_f32 v96, v96, v97
    v_cvt_pk_bf16_f32 v97, v98, v99
    s_waitcnt lgkmcnt(2)
    v_mfma_f32_16x16x32_bf16 a[236:239], a[108:111], v[188:191], a[236:239]
    ds_read_b64_tr_b16 a[84:85], v10 offset:1024
    ds_read_b64_tr_b16 a[86:87], v10 offset:1536
    v_mfma_f32_16x16x32_bf16 v[176:179], a[108:111], v[140:143], v[176:179]
    s_waitcnt lgkmcnt(2)
    ds_read_b64_tr_b16 a[88:89], v6 offset:1024
    ds_read_b64_tr_b16 a[90:91], v6 offset:1536
    v_mfma_f32_16x16x32_bf16 v[176:179], a[112:115], v[204:207], v[176:179]
    ds_read_b64_tr_b16 a[92:93], v7 offset:1024
    ds_read_b64_tr_b16 a[94:95], v7 offset:1536
    v_mfma_f32_16x16x32_bf16 v[180:183], a[112:115], v[220:223], v[180:183]
    v_accvgpr_read_b32 v108, a20
    v_accvgpr_read_b32 v109, a21
    v_mfma_f32_16x16x32_bf16 v[180:183], a[108:111], v[156:159], v[180:183]
    v_accvgpr_read_b32 v110, a22
    v_accvgpr_read_b32 v111, a23
    v_mfma_f32_16x16x32_bf16 v[184:187], a[108:111], v[172:175], v[184:187]
    v_mul_f32 v176, v60, v176
    v_mul_f32 v177, v60, v177
    v_mfma_f32_16x16x32_bf16 v[184:187], a[112:115], v[236:239], v[184:187]
    v_mul_f32 v178, v60, v178
    v_mul_f32 v179, v60, v179
    v_cvt_pk_bf16_f32 v98, v176, v177
    v_cvt_pk_bf16_f32 v99, v178, v179
    buffer_store_dwordx4 v[96:99], v24, s[28:31], s55 offen offset:0 sc1
    s_waitcnt lgkmcnt(4)
    v_mfma_f32_16x16x32_bf16 a[40:43], a[84:87], v[236:239], a[40:43]
    s_waitcnt lgkmcnt(2)
    v_mul_f32 v108, v62, v108
    v_mul_f32 v109, v62, v109
    v_mfma_f32_16x16x32_bf16 a[40:43], a[88:91], v[172:175], a[40:43]
    v_mul_f32 v110, v62, v110
    v_mul_f32 v111, v62, v111
    v_mfma_f32_16x16x32_bf16 a[24:27], a[88:91], v[156:159], a[24:27]
    v_cvt_pk_bf16_f32 v108, v108, v109
    v_mul_f32 v180, v62, v180
    v_mul_f32 v181, v62, v181
    v_mfma_f32_16x16x32_bf16 a[24:27], a[84:87], v[220:223], a[24:27]
    v_mul_f32 v182, v62, v182
    v_mul_f32 v183, v62, v183
    v_mfma_f32_16x16x32_bf16 a[8:11], a[84:87], v[204:207], a[8:11]
    v_cvt_pk_bf16_f32 v109, v110, v111
    ds_read_b64_tr_b16 a[96:97], v11 offset:1024
    v_mfma_f32_16x16x32_bf16 a[8:11], a[88:91], v[140:143], a[8:11]
    s_waitcnt lgkmcnt(1)
    ds_read_b64_tr_b16 a[98:99], v11 offset:1536
    v_cvt_pk_bf16_f32 v110, v180, v181
    v_mfma_f32_16x16x32_bf16 a[240:243], a[88:91], v[188:191], a[240:243]
    v_cvt_pk_bf16_f32 v111, v182, v183
    buffer_store_dwordx4 v[108:111], v24, s[28:31], s55 offen offset:1024 sc1
    v_mfma_f32_16x16x32_bf16 a[244:247], a[92:95], v[188:191], a[244:247]
    ds_read_b64_tr_b16 a[100:101], v12 offset:1024
    ds_read_b64_tr_b16 a[102:103], v12 offset:1536
    v_mfma_f32_16x16x32_bf16 v[208:211], a[92:95], v[140:143], v[208:211]
    ds_read_b64_tr_b16 a[104:105], v8 offset:1024
    ds_read_b64_tr_b16 a[106:107], v8 offset:1536
    v_accvgpr_read_b32 v52, a36
    v_accvgpr_read_b32 v53, a37
    v_accvgpr_read_b32 v54, a38
    v_accvgpr_read_b32 v55, a39
    v_pk_mul_f32 v[52:53], v[52:53], v[30:31] op_sel_hi:[1,0]
    v_pk_mul_f32 v[54:55], v[54:55], v[30:31] op_sel_hi:[1,0]
    v_cvt_pk_bf16_f32 v52, v52, v53
    v_pk_mul_f32 v[184:185], v[184:185], v[30:31] op_sel_hi:[1,0]
    v_pk_mul_f32 v[186:187], v[186:187], v[30:31] op_sel_hi:[1,0]
    v_cvt_pk_bf16_f32 v53, v54, v55
    v_cvt_pk_bf16_f32 v54, v184, v185
    v_cvt_pk_bf16_f32 v55, v186, v187
    ds_read_b64_tr_b16 a[108:109], v9 offset:1024
    s_waitcnt lgkmcnt(5)
    v_mfma_f32_16x16x32_bf16 v[208:211], a[96:99], v[204:207], v[208:211]
    buffer_store_dwordx4 v[52:55], v24, s[28:31], s55 offen offset:2048 sc1
    v_mfma_f32_16x16x32_bf16 v[212:215], a[96:99], v[220:223], v[212:215]
    ds_read_b64_tr_b16 a[110:111], v9 offset:1536
    v_accvgpr_read_b32 v56, a8
    v_mfma_f32_16x16x32_bf16 v[212:215], a[92:95], v[156:159], v[212:215]
    v_accvgpr_read_b32 v57, a9
    v_accvgpr_read_b32 v58, a10
    v_mfma_f32_16x16x32_bf16 v[216:219], a[92:95], v[172:175], v[216:219]
    s_waitcnt lgkmcnt(3)
    v_accvgpr_read_b32 v59, a11
    v_accvgpr_read_b32 v112, a24
    v_mfma_f32_16x16x32_bf16 v[216:219], a[96:99], v[236:239], v[216:219]
    s_waitcnt lgkmcnt(2)
    v_mul_f32 v56, v60, v56
    v_mul_f32 v57, v60, v57
    v_mfma_f32_16x16x32_bf16 a[44:47], a[100:103], v[236:239], a[44:47]
    v_mul_f32 v58, v60, v58
    v_mul_f32 v59, v60, v59
    v_mfma_f32_16x16x32_bf16 a[44:47], a[104:107], v[172:175], a[44:47]
    v_cvt_pk_bf16_f32 v56, v56, v57
    v_cvt_pk_bf16_f32 v57, v58, v59
    v_mfma_f32_16x16x32_bf16 a[28:31], a[104:107], v[156:159], a[28:31]
    v_mul_f32 v208, v60, v208
    v_mul_f32 v209, v60, v209
    v_mfma_f32_16x16x32_bf16 a[28:31], a[100:103], v[220:223], a[28:31]
    v_mul_f32 v210, v60, v210
    v_mul_f32 v211, v60, v211
    v_mfma_f32_16x16x32_bf16 a[12:15], a[100:103], v[204:207], a[12:15]
    v_cvt_pk_bf16_f32 v58, v208, v209
    v_cvt_pk_bf16_f32 v59, v210, v211
    v_mfma_f32_16x16x32_bf16 a[12:15], a[104:107], v[140:143], a[12:15]
    s_waitcnt lgkmcnt(0)
    buffer_store_dwordx4 v[56:59], v24, s[28:31], s55 offen offset:3072 sc1
    v_mfma_f32_16x16x32_bf16 a[248:251], a[104:107], v[188:191], a[248:251]
    ds_write_b128 v22, a[224:227] offset:0
    v_mfma_f32_16x16x32_bf16 a[252:255], a[108:111], v[188:191], a[252:255]
    ds_write_b128 v22, a[228:231] offset:1024
    v_mfma_f32_16x16x32_bf16 v[240:243], a[108:111], v[140:143], v[240:243]
    ds_write_b128 v22, a[232:235] offset:2048
    ds_write_b128 v22, a[236:239] offset:3072
    ds_write_b128 v22, a[240:243] offset:4096
    ds_write_b128 v22, a[244:247] offset:5120
    ds_write_b128 v22, a[248:251] offset:6144
    v_accvgpr_read_b32 v113, a25
    ds_write_b128 v22, a[252:255] offset:7168
    v_accvgpr_read_b32 v114, a26
    v_accvgpr_read_b32 v115, a27
    v_pk_mul_f32 v[112:113], v[112:113], v[62:63] op_sel_hi:[1,0]
    v_pk_mul_f32 v[114:115], v[114:115], v[62:63] op_sel_hi:[1,0]
    v_cvt_pk_bf16_f32 v112, v112, v113
    v_pk_mul_f32 v[212:213], v[212:213], v[62:63] op_sel_hi:[1,0]
    v_pk_mul_f32 v[214:215], v[214:215], v[62:63] op_sel_hi:[1,0]
    v_cvt_pk_bf16_f32 v113, v114, v115
    v_cvt_pk_bf16_f32 v114, v212, v213
    v_cvt_pk_bf16_f32 v115, v214, v215
    buffer_store_dwordx4 v[112:115], v24, s[28:31], s56 offen offset:0 sc1
    ds_read_b64_tr_b16 a[112:113], v13 offset:1024
    ds_read_b64_tr_b16 a[114:115], v13 offset:1536
    v_accvgpr_read_b32 v116, a40
    v_accvgpr_read_b32 v117, a41
    v_accvgpr_read_b32 v118, a42
    v_accvgpr_read_b32 v119, a43
    v_pk_mul_f32 v[116:117], v[116:117], v[30:31] op_sel_hi:[1,0]
    v_pk_mul_f32 v[118:119], v[118:119], v[30:31] op_sel_hi:[1,0]
    v_cvt_pk_bf16_f32 v116, v116, v117
    v_pk_mul_f32 v[216:217], v[216:217], v[30:31] op_sel_hi:[1,0]
    v_pk_mul_f32 v[218:219], v[218:219], v[30:31] op_sel_hi:[1,0]
    v_cvt_pk_bf16_f32 v117, v118, v119
    v_cvt_pk_bf16_f32 v118, v216, v217
    v_cvt_pk_bf16_f32 v119, v218, v219
    buffer_store_dwordx4 v[116:119], v24, s[28:31], s56 offen offset:1024 sc1
    v_accvgpr_read_b32 v120, a12
    v_accvgpr_read_b32 v121, a13
    v_accvgpr_read_b32 v122, a14
    v_accvgpr_read_b32 v123, a15
    v_pk_mul_f32 v[120:121], v[120:121], v[60:61] op_sel_hi:[1,0]
    v_pk_mul_f32 v[122:123], v[122:123], v[60:61] op_sel_hi:[1,0]
    v_cvt_pk_bf16_f32 v120, v120, v121
    v_cvt_pk_bf16_f32 v121, v122, v123
    v_accvgpr_read_b32 v96, a28
    v_accvgpr_read_b32 v97, a29
    v_accvgpr_read_b32 v98, a30
    v_accvgpr_read_b32 v99, a31
    v_pk_mul_f32 v[96:97], v[96:97], v[62:63] op_sel_hi:[1,0]
    s_waitcnt lgkmcnt(0)
    v_mfma_f32_16x16x32_bf16 v[240:243], a[112:115], v[204:207], v[240:243]
    v_mul_f32 v98, v62, v98
    v_mul_f32 v99, v62, v99
    v_mfma_f32_16x16x32_bf16 v[244:247], a[112:115], v[220:223], v[244:247]
    v_cvt_pk_bf16_f32 v96, v96, v97
    v_cvt_pk_bf16_f32 v97, v98, v99
    v_mfma_f32_16x16x32_bf16 v[244:247], a[108:111], v[156:159], v[244:247]
    v_accvgpr_read_b32 v127, a76
    v_min3_f32 v100, v124, v125, v126
    v_mfma_f32_16x16x32_bf16 v[248:251], a[108:111], v[172:175], v[248:251]
    v_mul_f32 v240, v60, v240
    v_mul_f32 v241, v60, v241
    v_mfma_f32_16x16x32_bf16 v[248:251], a[112:115], v[236:239], v[248:251]
    v_mul_f32 v242, v60, v242
    v_mul_f32 v243, v60, v243
    v_cvt_pk_bf16_f32 v122, v240, v241
    v_cvt_pk_bf16_f32 v123, v242, v243
    buffer_store_dwordx4 v[120:123], v24, s[28:31], s56 offen offset:3072 sc1
    v_pk_mul_f32 v[244:245], v[244:245], v[62:63] op_sel_hi:[1,0]
    v_pk_mul_f32 v[246:247], v[246:247], v[62:63] op_sel_hi:[1,0]
    v_cvt_pk_bf16_f32 v98, v244, v245
    v_cvt_pk_bf16_f32 v99, v246, v247
    buffer_store_dwordx4 v[96:99], v24, s[28:31], s57 offen offset:0 sc1
    v_add_f32 v101, v124, v125
    v_add_f32 v102, v126, v127
    v_min_f32 v100, v100, v127
    v_add_f32 v101, v101, v102
    v_cmp_le_f32 s[4:5], s50, v100
    v_cmp_ge_f32 vcc, s51, v101
    v_lshlrev_b32 v104, 3, v1
    v_mov_b32 v101, v127
    v_accvgpr_read_b32 v108, a44
    v_accvgpr_read_b32 v109, a45
    v_accvgpr_read_b32 v110, a46
    v_accvgpr_read_b32 v111, a47
    v_pk_mul_f32 v[108:109], v[108:109], v[30:31] op_sel_hi:[1,0]
    v_pk_mul_f32 v[110:111], v[110:111], v[30:31] op_sel_hi:[1,0]
    v_cvt_pk_bf16_f32 v108, v108, v109
    v_pk_mul_f32 v[248:249], v[248:249], v[30:31] op_sel_hi:[1,0]
    v_pk_mul_f32 v[250:251], v[250:251], v[30:31] op_sel_hi:[1,0]
    v_cvt_pk_bf16_f32 v109, v110, v111
    v_cvt_pk_bf16_f32 v110, v248, v249
    v_cvt_pk_bf16_f32 v111, v250, v251
    buffer_store_dwordx4 v[108:111], v24, s[28:31], s57 offen offset:1024 sc1
    s_and_b64 s[4:5], s[4:5], vcc
    s_cmp_eq_u64 s[4:5], -1
    s_cselect_b32 s4, 0, 1
    v_mov_b32 v100, s4
    s_add_u32 s46, s44, 131072
    v_add_u32 v104, s46, v104
    ds_write_b64 v104, v[100:101] offset:0
    v_and_b32 v104, 0xffffffbf, v104
    s_lshl_b32 s47, s41, 6
    v_or_b32 v104, s47, v104
    v_xor_b32 v105, 0x1000, v104
    v_xor_b32 v106, 0x2000, v104
    v_xor_b32 v107, 0x3000, v104
    s_waitcnt lgkmcnt(0)
    s_barrier
    ds_read_b32 v101, v104 offset:4
    ds_read_b64 v[102:103], v105 offset:0
    ds_read_b128 v[64:67], v23 offset:0
    ds_read_b128 v[80:83], v29 offset:0
    ds_read_b128 v[68:71], v23 offset:1024
    ds_read_b128 v[84:87], v29 offset:1024
    ds_read_b128 v[72:75], v23 offset:4096
    ds_read_b128 v[88:91], v29 offset:4096
    ds_read_b128 v[76:79], v23 offset:5120
    ds_read_b128 v[92:95], v29 offset:5120
    ds_read_b32 v106, v106 offset:0
    ds_read_b32 v107, v107 offset:0
    s_waitcnt lgkmcnt(10)
    v_add_f32 v104, v101, v103
    v_rcp_f32 v104, v104
    s_waitcnt lgkmcnt(6)
    v_pk_add_f32 v[64:65], v[64:65], v[80:81]
    v_pk_add_f32 v[66:67], v[66:67], v[82:83]
    v_pk_mul_f32 v[64:65], v[64:65], v[104:105] op_sel_hi:[1,0]
    v_pk_add_f32 v[68:69], v[68:69], v[84:85]
    v_pk_add_f32 v[70:71], v[70:71], v[86:87]
    v_pk_mul_f32 v[66:67], v[66:67], v[104:105] op_sel_hi:[1,0]
    v_cvt_pk_bf16_f32 v64, v64, v65
    v_pk_mul_f32 v[68:69], v[68:69], v[104:105] op_sel_hi:[1,0]
    v_pk_mul_f32 v[70:71], v[70:71], v[104:105] op_sel_hi:[1,0]
    v_cvt_pk_bf16_f32 v65, v66, v67
    v_cvt_pk_bf16_f32 v66, v68, v69
    v_cvt_pk_bf16_f32 v67, v70, v71
    buffer_store_dwordx4 v[64:67], v24, s[28:31], s54 offen offset:3072 sc1
    s_waitcnt lgkmcnt(0)
    v_pk_add_f32 v[72:73], v[72:73], v[88:89]
    v_pk_add_f32 v[74:75], v[74:75], v[90:91]
    v_pk_mul_f32 v[72:73], v[72:73], v[104:105] op_sel_hi:[1,0]
    v_pk_add_f32 v[76:77], v[76:77], v[92:93]
    v_pk_add_f32 v[78:79], v[78:79], v[94:95]
    v_pk_mul_f32 v[74:75], v[74:75], v[104:105] op_sel_hi:[1,0]
    v_cvt_pk_bf16_f32 v72, v72, v73
    v_pk_mul_f32 v[76:77], v[76:77], v[104:105] op_sel_hi:[1,0]
    v_pk_mul_f32 v[78:79], v[78:79], v[104:105] op_sel_hi:[1,0]
    v_cvt_pk_bf16_f32 v73, v74, v75
    v_cvt_pk_bf16_f32 v74, v76, v77
    v_cvt_pk_bf16_f32 v75, v78, v79
    buffer_store_dwordx4 v[72:75], v24, s[28:31], s56 offen offset:2048 sc1
    v_or3_b32 v100, v100, v102, v106
    v_or_b32 v100, v100, v107
    v_cmp_ne_u32 vcc, 0, v100
    s_nop 4
    s_cbranch_vccnz L_slow
L_done:
    s_waitcnt vmcnt(38)
    v_cmp_ne_u32 vcc, 1, v28
    s_mov_b32 s53, 1000000
    s_nop 3
    s_cbranch_vccz L_e1_ok
L_e1_spin:
    buffer_load_dword v28, v25, s[32:35], 0 offen sc1
    s_waitcnt vmcnt(0)
    v_cmp_ne_u32 vcc, 1, v28
    s_sub_u32 s53, s53, 1
    s_cmp_eq_u32 s53, 0
    s_cbranch_scc1 L_e1_ok
    s_nop 1
    s_cbranch_vccnz L_e1_spin
L_e1_ok:
    s_waitcnt vmcnt(34)
    ds_read_b64_tr_b16 a[148:149], v36 offset:32768
    ds_read_b64_tr_b16 a[150:151], v36 offset:34816
    ds_read_b64_tr_b16 a[152:153], v37 offset:32768
    ds_read_b64_tr_b16 a[154:155], v37 offset:34816
    ds_read_b64_tr_b16 a[156:157], v38 offset:32768
    ds_read_b64_tr_b16 a[158:159], v38 offset:34816
    ds_read_b64_tr_b16 a[160:161], v39 offset:32768
    ds_read_b64_tr_b16 a[162:163], v39 offset:34816
    s_waitcnt vmcnt(30)
    ds_read_b64_tr_b16 a[164:165], v36 offset:0
    ds_read_b64_tr_b16 a[166:167], v36 offset:2048
    ds_read_b64_tr_b16 a[168:169], v37 offset:0
    ds_read_b64_tr_b16 a[170:171], v37 offset:2048
    ds_read_b64_tr_b16 a[172:173], v38 offset:0
    ds_read_b64_tr_b16 a[174:175], v38 offset:2048
    ds_read_b64_tr_b16 a[176:177], v39 offset:0
    ds_read_b64_tr_b16 a[178:179], v39 offset:2048
    s_add_u32 s58, s74, 0
    s_add_u32 m0, s44, 98304
    s_nop 0
    buffer_load_dwordx4 v44, s[24:27], s58 offen offset:0 lds
    buffer_load_dwordx4 v45, s[24:27], s58 offen offset:1024 lds
    buffer_load_dwordx4 v46, s[24:27], s58 offen offset:2048 lds
    buffer_load_dwordx4 v47, s[24:27], s58 offen offset:3072 lds
    s_add_u32 s58, s74, 32768
    s_add_u32 m0, s44, 32768
    s_waitcnt lgkmcnt(8)
    buffer_load_dwordx4 v44, s[24:27], s58 offen offset:0 lds
    buffer_load_dwordx4 v45, s[24:27], s58 offen offset:1024 lds
    buffer_load_dwordx4 v46, s[24:27], s58 offen offset:2048 lds
    buffer_load_dwordx4 v47, s[24:27], s58 offen offset:3072 lds
    v_mov_b32 v12, 1
    s_waitcnt vmcnt(8)
    buffer_store_dword v12, v26, s[28:31], 0 offen sc1
    s_add_u32 s58, s74, 65536
    s_add_u32 m0, s44, 0
    s_waitcnt lgkmcnt(0)
    buffer_load_dwordx4 v44, s[24:27], s58 offen offset:0 lds
    buffer_load_dwordx4 v45, s[24:27], s58 offen offset:1024 lds
    buffer_load_dwordx4 v46, s[24:27], s58 offen offset:2048 lds
    buffer_load_dwordx4 v47, s[24:27], s58 offen offset:3072 lds
    s_waitcnt lgkmcnt(0)
    s_barrier
    ds_read_b64_tr_b16 a[180:181], v40 offset:16384
    ds_read_b64_tr_b16 a[182:183], v40 offset:18432
    ds_read_b64_tr_b16 a[184:185], v41 offset:16384
    ds_read_b64_tr_b16 a[186:187], v41 offset:18432
    ds_read_b64_tr_b16 a[188:189], v42 offset:16384
    ds_read_b64_tr_b16 a[190:191], v42 offset:18432
    ds_read_b64_tr_b16 a[192:193], v43 offset:16384
    ds_read_b64_tr_b16 a[194:195], v43 offset:18432
    ds_read_b64_tr_b16 a[196:197], v40 offset:0
    ds_read_b64_tr_b16 a[198:199], v40 offset:2048
    ds_read_b64_tr_b16 a[200:201], v41 offset:0
    ds_read_b64_tr_b16 a[202:203], v41 offset:2048
    ds_read_b64_tr_b16 a[204:205], v42 offset:0
    ds_read_b64_tr_b16 a[206:207], v42 offset:2048
    ds_read_b64_tr_b16 a[208:209], v43 offset:0
    ds_read_b64_tr_b16 a[210:211], v43 offset:2048
    ds_read_b64_tr_b16 a[212:213], v40 offset:49152
    ds_read_b64_tr_b16 a[214:215], v40 offset:51200
    ds_read_b64_tr_b16 a[216:217], v41 offset:49152
    ds_read_b64_tr_b16 a[218:219], v41 offset:51200
    ds_read_b64_tr_b16 a[220:221], v42 offset:49152
    ds_read_b64_tr_b16 a[222:223], v42 offset:51200
    ds_read_b64_tr_b16 a[224:225], v43 offset:49152
    ds_read_b64_tr_b16 a[226:227], v43 offset:51200
    ds_read_b64_tr_b16 a[228:229], v36 offset:16384
    ds_read_b64_tr_b16 a[230:231], v36 offset:18432
    ds_read_b64_tr_b16 a[232:233], v37 offset:16384
    ds_read_b64_tr_b16 a[234:235], v37 offset:18432
    ds_read_b64_tr_b16 a[236:237], v38 offset:16384
    ds_read_b64_tr_b16 a[238:239], v38 offset:18432
    ds_read_b64_tr_b16 a[240:241], v39 offset:16384
    ds_read_b64_tr_b16 a[242:243], v39 offset:18432
    s_lshl_b32 s46, s62, 7
    s_lshl_b32 s47, s92, 2
    s_add_u32 s46, s46, s47
    s_mul_i32 s47, s46, 14336
    s_add_u32 s47, s47, 1048576
    v_lshlrev_b32 v16, 4, v1
    v_add_u32 v22, s47, v16
    v_add_u32 v23, 4096, v22
    s_and_b32 s47, s60, 2
    s_lshl_b32 s47, s47, 5
    s_add_u32 s46, s46, s47
    s_lshl_b32 s46, s46, 7
    s_add_u32 s46, s46, 25165824
    s_lshr_b32 s47, s2, 7
    s_xor_b32 s47, s47, 1
    s_lshl_b32 s47, s47, 7
    s_add_u32 s46, s46, s47
    v_and_b32 v25, 2, v1
    v_lshlrev_b32 v25, 7, v25
    v_and_b32 v17, 4, v1
    v_lshl_add_u32 v25, v17, 10, v25
    v_add_u32 v25, s46, v25
    v_xor_b32 v19, 0x80, v25
    v_add_u32 v14, 0x10000, v27
    s_lshl_b32 s46, s2, 2
    s_add_u32 s46, s46, s40
    s_lshl_b32 s47, s46, 12
    s_add_u32 s47, s47, 16777216
    v_add_u32 v8, s47, v16
    v_xor_b32 v9, 0x4000, v8
    s_lshl_b32 s47, s46, 7
    s_add_u32 s47, s47, 25296896
    v_and_b32 v17, 31, v1
    v_lshl_add_u32 v10, v17, 2, s47
    s_xor_b32 s47, s47, 0x200
    v_mov_b32 v11, s47
    v_and_b32 v16, 0xffffff7f, v22
    v_bfe_u32 v17, v1, 3, 1
    s_and_b32 s46, s60, 1
    s_sub_u32 s47, s46, 1
    v_add_u32 v18, s47, v17
    s_mov_b32 s47, 458752
    v_mul_lo_u32 v18, v18, s47
    v_add_u32 v15, v16, v18
    v_cmp_eq_u32 vcc, s46, v17
    v_mov_b32 v16, 0x4000000
    s_nop 0
    v_cndmask_b32 v17, v16, 0, vcc
    v_cndmask_b32 v16, 0, v16, vcc
    v_add_u32 v21, v9, v17
    v_add_u32 v20, v8, v16
    v_and_b32 v16, 15, v1
    v_lshlrev_b32 v16, 10, v16
    v_lshrrev_b32 v18, 5, v1
    v_lshl_add_u32 v16, v18, 4, v16
    s_mul_i32 s46, s60, 49152
    s_lshl_b32 s47, s61, 7
    s_lshl_b32 s48, s40, 5
    s_add_u32 s47, s47, s48
    v_add_u32 v16, s47, v16
    v_bfe_u32 v18, v1, 4, 1
    v_lshl_add_u32 v4, v18, 14, v16
    v_add_u32 v4, s46, v4
    s_lshr_b32 s47, s60, 1
    s_add_u32 s47, s47, 12
    s_lshl_b32 s47, s47, 14
    s_add_u32 s46, s46, 32768
    v_add_u32 v17, s47, v17
    v_mov_b32 v5, s46
    v_cmp_eq_u32 vcc, 1, v18
    s_nop 1
    v_cndmask_b32 v5, v5, v17, vcc
    v_add_u32 v5, v5, v16
    v_xor_b32 v2, 4096, v27
    v_add_u32 v7, 0x10000, v2
    v_xor_b32 v3, 8192, v27
    v_add_u32 v24, 0x10000, v3
    v_xor_b32 v6, 12288, v27
    v_add_u32 v29, 0x10000, v6
    s_add_u32 s58, s74, 98304
    s_add_u32 m0, s44, 49152
    s_nop 0
    buffer_load_dwordx4 v44, s[24:27], s58 offen offset:0 lds
    buffer_load_dwordx4 v45, s[24:27], s58 offen offset:1024 lds
    buffer_load_dwordx4 v46, s[24:27], s58 offen offset:2048 lds
    buffer_load_dwordx4 v47, s[24:27], s58 offen offset:3072 lds
    s_add_u32 s58, s75, 0
    s_add_u32 m0, s44, 81920
    s_waitcnt lgkmcnt(15)
    buffer_load_dwordx4 v44, s[24:27], s58 offen offset:0 lds
    buffer_load_dwordx4 v45, s[24:27], s58 offen offset:1024 lds
    buffer_load_dwordx4 v46, s[24:27], s58 offen offset:2048 lds
    buffer_load_dwordx4 v47, s[24:27], s58 offen offset:3072 lds
    s_add_u32 s58, s75, 32768
    s_add_u32 m0, s44, 65536
    s_nop 0
    buffer_load_dwordx4 v44, s[24:27], s58 offen offset:0 lds
    buffer_load_dwordx4 v45, s[24:27], s58 offen offset:1024 lds
    buffer_load_dwordx4 v46, s[24:27], s58 offen offset:2048 lds
    buffer_load_dwordx4 v47, s[24:27], s58 offen offset:3072 lds
    s_add_u32 s58, s75, 65536
    s_add_u32 m0, s44, 114688
    s_waitcnt lgkmcnt(8)
    buffer_load_dwordx4 v44, s[24:27], s58 offen offset:0 lds
    buffer_load_dwordx4 v45, s[24:27], s58 offen offset:1024 lds
    buffer_load_dwordx4 v46, s[24:27], s58 offen offset:2048 lds
    buffer_load_dwordx4 v47, s[24:27], s58 offen offset:3072 lds
    buffer_load_dword v28, v25, s[28:31], 0 offen sc1
    s_add_u32 s58, s75, 98304
    s_add_u32 m0, s44, 16384
    s_waitcnt lgkmcnt(0)
    buffer_load_dwordx4 v44, s[24:27], s58 offen offset:0 lds
    buffer_load_dwordx4 v45, s[24:27], s58 offen offset:1024 lds
    buffer_load_dwordx4 v46, s[24:27], s58 offen offset:2048 lds
    buffer_load_dwordx4 v47, s[24:27], s58 offen offset:3072 lds
    s_waitcnt vmcnt(4)
    v_cmp_ne_u32 vcc, 1, v28
    s_mov_b32 s53, 1000000
    s_nop 3
    s_cbranch_vccz L_o_ok
L_o_spin:
    buffer_load_dword v28, v25, s[28:31], 0 offen sc1
    s_waitcnt vmcnt(0)
    v_cmp_ne_u32 vcc, 1, v28
    s_sub_u32 s53, s53, 1
    s_cmp_eq_u32 s53, 0
    s_cbranch_scc1 L_o_ok
    s_nop 1
    s_cbranch_vccnz L_o_spin
L_o_ok:
    s_add_u32 s59, s64, 0
    buffer_load_dwordx4 a[64:67], v15, s[28:31], s59 offen offset:3072 sc1
    buffer_load_dwordx4 a[68:71], v15, s[28:31], s59 offen offset:3200 sc1
    buffer_load_dwordx4 a[72:75], v22, s[28:31], s59 offen offset:0 sc1
    buffer_load_dwordx4 a[76:79], v23, s[28:31], s59 offen offset:0 sc1
    buffer_load_dwordx4 a[80:83], v22, s[28:31], s59 offen offset:1024 sc1
    buffer_load_dwordx4 a[84:87], v23, s[28:31], s59 offen offset:1024 sc1
    buffer_load_dwordx4 a[88:91], v22, s[28:31], s59 offen offset:2048 sc1
    buffer_load_dwordx4 a[92:95], v23, s[28:31], s59 offen offset:2048 sc1
    s_add_u32 s59, s64, 7168
    buffer_load_dwordx4 a[96:99], v15, s[28:31], s59 offen offset:3072 sc1
    buffer_load_dwordx4 a[100:103], v15, s[28:31], s59 offen offset:3200 sc1
    buffer_load_dwordx4 v[64:67], v22, s[28:31], s59 offen offset:0 sc1
    buffer_load_dwordx4 v[68:71], v23, s[28:31], s59 offen offset:0 sc1
    buffer_load_dwordx4 v[72:75], v22, s[28:31], s59 offen offset:1024 sc1
    buffer_load_dwordx4 v[76:79], v23, s[28:31], s59 offen offset:1024 sc1
    ds_read_b64_tr_b16 a[248:249], v41 offset:32768
    ds_read_b64_tr_b16 a[250:251], v41 offset:34816
    ds_read_b64_tr_b16 v[56:57], v37 offset:32768
    ds_read_b64_tr_b16 v[58:59], v37 offset:34816
    ds_read_b64_tr_b16 v[60:61], v38 offset:32768
    ds_read_b64_tr_b16 v[62:63], v38 offset:34816
    ds_read_b64_tr_b16 a[252:253], v42 offset:32768
    ds_read_b64_tr_b16 a[254:255], v42 offset:34816
    ds_read_b64_tr_b16 v[52:53], v43 offset:32768
    ds_read_b64_tr_b16 v[54:55], v43 offset:34816
    ds_read_b64_tr_b16 a[104:105], v39 offset:32768
    ds_read_b64_tr_b16 a[106:107], v39 offset:34816
    ds_read_b64_tr_b16 v[48:49], v36 offset:32768
    ds_read_b64_tr_b16 v[50:51], v36 offset:34816
    ds_read_b64_tr_b16 a[244:245], v40 offset:32768
    ds_read_b64_tr_b16 a[246:247], v40 offset:34816
    ds_read_b64_tr_b16 a[112:113], v37 offset:0
    ds_read_b64_tr_b16 a[114:115], v37 offset:2048
    ds_read_b64_tr_b16 v[176:177], v37 offset:49152
    ds_read_b64_tr_b16 v[178:179], v37 offset:51200
    ds_read_b64_tr_b16 v[180:181], v38 offset:49152
    ds_read_b64_tr_b16 v[182:183], v38 offset:51200
    ds_read_b64_tr_b16 v[164:165], v38 offset:0
    ds_read_b64_tr_b16 v[166:167], v38 offset:2048
    ds_read_b64_tr_b16 v[168:169], v39 offset:0
    ds_read_b64_tr_b16 v[170:171], v39 offset:2048
    ds_read_b64_tr_b16 v[184:185], v39 offset:49152
    ds_read_b64_tr_b16 v[186:187], v39 offset:51200
    ds_read_b64_tr_b16 v[172:173], v36 offset:49152
    ds_read_b64_tr_b16 v[174:175], v36 offset:51200
    ds_read_b64_tr_b16 a[108:109], v36 offset:0
    ds_read_b64_tr_b16 a[110:111], v36 offset:2048
    ds_read_b64_tr_b16 v[192:193], v41 offset:16384
    ds_read_b64_tr_b16 v[194:195], v41 offset:18432
    ds_read_b64_tr_b16 v[208:209], v41 offset:0
    ds_read_b64_tr_b16 v[210:211], v41 offset:2048
    ds_read_b64_tr_b16 v[212:213], v42 offset:0
    ds_read_b64_tr_b16 v[214:215], v42 offset:2048
    ds_read_b64_tr_b16 v[196:197], v42 offset:16384
    ds_read_b64_tr_b16 v[198:199], v42 offset:18432
    ds_read_b64_tr_b16 v[200:201], v43 offset:16384
    ds_read_b64_tr_b16 v[202:203], v43 offset:18432
    ds_read_b64_tr_b16 v[216:217], v43 offset:0
    ds_read_b64_tr_b16 v[218:219], v43 offset:2048
    ds_read_b64_tr_b16 v[204:205], v40 offset:0
    ds_read_b64_tr_b16 v[206:207], v40 offset:2048
    ds_read_b64_tr_b16 v[188:189], v40 offset:16384
    ds_read_b64_tr_b16 v[190:191], v40 offset:18432
    ds_read_b64_tr_b16 v[224:225], v41 offset:49152
    ds_read_b64_tr_b16 v[226:227], v41 offset:51200
    s_waitcnt vmcnt(14)
    ds_read_b64_tr_b16 v[240:241], v37 offset:16384
    ds_read_b64_tr_b16 v[242:243], v37 offset:18432
    ds_read_b64_tr_b16 v[244:245], v38 offset:16384
    ds_read_b64_tr_b16 v[246:247], v38 offset:18432
    ds_read_b64_tr_b16 v[228:229], v42 offset:49152
    ds_read_b64_tr_b16 v[230:231], v42 offset:51200
    ds_read_b64_tr_b16 v[232:233], v43 offset:49152
    ds_read_b64_tr_b16 v[234:235], v43 offset:51200
    ds_read_b64_tr_b16 v[248:249], v39 offset:16384
    ds_read_b64_tr_b16 v[250:251], v39 offset:18432
    ds_read_b64_tr_b16 v[236:237], v36 offset:16384
    ds_read_b64_tr_b16 v[238:239], v36 offset:18432
    ds_read_b64_tr_b16 v[220:221], v40 offset:49152
    ds_read_b64_tr_b16 v[222:223], v40 offset:51200
    s_waitcnt vmcnt(13)
    v_mfma_f32_16x16x32_bf16 a[52:55], a[120:123], a[64:67], 0
    s_waitcnt vmcnt(12)
    v_mfma_f32_16x16x32_bf16 a[52:55], a[136:139], a[68:71], a[52:55]
    v_mfma_f32_16x16x32_bf16 a[56:59], a[140:143], a[68:71], 0
    v_mfma_f32_16x16x32_bf16 a[56:59], a[124:127], a[64:67], a[56:59]
    v_mfma_f32_16x16x32_bf16 a[60:63], a[128:131], a[64:67], 0
    v_mfma_f32_16x16x32_bf16 a[60:63], a[144:147], a[68:71], a[60:63]
    v_mfma_f32_16x16x32_bf16 v[144:147], a[132:135], a[68:71], 0
    v_mfma_f32_16x16x32_bf16 v[144:147], a[116:119], a[64:67], v[144:147]
    s_waitcnt vmcnt(11)
    buffer_load_dwordx4 a[64:67], v22, s[28:31], s59 offen offset:2048 sc1
    v_mfma_f32_16x16x32_bf16 a[4:7], a[120:123], a[72:75], 0
    s_waitcnt vmcnt(11)
    buffer_load_dwordx4 a[68:71], v23, s[28:31], s59 offen offset:2048 sc1
    v_mfma_f32_16x16x32_bf16 a[4:7], a[136:139], a[76:79], a[4:7]
L_s6:
    s_cbranch_execz L_back
    s_add_u32 s59, s65, 0
    v_mfma_f32_16x16x32_bf16 a[8:11], a[140:143], a[76:79], 0
    v_mfma_f32_16x16x32_bf16 a[8:11], a[124:127], a[72:75], a[8:11]
    v_mfma_f32_16x16x32_bf16 a[12:15], a[128:131], a[72:75], 0
    v_mfma_f32_16x16x32_bf16 a[12:15], a[144:147], a[76:79], a[12:15]
    v_mfma_f32_16x16x32_bf16 v[132:135], a[132:135], a[76:79], 0
    v_mfma_f32_16x16x32_bf16 v[132:135], a[116:119], a[72:75], v[132:135]
    s_waitcnt vmcnt(11)
    buffer_load_dwordx4 a[72:75], v15, s[28:31], s59 offen offset:3072 sc1
    v_mfma_f32_16x16x32_bf16 a[20:23], a[120:123], a[80:83], 0
    s_waitcnt vmcnt(11)
    buffer_load_dwordx4 a[76:79], v15, s[28:31], s59 offen offset:3200 sc1
    v_mfma_f32_16x16x32_bf16 a[20:23], a[136:139], a[84:87], a[20:23]
    buffer_load_dword v28, v19, s[28:31], 0 offen sc1
    v_mfma_f32_16x16x32_bf16 a[24:27], a[140:143], a[84:87], 0
    v_mfma_f32_16x16x32_bf16 a[24:27], a[124:127], a[80:83], a[24:27]
    v_mfma_f32_16x16x32_bf16 a[28:31], a[128:131], a[80:83], 0
    v_mfma_f32_16x16x32_bf16 a[28:31], a[144:147], a[84:87], a[28:31]
    v_mfma_f32_16x16x32_bf16 v[136:139], a[132:135], a[84:87], 0
    v_mfma_f32_16x16x32_bf16 v[136:139], a[116:119], a[80:83], v[136:139]
    s_waitcnt vmcnt(12)
    buffer_load_dwordx4 a[80:83], v22, s[28:31], s59 offen offset:0 sc1
    v_mfma_f32_16x16x32_bf16 a[36:39], a[120:123], a[88:91], 0
    s_waitcnt vmcnt(12)
    buffer_load_dwordx4 a[84:87], v23, s[28:31], s59 offen offset:0 sc1
    v_mfma_f32_16x16x32_bf16 a[36:39], a[136:139], a[92:95], a[36:39]
    v_mfma_f32_16x16x32_bf16 a[40:43], a[140:143], a[92:95], 0
    v_mfma_f32_16x16x32_bf16 a[40:43], a[124:127], a[88:91], a[40:43]
    v_mfma_f32_16x16x32_bf16 a[44:47], a[128:131], a[88:91], 0
    v_mfma_f32_16x16x32_bf16 a[44:47], a[144:147], a[92:95], a[44:47]
    v_mfma_f32_16x16x32_bf16 v[140:143], a[132:135], a[92:95], 0
    v_mfma_f32_16x16x32_bf16 v[140:143], a[116:119], a[88:91], v[140:143]
    s_waitcnt vmcnt(12)
    buffer_load_dwordx4 a[88:91], v22, s[28:31], s59 offen offset:1024 sc1
    v_mfma_f32_16x16x32_bf16 a[52:55], a[152:155], a[96:99], a[52:55]
    s_waitcnt vmcnt(12)
    buffer_load_dwordx4 a[92:95], v23, s[28:31], s59 offen offset:1024 sc1
    v_mfma_f32_16x16x32_bf16 a[52:55], a[168:171], a[100:103], a[52:55]
    v_mfma_f32_16x16x32_bf16 a[56:59], a[172:175], a[100:103], a[56:59]
    v_mfma_f32_16x16x32_bf16 a[56:59], a[156:159], a[96:99], a[56:59]
    v_mfma_f32_16x16x32_bf16 a[60:63], a[160:163], a[96:99], a[60:63]
    v_mfma_f32_16x16x32_bf16 a[60:63], a[176:179], a[100:103], a[60:63]
    v_mfma_f32_16x16x32_bf16 v[144:147], a[164:167], a[100:103], v[144:147]
    v_mfma_f32_16x16x32_bf16 v[144:147], a[148:151], a[96:99], v[144:147]
    s_waitcnt vmcnt(12)
    buffer_load_dwordx4 a[96:99], v22, s[28:31], s59 offen offset:2048 sc1
    v_mfma_f32_16x16x32_bf16 a[4:7], a[152:155], v[64:67], a[4:7]
    s_waitcnt vmcnt(12)
    buffer_load_dwordx4 a[100:103], v23, s[28:31], s59 offen offset:2048 sc1
    v_mfma_f32_16x16x32_bf16 a[4:7], a[168:171], v[68:71], a[4:7]
    s_add_u32 s59, s65, 7168
    v_mfma_f32_16x16x32_bf16 a[8:11], a[172:175], v[68:71], a[8:11]
    v_mfma_f32_16x16x32_bf16 a[8:11], a[156:159], v[64:67], a[8:11]
    v_mfma_f32_16x16x32_bf16 a[12:15], a[160:163], v[64:67], a[12:15]
    v_mfma_f32_16x16x32_bf16 a[12:15], a[176:179], v[68:71], a[12:15]
    v_mfma_f32_16x16x32_bf16 v[132:135], a[164:167], v[68:71], v[132:135]
    v_mfma_f32_16x16x32_bf16 v[132:135], a[148:151], v[64:67], v[132:135]
    s_waitcnt vmcnt(12)
    buffer_load_dwordx4 v[64:67], v15, s[28:31], s59 offen offset:3072 sc1
    v_mfma_f32_16x16x32_bf16 a[20:23], a[152:155], v[72:75], a[20:23]
    s_waitcnt vmcnt(12)
    buffer_load_dwordx4 v[68:71], v15, s[28:31], s59 offen offset:3200 sc1
    v_mfma_f32_16x16x32_bf16 a[20:23], a[168:171], v[76:79], a[20:23]
    v_mfma_f32_16x16x32_bf16 a[24:27], a[172:175], v[76:79], a[24:27]
    v_mfma_f32_16x16x32_bf16 a[24:27], a[156:159], v[72:75], a[24:27]
    v_mfma_f32_16x16x32_bf16 a[28:31], a[160:163], v[72:75], a[28:31]
    v_mfma_f32_16x16x32_bf16 a[28:31], a[176:179], v[76:79], a[28:31]
    v_mfma_f32_16x16x32_bf16 v[136:139], a[164:167], v[76:79], v[136:139]
    v_mfma_f32_16x16x32_bf16 v[136:139], a[148:151], v[72:75], v[136:139]
    s_waitcnt vmcnt(12)
    buffer_load_dwordx4 v[72:75], v22, s[28:31], s59 offen offset:0 sc1
    v_mfma_f32_16x16x32_bf16 a[36:39], a[152:155], a[64:67], a[36:39]
    s_waitcnt vmcnt(12)
    buffer_load_dwordx4 v[76:79], v23, s[28:31], s59 offen offset:0 sc1
    v_mfma_f32_16x16x32_bf16 a[36:39], a[168:171], a[68:71], a[36:39]
    v_mfma_f32_16x16x32_bf16 a[40:43], a[172:175], a[68:71], a[40:43]
    v_mfma_f32_16x16x32_bf16 a[40:43], a[156:159], a[64:67], a[40:43]
    v_mfma_f32_16x16x32_bf16 a[44:47], a[160:163], a[64:67], a[44:47]
    v_mfma_f32_16x16x32_bf16 a[44:47], a[176:179], a[68:71], a[44:47]
    v_mfma_f32_16x16x32_bf16 v[140:143], a[164:167], a[68:71], v[140:143]
    v_mfma_f32_16x16x32_bf16 v[140:143], a[148:151], a[64:67], v[140:143]
    s_waitcnt vmcnt(12)
    buffer_load_dwordx4 a[64:67], v22, s[28:31], s59 offen offset:1024 sc1
    v_mfma_f32_16x16x32_bf16 a[52:55], a[184:187], a[72:75], a[52:55]
    s_waitcnt vmcnt(12)
    buffer_load_dwordx4 a[68:71], v23, s[28:31], s59 offen offset:1024 sc1
    v_mfma_f32_16x16x32_bf16 a[52:55], a[200:203], a[76:79], a[52:55]
    v_mfma_f32_16x16x32_bf16 a[56:59], a[204:207], a[76:79], a[56:59]
    v_mfma_f32_16x16x32_bf16 a[56:59], a[188:191], a[72:75], a[56:59]
    v_mfma_f32_16x16x32_bf16 a[60:63], a[192:195], a[72:75], a[60:63]
    v_mfma_f32_16x16x32_bf16 a[60:63], a[208:211], a[76:79], a[60:63]
    v_mfma_f32_16x16x32_bf16 v[144:147], a[196:199], a[76:79], v[144:147]
    v_mfma_f32_16x16x32_bf16 v[144:147], a[180:183], a[72:75], v[144:147]
    s_waitcnt vmcnt(11)
    buffer_load_dwordx4 a[72:75], v22, s[28:31], s59 offen offset:2048 sc1
    v_mfma_f32_16x16x32_bf16 a[4:7], a[184:187], a[80:83], a[4:7]
    s_waitcnt vmcnt(11)
    buffer_load_dwordx4 a[76:79], v23, s[28:31], s59 offen offset:2048 sc1
    v_mfma_f32_16x16x32_bf16 a[4:7], a[200:203], a[84:87], a[4:7]
    s_waitcnt vmcnt(12)
    v_cmp_ne_u32 vcc, 1, v28
    s_mov_b32 s53, 1000000
    s_nop 3
    s_cbranch_vccz L_ob_ok
L_ob_spin:
    buffer_load_dword v28, v19, s[28:31], 0 offen sc1
    s_waitcnt vmcnt(0)
    v_cmp_ne_u32 vcc, 1, v28
    s_sub_u32 s53, s53, 1
    s_cmp_eq_u32 s53, 0
    s_cbranch_scc1 L_ob_ok
    s_nop 1
    s_cbranch_vccnz L_ob_spin
L_ob_ok:
    v_mfma_f32_16x16x32_bf16 a[8:11], a[204:207], a[84:87], a[8:11]
    s_add_u32 s59, s66, 0
    v_mfma_f32_16x16x32_bf16 a[8:11], a[188:191], a[80:83], a[8:11]
    v_mfma_f32_16x16x32_bf16 a[12:15], a[192:195], a[80:83], a[12:15]
    v_mfma_f32_16x16x32_bf16 a[12:15], a[208:211], a[84:87], a[12:15]
    v_mfma_f32_16x16x32_bf16 v[132:135], a[196:199], a[84:87], v[132:135]
    v_mfma_f32_16x16x32_bf16 v[132:135], a[180:183], a[80:83], v[132:135]
    s_waitcnt vmcnt(11)
    buffer_load_dwordx4 a[80:83], v15, s[28:31], s59 offen offset:3072 sc1
    v_mfma_f32_16x16x32_bf16 a[20:23], a[184:187], a[88:91], a[20:23]
    s_waitcnt vmcnt(11)
    buffer_load_dwordx4 a[84:87], v15, s[28:31], s59 offen offset:3200 sc1
    v_mfma_f32_16x16x32_bf16 a[20:23], a[200:203], a[92:95], a[20:23]
    v_mfma_f32_16x16x32_bf16 a[24:27], a[204:207], a[92:95], a[24:27]
    v_mfma_f32_16x16x32_bf16 a[24:27], a[188:191], a[88:91], a[24:27]
    v_mfma_f32_16x16x32_bf16 a[28:31], a[192:195], a[88:91], a[28:31]
    v_mfma_f32_16x16x32_bf16 a[28:31], a[208:211], a[92:95], a[28:31]
    v_mfma_f32_16x16x32_bf16 v[136:139], a[196:199], a[92:95], v[136:139]
    v_mfma_f32_16x16x32_bf16 v[136:139], a[180:183], a[88:91], v[136:139]
    s_waitcnt vmcnt(11)
    buffer_load_dwordx4 a[88:91], v22, s[28:31], s59 offen offset:0 sc1
    v_mfma_f32_16x16x32_bf16 a[36:39], a[184:187], a[96:99], a[36:39]
    s_waitcnt vmcnt(11)
    buffer_load_dwordx4 a[92:95], v23, s[28:31], s59 offen offset:0 sc1
    v_mfma_f32_16x16x32_bf16 a[36:39], a[200:203], a[100:103], a[36:39]
    v_mfma_f32_16x16x32_bf16 a[40:43], a[204:207], a[100:103], a[40:43]
    v_mfma_f32_16x16x32_bf16 a[40:43], a[188:191], a[96:99], a[40:43]
    v_mfma_f32_16x16x32_bf16 a[44:47], a[192:195], a[96:99], a[44:47]
    v_mfma_f32_16x16x32_bf16 a[44:47], a[208:211], a[100:103], a[44:47]
    v_mfma_f32_16x16x32_bf16 v[140:143], a[196:199], a[100:103], v[140:143]
    v_mfma_f32_16x16x32_bf16 v[140:143], a[180:183], a[96:99], v[140:143]
    s_waitcnt vmcnt(11)
    buffer_load_dwordx4 a[96:99], v22, s[28:31], s59 offen offset:1024 sc1
    v_mfma_f32_16x16x32_bf16 a[52:55], a[216:219], v[64:67], a[52:55]
    s_waitcnt vmcnt(11)
    buffer_load_dwordx4 a[100:103], v23, s[28:31], s59 offen offset:1024 sc1
    v_mfma_f32_16x16x32_bf16 a[52:55], a[232:235], v[68:71], a[52:55]
    v_mfma_f32_16x16x32_bf16 a[56:59], a[236:239], v[68:71], a[56:59]
    v_mfma_f32_16x16x32_bf16 a[56:59], a[220:223], v[64:67], a[56:59]
    v_mfma_f32_16x16x32_bf16 a[60:63], a[224:227], v[64:67], a[60:63]
    v_mfma_f32_16x16x32_bf16 a[60:63], a[240:243], v[68:71], a[60:63]
    v_mfma_f32_16x16x32_bf16 v[144:147], a[228:231], v[68:71], v[144:147]
    v_mfma_f32_16x16x32_bf16 v[144:147], a[212:215], v[64:67], v[144:147]
    s_waitcnt vmcnt(11)
    buffer_load_dwordx4 v[64:67], v22, s[28:31], s59 offen offset:2048 sc1
    v_mfma_f32_16x16x32_bf16 a[4:7], a[216:219], v[72:75], a[4:7]
    s_waitcnt vmcnt(11)
    buffer_load_dwordx4 v[68:71], v23, s[28:31], s59 offen offset:2048 sc1
    v_mfma_f32_16x16x32_bf16 a[4:7], a[232:235], v[76:79], a[4:7]
    s_add_u32 s59, s66, 7168
    v_mfma_f32_16x16x32_bf16 a[8:11], a[236:239], v[76:79], a[8:11]
    v_mfma_f32_16x16x32_bf16 a[8:11], a[220:223], v[72:75], a[8:11]
    v_mfma_f32_16x16x32_bf16 a[12:15], a[224:227], v[72:75], a[12:15]
    v_mfma_f32_16x16x32_bf16 a[12:15], a[240:243], v[76:79], a[12:15]
    v_mfma_f32_16x16x32_bf16 v[132:135], a[228:231], v[76:79], v[132:135]
    v_mfma_f32_16x16x32_bf16 v[132:135], a[212:215], v[72:75], v[132:135]
    s_waitcnt vmcnt(11)
    buffer_load_dwordx4 v[72:75], v15, s[28:31], s59 offen offset:3072 sc1
    v_mfma_f32_16x16x32_bf16 a[20:23], a[216:219], a[64:67], a[20:23]
    s_waitcnt vmcnt(11)
    buffer_load_dwordx4 v[76:79], v15, s[28:31], s59 offen offset:3200 sc1
    v_mfma_f32_16x16x32_bf16 a[20:23], a[232:235], a[68:71], a[20:23]
    v_mfma_f32_16x16x32_bf16 a[24:27], a[236:239], a[68:71], a[24:27]
    v_mfma_f32_16x16x32_bf16 a[24:27], a[220:223], a[64:67], a[24:27]
    v_mfma_f32_16x16x32_bf16 a[28:31], a[224:227], a[64:67], a[28:31]
    v_mfma_f32_16x16x32_bf16 a[28:31], a[240:243], a[68:71], a[28:31]
    v_mfma_f32_16x16x32_bf16 v[136:139], a[228:231], a[68:71], v[136:139]
    v_mfma_f32_16x16x32_bf16 v[136:139], a[212:215], a[64:67], v[136:139]
    s_waitcnt vmcnt(11)
    buffer_load_dwordx4 a[64:67], v22, s[28:31], s59 offen offset:0 sc1
    v_mfma_f32_16x16x32_bf16 a[36:39], a[216:219], a[72:75], a[36:39]
    s_waitcnt vmcnt(11)
    buffer_load_dwordx4 a[68:71], v23, s[28:31], s59 offen offset:0 sc1
    v_mfma_f32_16x16x32_bf16 a[36:39], a[232:235], a[76:79], a[36:39]
    v_mfma_f32_16x16x32_bf16 a[40:43], a[236:239], a[76:79], a[40:43]
    v_mfma_f32_16x16x32_bf16 a[40:43], a[220:223], a[72:75], a[40:43]
    v_mfma_f32_16x16x32_bf16 a[44:47], a[224:227], a[72:75], a[44:47]
    v_mfma_f32_16x16x32_bf16 a[44:47], a[240:243], a[76:79], a[44:47]
    v_mfma_f32_16x16x32_bf16 v[140:143], a[228:231], a[76:79], v[140:143]
    s_waitcnt lgkmcnt(0)
    v_mfma_f32_16x16x32_bf16 v[140:143], a[212:215], a[72:75], v[140:143]
    s_waitcnt vmcnt(11)
    buffer_load_dwordx4 a[72:75], v22, s[28:31], s59 offen offset:1024 sc1
    v_mfma_f32_16x16x32_bf16 a[52:55], a[248:251], a[80:83], a[52:55]
    s_waitcnt vmcnt(11)
    buffer_load_dwordx4 a[76:79], v23, s[28:31], s59 offen offset:1024 sc1
    v_mfma_f32_16x16x32_bf16 a[52:55], v[56:59], a[84:87], a[52:55]
    v_mfma_f32_16x16x32_bf16 a[56:59], v[60:63], a[84:87], a[56:59]
    v_mfma_f32_16x16x32_bf16 a[56:59], a[252:255], a[80:83], a[56:59]
    v_mfma_f32_16x16x32_bf16 a[60:63], v[52:55], a[80:83], a[60:63]
    v_mfma_f32_16x16x32_bf16 a[60:63], a[104:107], a[84:87], a[60:63]
    v_mfma_f32_16x16x32_bf16 v[144:147], v[48:51], a[84:87], v[144:147]
    v_mfma_f32_16x16x32_bf16 v[144:147], a[244:247], a[80:83], v[144:147]
    s_waitcnt vmcnt(11)
    buffer_load_dwordx4 a[80:83], v22, s[28:31], s59 offen offset:2048 sc1
    v_mfma_f32_16x16x32_bf16 a[4:7], a[248:251], a[88:91], a[4:7]
    s_waitcnt vmcnt(11)
    buffer_load_dwordx4 a[84:87], v23, s[28:31], s59 offen offset:2048 sc1
    v_mfma_f32_16x16x32_bf16 a[4:7], v[56:59], a[92:95], a[4:7]
    s_add_u32 s59, s67, 0
    v_mfma_f32_16x16x32_bf16 a[8:11], v[60:63], a[92:95], a[8:11]
    v_mfma_f32_16x16x32_bf16 a[8:11], a[252:255], a[88:91], a[8:11]
    v_mfma_f32_16x16x32_bf16 a[12:15], v[52:55], a[88:91], a[12:15]
    v_mfma_f32_16x16x32_bf16 a[12:15], a[104:107], a[92:95], a[12:15]
    v_mfma_f32_16x16x32_bf16 v[132:135], v[48:51], a[92:95], v[132:135]
    v_mfma_f32_16x16x32_bf16 v[132:135], a[244:247], a[88:91], v[132:135]
    s_waitcnt vmcnt(11)
    buffer_load_dwordx4 a[88:91], v15, s[28:31], s59 offen offset:3072 sc1
    v_mfma_f32_16x16x32_bf16 a[20:23], a[248:251], a[96:99], a[20:23]
    s_waitcnt vmcnt(11)
    buffer_load_dwordx4 a[92:95], v15, s[28:31], s59 offen offset:3200 sc1
    v_mfma_f32_16x16x32_bf16 a[20:23], v[56:59], a[100:103], a[20:23]
    v_mfma_f32_16x16x32_bf16 a[24:27], v[60:63], a[100:103], a[24:27]
    v_mfma_f32_16x16x32_bf16 a[24:27], a[252:255], a[96:99], a[24:27]
    v_mfma_f32_16x16x32_bf16 a[28:31], v[52:55], a[96:99], a[28:31]
    v_mfma_f32_16x16x32_bf16 a[28:31], a[104:107], a[100:103], a[28:31]
    v_mfma_f32_16x16x32_bf16 v[136:139], v[48:51], a[100:103], v[136:139]
    v_mfma_f32_16x16x32_bf16 v[136:139], a[244:247], a[96:99], v[136:139]
    s_waitcnt vmcnt(11)
    buffer_load_dwordx4 a[96:99], v22, s[28:31], s59 offen offset:0 sc1
    v_mfma_f32_16x16x32_bf16 a[36:39], a[248:251], v[64:67], a[36:39]
    s_waitcnt vmcnt(11)
    buffer_load_dwordx4 a[100:103], v23, s[28:31], s59 offen offset:0 sc1
    v_mfma_f32_16x16x32_bf16 a[36:39], v[56:59], v[68:71], a[36:39]
    v_mfma_f32_16x16x32_bf16 a[40:43], v[60:63], v[68:71], a[40:43]
    v_mfma_f32_16x16x32_bf16 a[40:43], a[252:255], v[64:67], a[40:43]
    v_mfma_f32_16x16x32_bf16 a[44:47], v[52:55], v[64:67], a[44:47]
    v_mfma_f32_16x16x32_bf16 a[44:47], a[104:107], v[68:71], a[44:47]
    v_mfma_f32_16x16x32_bf16 v[140:143], v[48:51], v[68:71], v[140:143]
    v_mfma_f32_16x16x32_bf16 v[140:143], a[244:247], v[64:67], v[140:143]
    s_waitcnt vmcnt(11)
    buffer_load_dwordx4 v[64:67], v22, s[28:31], s59 offen offset:1024 sc1
    v_mfma_f32_16x16x32_bf16 a[52:55], a[112:115], v[72:75], a[52:55]
    s_waitcnt vmcnt(11)
    buffer_load_dwordx4 v[68:71], v23, s[28:31], s59 offen offset:1024 sc1
    v_mfma_f32_16x16x32_bf16 a[52:55], v[176:179], v[76:79], a[52:55]
    v_mfma_f32_16x16x32_bf16 a[56:59], v[180:183], v[76:79], a[56:59]
    v_mfma_f32_16x16x32_bf16 a[56:59], v[164:167], v[72:75], a[56:59]
    v_mfma_f32_16x16x32_bf16 a[60:63], v[168:171], v[72:75], a[60:63]
    v_mfma_f32_16x16x32_bf16 a[60:63], v[184:187], v[76:79], a[60:63]
    v_mfma_f32_16x16x32_bf16 v[144:147], v[172:175], v[76:79], v[144:147]
    v_mfma_f32_16x16x32_bf16 v[144:147], a[108:111], v[72:75], v[144:147]
    s_waitcnt vmcnt(11)
    buffer_load_dwordx4 v[72:75], v22, s[28:31], s59 offen offset:2048 sc1
    v_mfma_f32_16x16x32_bf16 a[4:7], a[112:115], a[64:67], a[4:7]
    s_waitcnt vmcnt(11)
    buffer_load_dwordx4 v[76:79], v23, s[28:31], s59 offen offset:2048 sc1
    v_mfma_f32_16x16x32_bf16 a[4:7], v[176:179], a[68:71], a[4:7]
    s_add_u32 s59, s67, 7168
    v_mfma_f32_16x16x32_bf16 a[8:11], v[180:183], a[68:71], a[8:11]
    v_mfma_f32_16x16x32_bf16 a[8:11], v[164:167], a[64:67], a[8:11]
    v_mfma_f32_16x16x32_bf16 a[12:15], v[168:171], a[64:67], a[12:15]
    v_mfma_f32_16x16x32_bf16 a[12:15], v[184:187], a[68:71], a[12:15]
    v_mfma_f32_16x16x32_bf16 v[132:135], v[172:175], a[68:71], v[132:135]
    v_mfma_f32_16x16x32_bf16 v[132:135], a[108:111], a[64:67], v[132:135]
    s_waitcnt vmcnt(11)
    buffer_load_dwordx4 a[64:67], v15, s[28:31], s59 offen offset:3072 sc1
    v_mfma_f32_16x16x32_bf16 a[20:23], a[112:115], a[72:75], a[20:23]
    s_waitcnt vmcnt(11)
    buffer_load_dwordx4 a[68:71], v15, s[28:31], s59 offen offset:3200 sc1
    v_mfma_f32_16x16x32_bf16 a[20:23], v[176:179], a[76:79], a[20:23]
    v_mfma_f32_16x16x32_bf16 a[24:27], v[180:183], a[76:79], a[24:27]
    v_mfma_f32_16x16x32_bf16 a[24:27], v[164:167], a[72:75], a[24:27]
    v_mfma_f32_16x16x32_bf16 a[28:31], v[168:171], a[72:75], a[28:31]
    v_mfma_f32_16x16x32_bf16 a[28:31], v[184:187], a[76:79], a[28:31]
    v_mfma_f32_16x16x32_bf16 v[136:139], v[172:175], a[76:79], v[136:139]
    v_mfma_f32_16x16x32_bf16 v[136:139], a[108:111], a[72:75], v[136:139]
    s_waitcnt vmcnt(11)
    buffer_load_dwordx4 a[72:75], v22, s[28:31], s59 offen offset:0 sc1
    v_mfma_f32_16x16x32_bf16 a[36:39], a[112:115], a[80:83], a[36:39]
    s_waitcnt vmcnt(11)
    buffer_load_dwordx4 a[76:79], v23, s[28:31], s59 offen offset:0 sc1
    v_mfma_f32_16x16x32_bf16 a[36:39], v[176:179], a[84:87], a[36:39]
    v_mfma_f32_16x16x32_bf16 a[40:43], v[180:183], a[84:87], a[40:43]
    v_mfma_f32_16x16x32_bf16 a[40:43], v[164:167], a[80:83], a[40:43]
    v_mfma_f32_16x16x32_bf16 a[44:47], v[168:171], a[80:83], a[44:47]
    v_mfma_f32_16x16x32_bf16 a[44:47], v[184:187], a[84:87], a[44:47]
    v_mfma_f32_16x16x32_bf16 v[140:143], v[172:175], a[84:87], v[140:143]
    v_mfma_f32_16x16x32_bf16 v[140:143], a[108:111], a[80:83], v[140:143]
    s_waitcnt vmcnt(11)
    buffer_load_dwordx4 a[80:83], v22, s[28:31], s59 offen offset:1024 sc1
    v_mfma_f32_16x16x32_bf16 a[52:55], v[192:195], a[88:91], a[52:55]
    s_waitcnt vmcnt(11)
    buffer_load_dwordx4 a[84:87], v23, s[28:31], s59 offen offset:1024 sc1
    v_mfma_f32_16x16x32_bf16 a[52:55], v[208:211], a[92:95], a[52:55]
    v_mfma_f32_16x16x32_bf16 a[56:59], v[212:215], a[92:95], a[56:59]
    v_mfma_f32_16x16x32_bf16 a[56:59], v[196:199], a[88:91], a[56:59]
    v_mfma_f32_16x16x32_bf16 a[60:63], v[200:203], a[88:91], a[60:63]
    v_mfma_f32_16x16x32_bf16 a[60:63], v[216:219], a[92:95], a[60:63]
    v_mfma_f32_16x16x32_bf16 v[144:147], v[204:207], a[92:95], v[144:147]
    v_mfma_f32_16x16x32_bf16 v[144:147], v[188:191], a[88:91], v[144:147]
    s_waitcnt vmcnt(11)
    buffer_load_dwordx4 a[88:91], v22, s[28:31], s59 offen offset:2048 sc1
    v_mfma_f32_16x16x32_bf16 a[4:7], v[192:195], a[96:99], a[4:7]
    s_waitcnt vmcnt(11)
    buffer_load_dwordx4 a[92:95], v23, s[28:31], s59 offen offset:2048 sc1
    v_mfma_f32_16x16x32_bf16 a[4:7], v[208:211], a[100:103], a[4:7]
    s_add_u32 s59, s68, 0
    v_mfma_f32_16x16x32_bf16 a[8:11], v[212:215], a[100:103], a[8:11]
    v_mfma_f32_16x16x32_bf16 a[8:11], v[196:199], a[96:99], a[8:11]
    v_mfma_f32_16x16x32_bf16 a[12:15], v[200:203], a[96:99], a[12:15]
    v_mfma_f32_16x16x32_bf16 a[12:15], v[216:219], a[100:103], a[12:15]
    v_mfma_f32_16x16x32_bf16 v[132:135], v[204:207], a[100:103], v[132:135]
    v_mfma_f32_16x16x32_bf16 v[132:135], v[188:191], a[96:99], v[132:135]
    s_waitcnt vmcnt(11)
    buffer_load_dwordx4 a[96:99], v22, s[28:31], s59 offen offset:0 sc1
    v_mfma_f32_16x16x32_bf16 a[20:23], v[192:195], v[64:67], a[20:23]
    s_waitcnt vmcnt(11)
    buffer_load_dwordx4 a[100:103], v23, s[28:31], s59 offen offset:0 sc1
    v_mfma_f32_16x16x32_bf16 a[20:23], v[208:211], v[68:71], a[20:23]
    v_mfma_f32_16x16x32_bf16 a[24:27], v[212:215], v[68:71], a[24:27]
    v_mfma_f32_16x16x32_bf16 a[24:27], v[196:199], v[64:67], a[24:27]
    v_mfma_f32_16x16x32_bf16 a[28:31], v[200:203], v[64:67], a[28:31]
    v_mfma_f32_16x16x32_bf16 a[28:31], v[216:219], v[68:71], a[28:31]
    v_mfma_f32_16x16x32_bf16 v[136:139], v[204:207], v[68:71], v[136:139]
    v_mfma_f32_16x16x32_bf16 v[136:139], v[188:191], v[64:67], v[136:139]
    s_waitcnt vmcnt(11)
    buffer_load_dwordx4 v[64:67], v22, s[28:31], s59 offen offset:1024 sc1
    v_mfma_f32_16x16x32_bf16 a[36:39], v[192:195], v[72:75], a[36:39]
    s_waitcnt vmcnt(11)
    buffer_load_dwordx4 v[68:71], v23, s[28:31], s59 offen offset:1024 sc1
    v_mfma_f32_16x16x32_bf16 a[36:39], v[208:211], v[76:79], a[36:39]
    v_mfma_f32_16x16x32_bf16 a[40:43], v[212:215], v[76:79], a[40:43]
    v_mfma_f32_16x16x32_bf16 a[40:43], v[196:199], v[72:75], a[40:43]
    v_mfma_f32_16x16x32_bf16 a[44:47], v[200:203], v[72:75], a[44:47]
    v_mfma_f32_16x16x32_bf16 a[44:47], v[216:219], v[76:79], a[44:47]
    v_mfma_f32_16x16x32_bf16 v[140:143], v[204:207], v[76:79], v[140:143]
    v_mfma_f32_16x16x32_bf16 v[140:143], v[188:191], v[72:75], v[140:143]
    s_waitcnt vmcnt(11)
    buffer_load_dwordx4 v[72:75], v22, s[28:31], s59 offen offset:2048 sc1
    v_mfma_f32_16x16x32_bf16 a[52:55], v[224:227], a[64:67], a[52:55]
    s_waitcnt vmcnt(11)
    buffer_load_dwordx4 v[76:79], v23, s[28:31], s59 offen offset:2048 sc1
    v_mfma_f32_16x16x32_bf16 a[52:55], v[240:243], a[68:71], a[52:55]
    s_add_u32 s59, s68, 7168
    v_mfma_f32_16x16x32_bf16 a[56:59], v[244:247], a[68:71], a[56:59]
    v_mfma_f32_16x16x32_bf16 a[56:59], v[228:231], a[64:67], a[56:59]
    v_mfma_f32_16x16x32_bf16 a[60:63], v[232:235], a[64:67], a[60:63]
    v_mfma_f32_16x16x32_bf16 a[60:63], v[248:251], a[68:71], a[60:63]
    v_mfma_f32_16x16x32_bf16 v[144:147], v[236:239], a[68:71], v[144:147]
    v_mfma_f32_16x16x32_bf16 v[144:147], v[220:223], a[64:67], v[144:147]
    s_waitcnt vmcnt(11)
    buffer_load_dwordx4 a[64:67], v22, s[28:31], s59 offen offset:0 sc1
    v_mfma_f32_16x16x32_bf16 a[4:7], v[224:227], a[72:75], a[4:7]
    s_waitcnt vmcnt(11)
    buffer_load_dwordx4 a[68:71], v23, s[28:31], s59 offen offset:0 sc1
    v_mfma_f32_16x16x32_bf16 a[4:7], v[240:243], a[76:79], a[4:7]
    v_mfma_f32_16x16x32_bf16 a[8:11], v[244:247], a[76:79], a[8:11]
    v_mfma_f32_16x16x32_bf16 a[8:11], v[228:231], a[72:75], a[8:11]
    v_mfma_f32_16x16x32_bf16 a[12:15], v[232:235], a[72:75], a[12:15]
    v_mfma_f32_16x16x32_bf16 a[12:15], v[248:251], a[76:79], a[12:15]
    v_mfma_f32_16x16x32_bf16 v[132:135], v[236:239], a[76:79], v[132:135]
    v_mfma_f32_16x16x32_bf16 v[132:135], v[220:223], a[72:75], v[132:135]
    s_waitcnt vmcnt(11)
    buffer_load_dwordx4 a[72:75], v22, s[28:31], s59 offen offset:1024 sc1
    v_mfma_f32_16x16x32_bf16 a[20:23], v[224:227], a[80:83], a[20:23]
    s_waitcnt vmcnt(11)
    buffer_load_dwordx4 a[76:79], v23, s[28:31], s59 offen offset:1024 sc1
    v_mfma_f32_16x16x32_bf16 a[20:23], v[240:243], a[84:87], a[20:23]
    ds_write_b128 v27, a[4:7] offset:1024
    v_mfma_f32_16x16x32_bf16 a[24:27], v[244:247], a[84:87], a[24:27]
    ds_write_b128 v27, a[8:11] offset:2048
    v_mfma_f32_16x16x32_bf16 a[24:27], v[228:231], a[80:83], a[24:27]
    ds_write_b128 v27, a[12:15] offset:3072
    v_mfma_f32_16x16x32_bf16 a[28:31], v[232:235], a[80:83], a[28:31]
    v_mfma_f32_16x16x32_bf16 a[28:31], v[248:251], a[84:87], a[28:31]
    v_mfma_f32_16x16x32_bf16 v[136:139], v[236:239], a[84:87], v[136:139]
    ds_write_b128 v27, a[20:23] offset:17408
    v_mfma_f32_16x16x32_bf16 v[136:139], v[220:223], a[80:83], v[136:139]
    s_waitcnt vmcnt(11)
    buffer_load_dwordx4 a[80:83], v22, s[28:31], s59 offen offset:2048 sc1
    v_mfma_f32_16x16x32_bf16 a[36:39], v[224:227], a[88:91], a[36:39]
    s_waitcnt vmcnt(11)
    buffer_load_dwordx4 a[84:87], v23, s[28:31], s59 offen offset:2048 sc1
    v_mfma_f32_16x16x32_bf16 a[36:39], v[240:243], a[92:95], a[36:39]
    s_add_u32 s59, s69, 0
    ds_write_b128 v27, a[24:27] offset:18432
    v_mfma_f32_16x16x32_bf16 a[40:43], v[244:247], a[92:95], a[40:43]
    ds_write_b128 v27, a[28:31] offset:19456
    v_mfma_f32_16x16x32_bf16 a[40:43], v[228:231], a[88:91], a[40:43]
    ds_write_b128 v27, a[52:55] offset:50176
    v_mfma_f32_16x16x32_bf16 a[44:47], v[232:235], a[88:91], a[44:47]
    ds_write_b128 v27, a[56:59] offset:51200
    v_mfma_f32_16x16x32_bf16 a[44:47], v[248:251], a[92:95], a[44:47]
    ds_write_b128 v27, a[36:39] offset:33792
    v_mfma_f32_16x16x32_bf16 v[140:143], v[236:239], a[92:95], v[140:143]
    ds_write_b128 v27, a[60:63] offset:52224
    v_mfma_f32_16x16x32_bf16 v[140:143], v[220:223], a[88:91], v[140:143]
    s_waitcnt vmcnt(11)
    buffer_load_dwordx4 a[88:91], v22, s[28:31], s59 offen offset:0 sc1
    v_mfma_f32_16x16x32_bf16 a[4:7], a[120:123], a[96:99], 0
    s_waitcnt vmcnt(11)
    buffer_load_dwordx4 a[92:95], v23, s[28:31], s59 offen offset:0 sc1
    v_mfma_f32_16x16x32_bf16 a[4:7], a[136:139], a[100:103], a[4:7]
    ds_write_b128 v27, a[40:43] offset:34816
    v_mfma_f32_16x16x32_bf16 a[8:11], a[140:143], a[100:103], 0
    ds_write_b128 v27, a[44:47] offset:35840
    v_mfma_f32_16x16x32_bf16 a[8:11], a[124:127], a[96:99], a[8:11]
    v_mfma_f32_16x16x32_bf16 a[12:15], a[128:131], a[96:99], 0
    v_mfma_f32_16x16x32_bf16 a[12:15], a[144:147], a[100:103], a[12:15]
    v_mfma_f32_16x16x32_bf16 v[80:83], a[132:135], a[100:103], 0
    s_waitcnt lgkmcnt(0)
    s_barrier
    ds_read_b128 v[84:87], v2 offset:1024
    v_mfma_f32_16x16x32_bf16 v[80:83], a[116:119], a[96:99], v[80:83]
    s_waitcnt vmcnt(11)
    buffer_load_dwordx4 a[96:99], v22, s[28:31], s59 offen offset:1024 sc1
    v_mfma_f32_16x16x32_bf16 a[20:23], a[120:123], v[64:67], 0
    s_waitcnt vmcnt(11)
    buffer_load_dwordx4 a[100:103], v23, s[28:31], s59 offen offset:1024 sc1
    v_mfma_f32_16x16x32_bf16 a[20:23], a[136:139], v[68:71], a[20:23]
    ds_read_b128 v[88:91], v3 offset:2048
    ds_read_b128 v[92:95], v6 offset:3072
    v_mfma_f32_16x16x32_bf16 a[24:27], a[140:143], v[68:71], 0
    ds_read_b128 v[96:99], v2 offset:17408
    ds_read_b128 v[100:103], v3 offset:18432
    v_mfma_f32_16x16x32_bf16 a[24:27], a[124:127], v[64:67], a[24:27]
    ds_read_b128 v[104:107], v6 offset:19456
    ds_read_b128 v[108:111], v2 offset:33792
    v_mfma_f32_16x16x32_bf16 a[28:31], a[128:131], v[64:67], 0
    ds_read_b128 v[112:115], v3 offset:34816
    ds_read_b128 v[116:119], v6 offset:35840
    v_mfma_f32_16x16x32_bf16 a[28:31], a[144:147], v[68:71], a[28:31]
    ds_read_b128 v[120:123], v2 offset:50176
    ds_read_b128 v[124:127], v3 offset:51200
    v_mfma_f32_16x16x32_bf16 v[252:255], a[132:135], v[68:71], 0
    ds_read_b128 v[128:131], v6 offset:52224
    v_mfma_f32_16x16x32_bf16 v[252:255], a[116:119], v[64:67], v[252:255]
    s_waitcnt vmcnt(11)
    buffer_load_dwordx4 v[64:67], v22, s[28:31], s59 offen offset:2048 sc1
    v_mfma_f32_16x16x32_bf16 a[36:39], a[120:123], v[72:75], 0
    s_waitcnt vmcnt(11)
    buffer_load_dwordx4 v[68:71], v23, s[28:31], s59 offen offset:2048 sc1
    v_mfma_f32_16x16x32_bf16 a[36:39], a[136:139], v[76:79], a[36:39]
    s_add_u32 s59, s69, 7168
    v_mfma_f32_16x16x32_bf16 a[40:43], a[140:143], v[76:79], 0
    s_waitcnt lgkmcnt(9)
    v_add_f32 v132, v132, v84
    v_add_f32 v133, v133, v85
    v_mfma_f32_16x16x32_bf16 a[40:43], a[124:127], v[72:75], a[40:43]
    v_add_f32 v134, v134, v86
    v_add_f32 v135, v135, v87
    v_mfma_f32_16x16x32_bf16 a[44:47], a[128:131], v[72:75], 0
    v_add_f32 v88, v88, v92
    v_add_f32 v89, v89, v93
    v_mfma_f32_16x16x32_bf16 a[44:47], a[144:147], v[76:79], a[44:47]
    v_add_f32 v90, v90, v94
    v_add_f32 v91, v91, v95
    v_mfma_f32_16x16x32_bf16 v[44:47], a[132:135], v[76:79], 0
    v_add_f32 v132, v132, v88
    v_add_f32 v133, v133, v89
    v_mfma_f32_16x16x32_bf16 v[44:47], a[116:119], v[72:75], v[44:47]
    s_waitcnt vmcnt(11)
    v_add_f32 v134, v134, v90
    v_add_f32 v135, v135, v91
    v_mfma_f32_16x16x32_bf16 a[4:7], a[152:155], a[64:67], a[4:7]
    s_waitcnt vmcnt(10)
    buffer_store_dwordx4 v[132:135], v8, s[28:31], 0 offen offset:0 sc1
    v_mfma_f32_16x16x32_bf16 a[4:7], a[168:171], a[68:71], a[4:7]
    buffer_load_dwordx4 v[72:75], v22, s[28:31], s59 offen offset:0 sc1
    v_mfma_f32_16x16x32_bf16 a[8:11], a[172:175], a[68:71], a[8:11]
    buffer_load_dwordx4 v[76:79], v23, s[28:31], s59 offen offset:0 sc1
    v_mfma_f32_16x16x32_bf16 a[8:11], a[156:159], a[64:67], a[8:11]
    s_waitcnt lgkmcnt(0)
    v_add_f32 v136, v136, v96
    v_add_f32 v137, v137, v97
    v_mfma_f32_16x16x32_bf16 a[12:15], a[160:163], a[64:67], a[12:15]
    v_add_f32 v138, v138, v98
    v_add_f32 v139, v139, v99
    v_mfma_f32_16x16x32_bf16 a[12:15], a[176:179], a[68:71], a[12:15]
    v_add_f32 v100, v100, v104
    v_add_f32 v101, v101, v105
    v_mfma_f32_16x16x32_bf16 v[80:83], a[164:167], a[68:71], v[80:83]
    v_add_f32 v102, v102, v106
    v_add_f32 v103, v103, v107
    v_mfma_f32_16x16x32_bf16 v[80:83], a[148:151], a[64:67], v[80:83]
    s_waitcnt vmcnt(12)
    v_add_f32 v136, v136, v100
    v_add_f32 v137, v137, v101
    v_mfma_f32_16x16x32_bf16 a[20:23], a[152:155], a[72:75], a[20:23]
    s_waitcnt vmcnt(11)
    v_add_f32 v138, v138, v102
    v_add_f32 v139, v139, v103
    v_mfma_f32_16x16x32_bf16 a[20:23], a[168:171], a[76:79], a[20:23]
    buffer_store_dwordx4 v[136:139], v8, s[28:31], 0 offen offset:1024 sc1
    v_mfma_f32_16x16x32_bf16 a[24:27], a[172:175], a[76:79], a[24:27]
    v_add_f32 v140, v140, v108
    v_add_f32 v141, v141, v109
    v_mfma_f32_16x16x32_bf16 a[24:27], a[156:159], a[72:75], a[24:27]
    v_add_f32 v142, v142, v110
    v_add_f32 v143, v143, v111
    v_mfma_f32_16x16x32_bf16 a[28:31], a[160:163], a[72:75], a[28:31]
    v_add_f32 v112, v112, v116
    v_add_f32 v113, v113, v117
    v_mfma_f32_16x16x32_bf16 a[28:31], a[176:179], a[76:79], a[28:31]
    v_add_f32 v114, v114, v118
    v_add_f32 v115, v115, v119
    v_mfma_f32_16x16x32_bf16 v[252:255], a[164:167], a[76:79], v[252:255]
    v_add_f32 v140, v140, v112
    v_add_f32 v141, v141, v113
    v_mfma_f32_16x16x32_bf16 v[252:255], a[148:151], a[72:75], v[252:255]
    s_waitcnt vmcnt(11)
    v_add_f32 v142, v142, v114
    v_add_f32 v143, v143, v115
    v_mfma_f32_16x16x32_bf16 a[36:39], a[152:155], a[80:83], a[36:39]
    s_waitcnt vmcnt(10)
    buffer_store_dwordx4 v[140:143], v8, s[28:31], 0 offen offset:2048 sc1
    v_mfma_f32_16x16x32_bf16 a[36:39], a[168:171], a[84:87], a[36:39]
    buffer_load_dwordx4 a[64:67], v22, s[28:31], s59 offen offset:1024 sc1
    v_mfma_f32_16x16x32_bf16 a[40:43], a[172:175], a[84:87], a[40:43]
    buffer_load_dwordx4 a[68:71], v23, s[28:31], s59 offen offset:1024 sc1
    v_mfma_f32_16x16x32_bf16 a[40:43], a[156:159], a[80:83], a[40:43]
    v_add_f32 v144, v144, v120
    v_add_f32 v145, v145, v121
    v_mfma_f32_16x16x32_bf16 a[44:47], a[160:163], a[80:83], a[44:47]
    v_add_f32 v146, v146, v122
    v_add_f32 v147, v147, v123
    v_mfma_f32_16x16x32_bf16 a[44:47], a[176:179], a[84:87], a[44:47]
    v_add_f32 v124, v124, v128
    v_add_f32 v125, v125, v129
    v_mfma_f32_16x16x32_bf16 v[44:47], a[164:167], a[84:87], v[44:47]
    v_add_f32 v126, v126, v130
    v_add_f32 v127, v127, v131
    v_mfma_f32_16x16x32_bf16 v[44:47], a[148:151], a[80:83], v[44:47]
    s_waitcnt vmcnt(12)
    v_add_f32 v144, v144, v124
    v_add_f32 v145, v145, v125
    v_mfma_f32_16x16x32_bf16 a[4:7], a[184:187], a[88:91], a[4:7]
    s_waitcnt vmcnt(11)
    v_add_f32 v146, v146, v126
    v_add_f32 v147, v147, v127
    v_mfma_f32_16x16x32_bf16 a[4:7], a[200:203], a[92:95], a[4:7]
    buffer_store_dwordx4 v[144:147], v20, s[28:31], 0 offen offset:3072 sc1
    v_mfma_f32_16x16x32_bf16 a[8:11], a[204:207], a[92:95], a[8:11]
    buffer_load_dwordx4 a[72:75], v22, s[28:31], s59 offen offset:2048 sc1
    v_mfma_f32_16x16x32_bf16 a[8:11], a[188:191], a[88:91], a[8:11]
    buffer_load_dwordx4 a[76:79], v23, s[28:31], s59 offen offset:2048 sc1
    v_mfma_f32_16x16x32_bf16 a[12:15], a[192:195], a[88:91], a[12:15]
    s_add_u32 s59, s70, 0
    buffer_load_dwordx4 a[80:83], v22, s[28:31], s59 offen offset:0 sc1
    v_mfma_f32_16x16x32_bf16 a[12:15], a[208:211], a[92:95], a[12:15]
    buffer_load_dwordx4 a[84:87], v23, s[28:31], s59 offen offset:0 sc1
    v_mfma_f32_16x16x32_bf16 v[80:83], a[196:199], a[92:95], v[80:83]
    v_mfma_f32_16x16x32_bf16 v[80:83], a[180:183], a[88:91], v[80:83]
    s_waitcnt vmcnt(15)
    buffer_load_dwordx4 a[88:91], v22, s[28:31], s59 offen offset:1024 sc1
    v_mfma_f32_16x16x32_bf16 a[20:23], a[184:187], a[96:99], a[20:23]
    s_waitcnt vmcnt(15)
    buffer_load_dwordx4 a[92:95], v23, s[28:31], s59 offen offset:1024 sc1
    v_mfma_f32_16x16x32_bf16 a[20:23], a[200:203], a[100:103], a[20:23]
    v_mfma_f32_16x16x32_bf16 a[24:27], a[204:207], a[100:103], a[24:27]
    v_mfma_f32_16x16x32_bf16 a[24:27], a[188:191], a[96:99], a[24:27]
    v_mfma_f32_16x16x32_bf16 a[28:31], a[192:195], a[96:99], a[28:31]
    v_mfma_f32_16x16x32_bf16 a[28:31], a[208:211], a[100:103], a[28:31]
    v_mfma_f32_16x16x32_bf16 v[252:255], a[196:199], a[100:103], v[252:255]
    v_mfma_f32_16x16x32_bf16 v[252:255], a[180:183], a[96:99], v[252:255]
    s_waitcnt vmcnt(15)
    buffer_load_dwordx4 a[96:99], v22, s[28:31], s59 offen offset:2048 sc1
    v_mfma_f32_16x16x32_bf16 a[36:39], a[184:187], v[64:67], a[36:39]
    s_waitcnt vmcnt(15)
    buffer_load_dwordx4 a[100:103], v23, s[28:31], s59 offen offset:2048 sc1
    v_mfma_f32_16x16x32_bf16 a[36:39], a[200:203], v[68:71], a[36:39]
    s_add_u32 s59, s70, 7168
    v_mfma_f32_16x16x32_bf16 a[40:43], a[204:207], v[68:71], a[40:43]
    v_mfma_f32_16x16x32_bf16 a[40:43], a[188:191], v[64:67], a[40:43]
    v_mfma_f32_16x16x32_bf16 a[44:47], a[192:195], v[64:67], a[44:47]
    v_mfma_f32_16x16x32_bf16 a[44:47], a[208:211], v[68:71], a[44:47]
    v_mfma_f32_16x16x32_bf16 v[44:47], a[196:199], v[68:71], v[44:47]
    v_mfma_f32_16x16x32_bf16 v[44:47], a[180:183], v[64:67], v[44:47]
    s_waitcnt vmcnt(14)
    buffer_load_dwordx4 v[64:67], v22, s[28:31], s59 offen offset:0 sc1
    v_mfma_f32_16x16x32_bf16 a[4:7], a[216:219], v[72:75], a[4:7]
    s_waitcnt vmcnt(14)
    buffer_load_dwordx4 v[68:71], v23, s[28:31], s59 offen offset:0 sc1
    v_mfma_f32_16x16x32_bf16 a[4:7], a[232:235], v[76:79], a[4:7]
L_s7:
    s_cbranch_execz L_back
    v_mfma_f32_16x16x32_bf16 a[8:11], a[236:239], v[76:79], a[8:11]
    v_mfma_f32_16x16x32_bf16 a[8:11], a[220:223], v[72:75], a[8:11]
    v_mfma_f32_16x16x32_bf16 a[12:15], a[224:227], v[72:75], a[12:15]
    v_mfma_f32_16x16x32_bf16 a[12:15], a[240:243], v[76:79], a[12:15]
    v_mfma_f32_16x16x32_bf16 v[80:83], a[228:231], v[76:79], v[80:83]
    v_mfma_f32_16x16x32_bf16 v[80:83], a[212:215], v[72:75], v[80:83]
    s_waitcnt vmcnt(10)
    buffer_load_dwordx4 v[72:75], v22, s[28:31], s59 offen offset:1024 sc1
    v_mfma_f32_16x16x32_bf16 a[20:23], a[216:219], a[64:67], a[20:23]
    buffer_load_dwordx4 v[76:79], v23, s[28:31], s59 offen offset:1024 sc1
    v_mfma_f32_16x16x32_bf16 a[20:23], a[232:235], a[68:71], a[20:23]
    buffer_store_dword v12, v10, s[28:31], 0 offen sc1
    v_mfma_f32_16x16x32_bf16 a[24:27], a[236:239], a[68:71], a[24:27]
    v_mfma_f32_16x16x32_bf16 a[24:27], a[220:223], a[64:67], a[24:27]
    v_mfma_f32_16x16x32_bf16 a[28:31], a[224:227], a[64:67], a[28:31]
    v_mfma_f32_16x16x32_bf16 a[28:31], a[240:243], a[68:71], a[28:31]
    v_mfma_f32_16x16x32_bf16 v[252:255], a[228:231], a[68:71], v[252:255]
    v_mfma_f32_16x16x32_bf16 v[252:255], a[212:215], a[64:67], v[252:255]
    s_waitcnt vmcnt(12)
    buffer_load_dwordx4 a[64:67], v22, s[28:31], s59 offen offset:2048 sc1
    v_mfma_f32_16x16x32_bf16 a[36:39], a[216:219], a[72:75], a[36:39]
    s_waitcnt vmcnt(12)
    buffer_load_dwordx4 a[68:71], v23, s[28:31], s59 offen offset:2048 sc1
    v_mfma_f32_16x16x32_bf16 a[36:39], a[232:235], a[76:79], a[36:39]
    s_add_u32 s59, s71, 0
    v_mfma_f32_16x16x32_bf16 a[40:43], a[236:239], a[76:79], a[40:43]
    v_mfma_f32_16x16x32_bf16 a[40:43], a[220:223], a[72:75], a[40:43]
    v_mfma_f32_16x16x32_bf16 a[44:47], a[224:227], a[72:75], a[44:47]
    v_mfma_f32_16x16x32_bf16 a[44:47], a[240:243], a[76:79], a[44:47]
    v_mfma_f32_16x16x32_bf16 v[44:47], a[228:231], a[76:79], v[44:47]
    v_mfma_f32_16x16x32_bf16 v[44:47], a[212:215], a[72:75], v[44:47]
    s_waitcnt vmcnt(12)
    buffer_load_dwordx4 a[72:75], v22, s[28:31], s59 offen offset:0 sc1
    v_mfma_f32_16x16x32_bf16 a[4:7], a[248:251], a[80:83], a[4:7]
    s_waitcnt vmcnt(12)
    buffer_load_dwordx4 a[76:79], v23, s[28:31], s59 offen offset:0 sc1
    v_mfma_f32_16x16x32_bf16 a[4:7], v[56:59], a[84:87], a[4:7]
    v_mfma_f32_16x16x32_bf16 a[8:11], v[60:63], a[84:87], a[8:11]
    v_mfma_f32_16x16x32_bf16 a[8:11], a[252:255], a[80:83], a[8:11]
    v_mfma_f32_16x16x32_bf16 a[12:15], v[52:55], a[80:83], a[12:15]
    v_mfma_f32_16x16x32_bf16 a[12:15], a[104:107], a[84:87], a[12:15]
    v_mfma_f32_16x16x32_bf16 v[80:83], v[48:51], a[84:87], v[80:83]
    v_mfma_f32_16x16x32_bf16 v[80:83], a[244:247], a[80:83], v[80:83]
    s_waitcnt vmcnt(12)
    buffer_load_dwordx4 a[80:83], v22, s[28:31], s59 offen offset:1024 sc1
    v_mfma_f32_16x16x32_bf16 a[20:23], a[248:251], a[88:91], a[20:23]
    s_waitcnt vmcnt(12)
    buffer_load_dwordx4 a[84:87], v23, s[28:31], s59 offen offset:1024 sc1
    v_mfma_f32_16x16x32_bf16 a[20:23], v[56:59], a[92:95], a[20:23]
    v_mfma_f32_16x16x32_bf16 a[24:27], v[60:63], a[92:95], a[24:27]
    v_mfma_f32_16x16x32_bf16 a[24:27], a[252:255], a[88:91], a[24:27]
    v_mfma_f32_16x16x32_bf16 a[28:31], v[52:55], a[88:91], a[28:31]
    v_mfma_f32_16x16x32_bf16 a[28:31], a[104:107], a[92:95], a[28:31]
    v_mfma_f32_16x16x32_bf16 v[252:255], v[48:51], a[92:95], v[252:255]
    v_mfma_f32_16x16x32_bf16 v[252:255], a[244:247], a[88:91], v[252:255]
    s_waitcnt vmcnt(12)
    buffer_load_dwordx4 a[88:91], v22, s[28:31], s59 offen offset:2048 sc1
    v_mfma_f32_16x16x32_bf16 a[36:39], a[248:251], a[96:99], a[36:39]
    s_waitcnt vmcnt(12)
    buffer_load_dwordx4 a[92:95], v23, s[28:31], s59 offen offset:2048 sc1
    v_mfma_f32_16x16x32_bf16 a[36:39], v[56:59], a[100:103], a[36:39]
    s_add_u32 s59, s71, 7168
    v_mfma_f32_16x16x32_bf16 a[40:43], v[60:63], a[100:103], a[40:43]
    v_mfma_f32_16x16x32_bf16 a[40:43], a[252:255], a[96:99], a[40:43]
    v_mfma_f32_16x16x32_bf16 a[44:47], v[52:55], a[96:99], a[44:47]
    v_mfma_f32_16x16x32_bf16 a[44:47], a[104:107], a[100:103], a[44:47]
    v_mfma_f32_16x16x32_bf16 v[44:47], v[48:51], a[100:103], v[44:47]
    v_mfma_f32_16x16x32_bf16 v[44:47], a[244:247], a[96:99], v[44:47]
    s_waitcnt vmcnt(12)
    buffer_load_dwordx4 a[96:99], v22, s[28:31], s59 offen offset:0 sc1
    v_mfma_f32_16x16x32_bf16 a[4:7], a[112:115], v[64:67], a[4:7]
    s_waitcnt vmcnt(12)
    buffer_load_dwordx4 a[100:103], v23, s[28:31], s59 offen offset:0 sc1
    v_mfma_f32_16x16x32_bf16 a[4:7], v[176:179], v[68:71], a[4:7]
    buffer_load_dword v13, v11, s[28:31], 0 offen sc1
    v_mfma_f32_16x16x32_bf16 a[8:11], v[180:183], v[68:71], a[8:11]
    v_mfma_f32_16x16x32_bf16 a[8:11], v[164:167], v[64:67], a[8:11]
    v_mfma_f32_16x16x32_bf16 a[12:15], v[168:171], v[64:67], a[12:15]
    v_mfma_f32_16x16x32_bf16 a[12:15], v[184:187], v[68:71], a[12:15]
    v_mfma_f32_16x16x32_bf16 v[80:83], v[172:175], v[68:71], v[80:83]
    v_mfma_f32_16x16x32_bf16 v[80:83], a[108:111], v[64:67], v[80:83]
    s_waitcnt vmcnt(13)
    buffer_load_dwordx4 v[64:67], v22, s[28:31], s59 offen offset:1024 sc1
    v_mfma_f32_16x16x32_bf16 a[20:23], a[112:115], v[72:75], a[20:23]
    s_waitcnt vmcnt(13)
    buffer_load_dwordx4 v[68:71], v23, s[28:31], s59 offen offset:1024 sc1
    v_mfma_f32_16x16x32_bf16 a[20:23], v[176:179], v[76:79], a[20:23]
    v_mfma_f32_16x16x32_bf16 a[24:27], v[180:183], v[76:79], a[24:27]
    v_mfma_f32_16x16x32_bf16 a[24:27], v[164:167], v[72:75], a[24:27]
    v_mfma_f32_16x16x32_bf16 a[28:31], v[168:171], v[72:75], a[28:31]
    v_mfma_f32_16x16x32_bf16 a[28:31], v[184:187], v[76:79], a[28:31]
    v_mfma_f32_16x16x32_bf16 v[252:255], v[172:175], v[76:79], v[252:255]
    v_mfma_f32_16x16x32_bf16 v[252:255], a[108:111], v[72:75], v[252:255]
    s_waitcnt vmcnt(12)
    buffer_load_dwordx4 v[72:75], v22, s[28:31], s59 offen offset:2048 sc1
    v_mfma_f32_16x16x32_bf16 a[36:39], a[112:115], a[64:67], a[36:39]
    s_waitcnt vmcnt(12)
    buffer_load_dwordx4 v[76:79], v23, s[28:31], s59 offen offset:2048 sc1
    v_mfma_f32_16x16x32_bf16 a[36:39], v[176:179], a[68:71], a[36:39]
    v_mfma_f32_16x16x32_bf16 a[40:43], v[180:183], a[68:71], a[40:43]
    v_mfma_f32_16x16x32_bf16 a[40:43], v[164:167], a[64:67], a[40:43]
    v_mfma_f32_16x16x32_bf16 a[44:47], v[168:171], a[64:67], a[44:47]
    v_mfma_f32_16x16x32_bf16 a[44:47], v[184:187], a[68:71], a[44:47]
    v_mfma_f32_16x16x32_bf16 v[44:47], v[172:175], a[68:71], v[44:47]
    v_mfma_f32_16x16x32_bf16 v[44:47], a[108:111], a[64:67], v[44:47]
    s_waitcnt vmcnt(12)
    v_mfma_f32_16x16x32_bf16 a[4:7], v[192:195], a[72:75], a[4:7]
    s_waitcnt vmcnt(11)
    v_mfma_f32_16x16x32_bf16 a[4:7], v[208:211], a[76:79], a[4:7]
    v_mfma_f32_16x16x32_bf16 a[8:11], v[212:215], a[76:79], a[8:11]
    v_mfma_f32_16x16x32_bf16 a[8:11], v[196:199], a[72:75], a[8:11]
    v_mfma_f32_16x16x32_bf16 a[12:15], v[200:203], a[72:75], a[12:15]
    v_mfma_f32_16x16x32_bf16 a[12:15], v[216:219], a[76:79], a[12:15]
    v_mfma_f32_16x16x32_bf16 v[80:83], v[204:207], a[76:79], v[80:83]
    v_mfma_f32_16x16x32_bf16 v[80:83], v[188:191], a[72:75], v[80:83]
    s_waitcnt vmcnt(10)
    v_mfma_f32_16x16x32_bf16 a[20:23], v[192:195], a[80:83], a[20:23]
    s_waitcnt vmcnt(9)
    v_mfma_f32_16x16x32_bf16 a[20:23], v[208:211], a[84:87], a[20:23]
    v_mfma_f32_16x16x32_bf16 a[24:27], v[212:215], a[84:87], a[24:27]
    v_mfma_f32_16x16x32_bf16 a[24:27], v[196:199], a[80:83], a[24:27]
    v_mfma_f32_16x16x32_bf16 a[28:31], v[200:203], a[80:83], a[28:31]
    v_mfma_f32_16x16x32_bf16 a[28:31], v[216:219], a[84:87], a[28:31]
    v_mfma_f32_16x16x32_bf16 v[252:255], v[204:207], a[84:87], v[252:255]
    v_mfma_f32_16x16x32_bf16 v[252:255], v[188:191], a[80:83], v[252:255]
    s_waitcnt vmcnt(8)
    v_mfma_f32_16x16x32_bf16 a[36:39], v[192:195], a[88:91], a[36:39]
    s_waitcnt vmcnt(7)
    v_mfma_f32_16x16x32_bf16 a[36:39], v[208:211], a[92:95], a[36:39]
    v_mfma_f32_16x16x32_bf16 a[40:43], v[212:215], a[92:95], a[40:43]
    v_mfma_f32_16x16x32_bf16 a[40:43], v[196:199], a[88:91], a[40:43]
    v_mfma_f32_16x16x32_bf16 a[44:47], v[200:203], a[88:91], a[44:47]
    v_mfma_f32_16x16x32_bf16 a[44:47], v[216:219], a[92:95], a[44:47]
    v_mfma_f32_16x16x32_bf16 v[44:47], v[204:207], a[92:95], v[44:47]
    v_mfma_f32_16x16x32_bf16 v[44:47], v[188:191], a[88:91], v[44:47]
    s_waitcnt vmcnt(4)
    v_cmp_ne_u32 vcc, 1, v13
    s_mov_b32 s53, 1000000
    s_nop 3
    s_cbranch_vccz L_x_ok
L_x_spin:
    buffer_load_dword v13, v11, s[28:31], 0 offen sc1
    s_waitcnt vmcnt(0)
    v_cmp_ne_u32 vcc, 1, v13
    s_sub_u32 s53, s53, 1
    s_cmp_eq_u32 s53, 0
    s_cbranch_scc1 L_x_ok
    s_nop 1
    s_cbranch_vccnz L_x_spin
L_x_ok:
    v_mfma_f32_16x16x32_bf16 a[4:7], v[224:227], a[96:99], a[4:7]
    buffer_load_dwordx4 v[148:151], v9, s[28:31], 0 offen offset:0 sc1
    v_mfma_f32_16x16x32_bf16 a[4:7], v[240:243], a[100:103], a[4:7]
    buffer_load_dwordx4 v[152:155], v9, s[28:31], 0 offen offset:1024 sc1
    v_mfma_f32_16x16x32_bf16 a[8:11], v[244:247], a[100:103], a[8:11]
    buffer_load_dwordx4 v[156:159], v9, s[28:31], 0 offen offset:2048 sc1
    v_mfma_f32_16x16x32_bf16 a[8:11], v[228:231], a[96:99], a[8:11]
    buffer_load_dwordx4 v[160:163], v21, s[28:31], 0 offen offset:3072 sc1
    v_mfma_f32_16x16x32_bf16 a[12:15], v[232:235], a[96:99], a[12:15]
    v_mfma_f32_16x16x32_bf16 a[12:15], v[248:251], a[100:103], a[12:15]
    v_mfma_f32_16x16x32_bf16 v[80:83], v[236:239], a[100:103], v[80:83]
    ds_write_b128 v14, a[4:7] offset:1024
    v_mfma_f32_16x16x32_bf16 v[80:83], v[220:223], a[96:99], v[80:83]
    s_waitcnt vmcnt(7)
    v_mfma_f32_16x16x32_bf16 a[20:23], v[224:227], v[64:67], a[20:23]
    s_waitcnt vmcnt(6)
    v_mfma_f32_16x16x32_bf16 a[20:23], v[240:243], v[68:71], a[20:23]
    ds_write_b128 v14, a[8:11] offset:2048
    v_mfma_f32_16x16x32_bf16 a[24:27], v[244:247], v[68:71], a[24:27]
    v_mfma_f32_16x16x32_bf16 a[24:27], v[228:231], v[64:67], a[24:27]
    ds_write_b128 v14, a[12:15] offset:3072
    v_mfma_f32_16x16x32_bf16 a[28:31], v[232:235], v[64:67], a[28:31]
    v_mfma_f32_16x16x32_bf16 a[28:31], v[248:251], v[68:71], a[28:31]
    v_mfma_f32_16x16x32_bf16 v[252:255], v[236:239], v[68:71], v[252:255]
    v_mfma_f32_16x16x32_bf16 v[252:255], v[220:223], v[64:67], v[252:255]
    s_waitcnt vmcnt(5)
    ds_write_b128 v14, a[20:23] offset:17408
    v_mfma_f32_16x16x32_bf16 a[36:39], v[224:227], v[72:75], a[36:39]
    s_waitcnt vmcnt(4)
    v_mfma_f32_16x16x32_bf16 a[36:39], v[240:243], v[76:79], a[36:39]
    ds_write_b128 v14, a[24:27] offset:18432
    v_mfma_f32_16x16x32_bf16 a[40:43], v[244:247], v[76:79], a[40:43]
    v_mfma_f32_16x16x32_bf16 a[40:43], v[228:231], v[72:75], a[40:43]
    ds_write_b128 v14, a[28:31] offset:19456
    v_mfma_f32_16x16x32_bf16 a[44:47], v[232:235], v[72:75], a[44:47]
    v_mfma_f32_16x16x32_bf16 a[44:47], v[248:251], v[76:79], a[44:47]
    v_mfma_f32_16x16x32_bf16 v[44:47], v[236:239], v[76:79], v[44:47]
    v_mfma_f32_16x16x32_bf16 v[44:47], v[220:223], v[72:75], v[44:47]
    ds_write_b128 v14, a[36:39] offset:33792
    s_nop 1
    ds_write_b128 v14, a[40:43] offset:34816
    s_nop 1
    ds_write_b128 v14, a[44:47] offset:35840
    s_waitcnt lgkmcnt(0)
    s_barrier
    ds_read_b128 v[84:87], v7 offset:1024
    ds_read_b128 v[88:91], v24 offset:2048
    ds_read_b128 v[92:95], v29 offset:3072
    ds_read_b128 v[96:99], v7 offset:17408
    ds_read_b128 v[100:103], v24 offset:18432
    ds_read_b128 v[104:107], v29 offset:19456
    ds_read_b128 v[108:111], v7 offset:33792
    ds_read_b128 v[112:115], v24 offset:34816
    ds_read_b128 v[116:119], v29 offset:35840
    s_waitcnt vmcnt(0)
    v_pk_add_f32 v[144:145], v[144:145], v[160:161]
    v_pk_add_f32 v[146:147], v[146:147], v[162:163]
    s_waitcnt lgkmcnt(8)
    v_pk_add_f32 v[80:81], v[80:81], v[84:85]
    v_pk_add_f32 v[82:83], v[82:83], v[86:87]
    s_waitcnt lgkmcnt(5)
    v_pk_add_f32 v[88:89], v[88:89], v[92:93]
    v_pk_add_f32 v[90:91], v[90:91], v[94:95]
    v_pk_add_f32 v[252:253], v[252:253], v[96:97]
    v_pk_add_f32 v[254:255], v[254:255], v[98:99]
    s_waitcnt lgkmcnt(0)
    v_pk_add_f32 v[100:101], v[100:101], v[104:105]
    v_pk_add_f32 v[102:103], v[102:103], v[106:107]
    v_pk_add_f32 v[80:81], v[80:81], v[88:89]
    v_pk_add_f32 v[82:83], v[82:83], v[90:91]
    v_pk_add_f32 v[252:253], v[252:253], v[100:101]
    v_pk_add_f32 v[254:255], v[254:255], v[102:103]
    v_pk_add_f32 v[80:81], v[80:81], v[148:149]
    v_pk_add_f32 v[82:83], v[82:83], v[150:151]
    v_pk_add_f32 v[252:253], v[252:253], v[152:153]
    v_pk_add_f32 v[254:255], v[254:255], v[154:155]
    v_cvt_pk_bf16_f32 v148, v80, v81
    v_cvt_pk_bf16_f32 v149, v82, v83
    v_cvt_pk_bf16_f32 v150, v252, v253
    v_cvt_pk_bf16_f32 v151, v254, v255
    v_pk_add_f32 v[44:45], v[44:45], v[108:109]
    v_pk_add_f32 v[46:47], v[46:47], v[110:111]
    v_pk_add_f32 v[112:113], v[112:113], v[116:117]
    v_pk_add_f32 v[114:115], v[114:115], v[118:119]
    v_pk_add_f32 v[44:45], v[44:45], v[112:113]
    v_pk_add_f32 v[46:47], v[46:47], v[114:115]
    v_permlane16_swap_b32 v148, v150
    v_permlane16_swap_b32 v149, v151
    v_pk_add_f32 v[44:45], v[44:45], v[156:157]
    v_pk_add_f32 v[46:47], v[46:47], v[158:159]
    buffer_store_dwordx4 v[148:151], v4, s[36:39], 0 offen
    v_cvt_pk_bf16_f32 v156, v44, v45
    v_cvt_pk_bf16_f32 v157, v46, v47
    v_cvt_pk_bf16_f32 v158, v144, v145
    v_cvt_pk_bf16_f32 v159, v146, v147
    s_nop 0
    v_permlane16_swap_b32 v156, v158
    v_permlane16_swap_b32 v157, v159
    buffer_store_dwordx4 v[156:159], v5, s[36:39], 0 offen
L_end:
    s_endpgm
L_codeend:
L_slow:
    s_waitcnt vmcnt(0) lgkmcnt(0)
    s_nop 7
    s_barrier
    v_mov_b32 v112, 0xff800000
    v_mov_b32 v113, 0xff800000
    v_mov_b32 v114, 0xff800000
    v_mov_b32 v115, 0xff800000
    v_mov_b32 v116, 0xff800000
    v_mov_b32 v117, 0xff800000
    v_mov_b32 v118, 0xff800000
    v_mov_b32 v119, 0xff800000
    v_mov_b32 v120, 0xff800000
    v_mov_b32 v121, 0xff800000
    v_mov_b32 v122, 0xff800000
    v_mov_b32 v123, 0xff800000
    v_mov_b32 v124, 0xff800000
    v_mov_b32 v125, 0xff800000
    v_mov_b32 v126, 0xff800000
    v_mov_b32 v127, 0xff800000
    s_mov_b32 s52, 0
L_max:
    s_add_u32 m0, s44, 49152
    s_nop 0
    buffer_load_dwordx4 v14, s[12:15], s52 offen offset:0 nt lds
    buffer_load_dwordx4 v15, s[12:15], s52 offen offset:1024 nt lds
    buffer_load_dwordx4 v16, s[12:15], s52 offen offset:2048 nt lds
    buffer_load_dwordx4 v17, s[12:15], s52 offen offset:3072 nt lds
    s_waitcnt vmcnt(0)
    s_barrier
    ds_read_b128 a[84:87], v2 offset:49152
    ds_read_b128 a[88:91], v3 offset:49152
    ds_read_b128 a[92:95], v48 offset:49152
    ds_read_b128 a[96:99], v49 offset:49152
    ds_read_b128 a[100:103], v2 offset:49664
    ds_read_b128 a[104:107], v3 offset:49664
    ds_read_b128 a[108:111], v48 offset:49664
    ds_read_b128 a[112:115], v49 offset:49664
    s_waitcnt lgkmcnt(7)
    v_mfma_f32_16x16x32_bf16 v[64:67], a[84:87], v[128:131], 0
    s_waitcnt lgkmcnt(6)
    v_mfma_f32_16x16x32_bf16 v[64:67], a[88:91], v[160:163], v[64:67]
    s_waitcnt lgkmcnt(2)
    v_mfma_f32_16x16x32_bf16 v[64:67], a[92:95], v[192:195], v[64:67]
    v_mfma_f32_16x16x32_bf16 v[64:67], a[96:99], v[224:227], v[64:67]
    v_mfma_f32_16x16x32_bf16 v[68:71], a[96:99], v[228:231], 0
    v_mfma_f32_16x16x32_bf16 v[68:71], a[92:95], v[196:199], v[68:71]
    v_mfma_f32_16x16x32_bf16 v[68:71], a[88:91], v[164:167], v[68:71]
    v_mfma_f32_16x16x32_bf16 v[68:71], a[84:87], v[132:135], v[68:71]
    v_mfma_f32_16x16x32_bf16 v[72:75], a[84:87], v[136:139], 0
    v_mfma_f32_16x16x32_bf16 v[72:75], a[88:91], v[168:171], v[72:75]
    v_mfma_f32_16x16x32_bf16 v[72:75], a[92:95], v[200:203], v[72:75]
    v_mfma_f32_16x16x32_bf16 v[72:75], a[96:99], v[232:235], v[72:75]
    v_mfma_f32_16x16x32_bf16 v[76:79], a[96:99], a[60:63], 0
    ds_read_b128 a[96:99], v51 offset:49152
    v_mfma_f32_16x16x32_bf16 v[76:79], a[92:95], a[56:59], v[76:79]
    ds_read_b128 a[92:95], v50 offset:49152
    v_mfma_f32_16x16x32_bf16 v[76:79], a[88:91], a[52:55], v[76:79]
    ds_read_b128 a[88:91], v5 offset:49152
    v_mfma_f32_16x16x32_bf16 v[76:79], a[84:87], a[48:51], v[76:79]
    ds_read_b128 a[84:87], v4 offset:49152
    v_mfma_f32_16x16x32_bf16 v[80:83], a[100:103], v[128:131], 0
    s_waitcnt lgkmcnt(4)
    v_mfma_f32_16x16x32_bf16 v[80:83], a[104:107], v[160:163], v[80:83]
    v_mfma_f32_16x16x32_bf16 v[80:83], a[108:111], v[192:195], v[80:83]
    v_mfma_f32_16x16x32_bf16 v[80:83], a[112:115], v[224:227], v[80:83]
    v_mfma_f32_16x16x32_bf16 v[84:87], a[112:115], v[228:231], 0
    v_mfma_f32_16x16x32_bf16 v[84:87], a[108:111], v[196:199], v[84:87]
    v_mfma_f32_16x16x32_bf16 v[84:87], a[104:107], v[164:167], v[84:87]
    v_mfma_f32_16x16x32_bf16 v[84:87], a[100:103], v[132:135], v[84:87]
    v_mfma_f32_16x16x32_bf16 v[88:91], a[100:103], v[136:139], 0
    v_mfma_f32_16x16x32_bf16 v[88:91], a[104:107], v[168:171], v[88:91]
    v_mfma_f32_16x16x32_bf16 v[88:91], a[108:111], v[200:203], v[88:91]
    v_mfma_f32_16x16x32_bf16 v[88:91], a[112:115], v[232:235], v[88:91]
    v_max3_f32 v112, v112, v64, v80
    v_max3_f32 v113, v113, v65, v81
    v_mfma_f32_16x16x32_bf16 v[92:95], a[112:115], a[60:63], 0
    v_max3_f32 v114, v114, v66, v82
    v_max3_f32 v115, v115, v67, v83
    v_mfma_f32_16x16x32_bf16 v[92:95], a[108:111], a[56:59], v[92:95]
    v_max3_f32 v116, v116, v68, v84
    v_max3_f32 v117, v117, v69, v85
    v_mfma_f32_16x16x32_bf16 v[92:95], a[104:107], a[52:55], v[92:95]
    s_waitcnt lgkmcnt(0)
    v_max3_f32 v118, v118, v70, v86
    v_max3_f32 v119, v119, v71, v87
    v_mfma_f32_16x16x32_bf16 v[92:95], a[100:103], a[48:51], v[92:95]
    v_max3_f32 v120, v120, v72, v88
    v_max3_f32 v121, v121, v73, v89
    v_mfma_f32_16x16x32_bf16 v[64:67], a[84:87], v[128:131], 0
    v_max3_f32 v122, v122, v74, v90
    v_max3_f32 v123, v123, v75, v91
    v_mfma_f32_16x16x32_bf16 v[64:67], a[88:91], v[160:163], v[64:67]
    ds_read_b128 a[100:103], v4 offset:49664
    ds_read_b128 a[104:107], v5 offset:49664
    v_mfma_f32_16x16x32_bf16 v[64:67], a[92:95], v[192:195], v[64:67]
    ds_read_b128 a[108:111], v50 offset:49664
    ds_read_b128 a[112:115], v51 offset:49664
    v_mfma_f32_16x16x32_bf16 v[64:67], a[96:99], v[224:227], v[64:67]
    v_max3_f32 v124, v124, v76, v92
    v_max3_f32 v125, v125, v77, v93
    v_mfma_f32_16x16x32_bf16 v[68:71], a[96:99], v[228:231], 0
    v_max3_f32 v126, v126, v78, v94
    v_max3_f32 v127, v127, v79, v95
    v_mfma_f32_16x16x32_bf16 v[68:71], a[92:95], v[196:199], v[68:71]
    v_mfma_f32_16x16x32_bf16 v[68:71], a[88:91], v[164:167], v[68:71]
    v_mfma_f32_16x16x32_bf16 v[68:71], a[84:87], v[132:135], v[68:71]
    v_mfma_f32_16x16x32_bf16 v[72:75], a[84:87], v[136:139], 0
    v_mfma_f32_16x16x32_bf16 v[72:75], a[88:91], v[168:171], v[72:75]
    v_mfma_f32_16x16x32_bf16 v[72:75], a[92:95], v[200:203], v[72:75]
    v_mfma_f32_16x16x32_bf16 v[72:75], a[96:99], v[232:235], v[72:75]
    v_mfma_f32_16x16x32_bf16 v[76:79], a[96:99], a[60:63], 0
    v_mfma_f32_16x16x32_bf16 v[76:79], a[92:95], a[56:59], v[76:79]
    v_mfma_f32_16x16x32_bf16 v[76:79], a[88:91], a[52:55], v[76:79]
    s_waitcnt lgkmcnt(0)
    v_mfma_f32_16x16x32_bf16 v[76:79], a[84:87], a[48:51], v[76:79]
    v_mfma_f32_16x16x32_bf16 v[80:83], a[100:103], v[128:131], 0
    v_mfma_f32_16x16x32_bf16 v[80:83], a[104:107], v[160:163], v[80:83]
    v_mfma_f32_16x16x32_bf16 v[80:83], a[108:111], v[192:195], v[80:83]
    v_mfma_f32_16x16x32_bf16 v[80:83], a[112:115], v[224:227], v[80:83]
    v_mfma_f32_16x16x32_bf16 v[84:87], a[112:115], v[228:231], 0
    v_mfma_f32_16x16x32_bf16 v[84:87], a[108:111], v[196:199], v[84:87]
    v_mfma_f32_16x16x32_bf16 v[84:87], a[104:107], v[164:167], v[84:87]
    v_mfma_f32_16x16x32_bf16 v[84:87], a[100:103], v[132:135], v[84:87]
    v_mfma_f32_16x16x32_bf16 v[88:91], a[100:103], v[136:139], 0
    v_mfma_f32_16x16x32_bf16 v[88:91], a[104:107], v[168:171], v[88:91]
    v_mfma_f32_16x16x32_bf16 v[88:91], a[108:111], v[200:203], v[88:91]
    v_mfma_f32_16x16x32_bf16 v[88:91], a[112:115], v[232:235], v[88:91]
    v_max3_f32 v112, v112, v64, v80
    v_max3_f32 v113, v113, v65, v81
    v_mfma_f32_16x16x32_bf16 v[92:95], a[112:115], a[60:63], 0
    v_max3_f32 v114, v114, v66, v82
    v_max3_f32 v115, v115, v67, v83
    v_mfma_f32_16x16x32_bf16 v[92:95], a[108:111], a[56:59], v[92:95]
    v_max3_f32 v116, v116, v68, v84
    v_max3_f32 v117, v117, v69, v85
    v_mfma_f32_16x16x32_bf16 v[92:95], a[104:107], a[52:55], v[92:95]
    v_max3_f32 v118, v118, v70, v86
    v_max3_f32 v119, v119, v71, v87
    v_mfma_f32_16x16x32_bf16 v[92:95], a[100:103], a[48:51], v[92:95]
    v_max3_f32 v120, v120, v72, v88
    v_max3_f32 v121, v121, v73, v89
    v_max3_f32 v122, v122, v74, v90
    v_max3_f32 v123, v123, v75, v91
    s_nop 3
    v_max3_f32 v124, v124, v76, v92
    v_max3_f32 v125, v125, v77, v93
    v_max3_f32 v126, v126, v78, v94
    v_max3_f32 v127, v127, v79, v95
    s_waitcnt lgkmcnt(0)
    s_barrier
    s_add_u32 s52, s52, 16384
    s_cmp_lt_u32 s52, 131072
    s_nop 7
    s_cbranch_scc1 L_max
    v_max3_f32 v112, v112, v113, v114
    v_max_f32 v112, v112, v115
    v_mov_b32 v113, v112
    s_nop 1
    v_permlane16_swap_b32 v112, v113
    v_max_f32 v112, v112, v113
    v_mov_b32 v113, v112
    s_nop 1
    v_permlane32_swap_b32 v112, v113
    v_max_f32 v112, v112, v113
    v_sub_f32 v112, 0, v112
    v_mov_b32 v113, v112
    v_mov_b32 v114, v112
    v_mov_b32 v115, v112
    v_max3_f32 v116, v116, v117, v118
    v_max_f32 v116, v116, v119
    v_mov_b32 v117, v116
    s_nop 1
    v_permlane16_swap_b32 v116, v117
    v_max_f32 v116, v116, v117
    v_mov_b32 v117, v116
    s_nop 1
    v_permlane32_swap_b32 v116, v117
    v_max_f32 v116, v116, v117
    v_sub_f32 v116, 0, v116
    v_mov_b32 v117, v116
    v_mov_b32 v118, v116
    v_mov_b32 v119, v116
    v_max3_f32 v120, v120, v121, v122
    v_max_f32 v120, v120, v123
    v_mov_b32 v121, v120
    s_nop 1
    v_permlane16_swap_b32 v120, v121
    v_max_f32 v120, v120, v121
    v_mov_b32 v121, v120
    s_nop 1
    v_permlane32_swap_b32 v120, v121
    v_max_f32 v120, v120, v121
    v_sub_f32 v120, 0, v120
    v_mov_b32 v121, v120
    v_mov_b32 v122, v120
    v_mov_b32 v123, v120
    v_max3_f32 v124, v124, v125, v126
    v_max_f32 v124, v124, v127
    v_mov_b32 v125, v124
    s_nop 1
    v_permlane16_swap_b32 v124, v125
    v_max_f32 v124, v124, v125
    v_mov_b32 v125, v124
    s_nop 1
    v_permlane32_swap_b32 v124, v125
    v_max_f32 v124, v124, v125
    v_sub_f32 v124, 0, v124
    v_mov_b32 v125, v124
    v_mov_b32 v126, v124
    v_mov_b32 v127, v124
    v_mov_b32 v144, 0
    v_mov_b32 v145, 0
    v_mov_b32 v146, 0
    v_mov_b32 v147, 0
    v_mov_b32 v148, 0
    v_mov_b32 v149, 0
    v_mov_b32 v150, 0
    v_mov_b32 v151, 0
    v_mov_b32 v152, 0
    v_mov_b32 v153, 0
    v_mov_b32 v154, 0
    v_mov_b32 v155, 0
    v_mov_b32 v176, 0
    v_mov_b32 v177, 0
    v_mov_b32 v178, 0
    v_mov_b32 v179, 0
    v_mov_b32 v180, 0
    v_mov_b32 v181, 0
    v_mov_b32 v182, 0
    v_mov_b32 v183, 0
    v_mov_b32 v184, 0
    v_mov_b32 v185, 0
    v_mov_b32 v186, 0
    v_mov_b32 v187, 0
    v_mov_b32 v208, 0
    v_mov_b32 v209, 0
    v_mov_b32 v210, 0
    v_mov_b32 v211, 0
    v_mov_b32 v212, 0
    v_mov_b32 v213, 0
    v_mov_b32 v214, 0
    v_mov_b32 v215, 0
    v_mov_b32 v216, 0
    v_mov_b32 v217, 0
    v_mov_b32 v218, 0
    v_mov_b32 v219, 0
    v_mov_b32 v240, 0
    v_mov_b32 v241, 0
    v_mov_b32 v242, 0
    v_mov_b32 v243, 0
    v_mov_b32 v244, 0
    v_mov_b32 v245, 0
    v_mov_b32 v246, 0
    v_mov_b32 v247, 0
    v_mov_b32 v248, 0
    v_mov_b32 v249, 0
    v_mov_b32 v250, 0
    v_mov_b32 v251, 0
    v_accvgpr_write_b32 a0, 0
    v_accvgpr_write_b32 a1, 0
    v_accvgpr_write_b32 a2, 0
    v_accvgpr_write_b32 a3, 0
    v_accvgpr_write_b32 a4, 0
    v_accvgpr_write_b32 a5, 0
    v_accvgpr_write_b32 a6, 0
    v_accvgpr_write_b32 a7, 0
    v_accvgpr_write_b32 a8, 0
    v_accvgpr_write_b32 a9, 0
    v_accvgpr_write_b32 a10, 0
    v_accvgpr_write_b32 a11, 0
    v_accvgpr_write_b32 a12, 0
    v_accvgpr_write_b32 a13, 0
    v_accvgpr_write_b32 a14, 0
    v_accvgpr_write_b32 a15, 0
    v_accvgpr_write_b32 a16, 0
    v_accvgpr_write_b32 a17, 0
    v_accvgpr_write_b32 a18, 0
    v_accvgpr_write_b32 a19, 0
    v_accvgpr_write_b32 a20, 0
    v_accvgpr_write_b32 a21, 0
    v_accvgpr_write_b32 a22, 0
    v_accvgpr_write_b32 a23, 0
    v_accvgpr_write_b32 a24, 0
    v_accvgpr_write_b32 a25, 0
    v_accvgpr_write_b32 a26, 0
    v_accvgpr_write_b32 a27, 0
    v_accvgpr_write_b32 a28, 0
    v_accvgpr_write_b32 a29, 0
    v_accvgpr_write_b32 a30, 0
    v_accvgpr_write_b32 a31, 0
    v_accvgpr_write_b32 a32, 0
    v_accvgpr_write_b32 a33, 0
    v_accvgpr_write_b32 a34, 0
    v_accvgpr_write_b32 a35, 0
    v_accvgpr_write_b32 a36, 0
    v_accvgpr_write_b32 a37, 0
    v_accvgpr_write_b32 a38, 0
    v_accvgpr_write_b32 a39, 0
    v_accvgpr_write_b32 a40, 0
    v_accvgpr_write_b32 a41, 0
    v_accvgpr_write_b32 a42, 0
    v_accvgpr_write_b32 a43, 0
    v_accvgpr_write_b32 a44, 0
    v_accvgpr_write_b32 a45, 0
    v_accvgpr_write_b32 a46, 0
    v_accvgpr_write_b32 a47, 0
    v_accvgpr_write_b32 a224, 0
    v_accvgpr_write_b32 a225, 0
    v_accvgpr_write_b32 a226, 0
    v_accvgpr_write_b32 a227, 0
    v_accvgpr_write_b32 a228, 0
    v_accvgpr_write_b32 a229, 0
    v_accvgpr_write_b32 a230, 0
    v_accvgpr_write_b32 a231, 0
    v_accvgpr_write_b32 a232, 0
    v_accvgpr_write_b32 a233, 0
    v_accvgpr_write_b32 a234, 0
    v_accvgpr_write_b32 a235, 0
    v_accvgpr_write_b32 a236, 0
    v_accvgpr_write_b32 a237, 0
    v_accvgpr_write_b32 a238, 0
    v_accvgpr_write_b32 a239, 0
    v_accvgpr_write_b32 a240, 0
    v_accvgpr_write_b32 a241, 0
    v_accvgpr_write_b32 a242, 0
    v_accvgpr_write_b32 a243, 0
    v_accvgpr_write_b32 a244, 0
    v_accvgpr_write_b32 a245, 0
    v_accvgpr_write_b32 a246, 0
    v_accvgpr_write_b32 a247, 0
    v_accvgpr_write_b32 a248, 0
    v_accvgpr_write_b32 a249, 0
    v_accvgpr_write_b32 a250, 0
    v_accvgpr_write_b32 a251, 0
    v_accvgpr_write_b32 a252, 0
    v_accvgpr_write_b32 a253, 0
    v_accvgpr_write_b32 a254, 0
    v_accvgpr_write_b32 a255, 0
    v_accvgpr_write_b32 a64, 0
    v_accvgpr_write_b32 a65, 0
    v_accvgpr_write_b32 a66, 0
    v_accvgpr_write_b32 a67, 0
    v_accvgpr_write_b32 a68, 0
    v_accvgpr_write_b32 a69, 0
    v_accvgpr_write_b32 a70, 0
    v_accvgpr_write_b32 a71, 0
    v_accvgpr_write_b32 a72, 0
    v_accvgpr_write_b32 a73, 0
    v_accvgpr_write_b32 a74, 0
    v_accvgpr_write_b32 a75, 0
    v_accvgpr_write_b32 a76, 0
    v_accvgpr_write_b32 a77, 0
    v_accvgpr_write_b32 a78, 0
    v_accvgpr_write_b32 a79, 0
    s_mov_b32 s52, 0
L_att:
    s_add_u32 m0, s44, 49152
    s_nop 0
    buffer_load_dwordx4 v14, s[12:15], s52 offen offset:0 nt lds
    buffer_load_dwordx4 v15, s[12:15], s52 offen offset:1024 nt lds
    buffer_load_dwordx4 v16, s[12:15], s52 offen offset:2048 nt lds
    buffer_load_dwordx4 v17, s[12:15], s52 offen offset:3072 nt lds
    s_add_u32 m0, s44, 98304
    s_nop 0
    buffer_load_dwordx4 v18, s[16:19], s52 offen offset:0 nt lds
    buffer_load_dwordx4 v19, s[16:19], s52 offen offset:1024 nt lds
    buffer_load_dwordx4 v20, s[16:19], s52 offen offset:2048 nt lds
    buffer_load_dwordx4 v21, s[16:19], s52 offen offset:3072 nt lds
    s_waitcnt vmcnt(0)
    s_barrier
    ds_read_b128 a[84:87], v2 offset:49152
    ds_read_b128 a[88:91], v3 offset:49152
    ds_read_b128 a[92:95], v48 offset:49152
    ds_read_b128 a[96:99], v49 offset:49152
    ds_read_b128 a[100:103], v2 offset:49664
    ds_read_b128 a[104:107], v3 offset:49664
    ds_read_b128 a[108:111], v48 offset:49664
    ds_read_b128 a[112:115], v49 offset:49664
    s_waitcnt lgkmcnt(7)
    v_mfma_f32_16x16x32_bf16 v[64:67], a[84:87], v[128:131], v[112:115]
    s_waitcnt lgkmcnt(6)
    v_mfma_f32_16x16x32_bf16 v[64:67], a[88:91], v[160:163], v[64:67]
    s_waitcnt lgkmcnt(2)
    v_mfma_f32_16x16x32_bf16 v[64:67], a[92:95], v[192:195], v[64:67]
    v_mfma_f32_16x16x32_bf16 v[64:67], a[96:99], v[224:227], v[64:67]
    v_mfma_f32_16x16x32_bf16 v[68:71], a[96:99], v[228:231], v[116:119]
    v_mfma_f32_16x16x32_bf16 v[68:71], a[92:95], v[196:199], v[68:71]
    v_mfma_f32_16x16x32_bf16 v[68:71], a[88:91], v[164:167], v[68:71]
    v_mfma_f32_16x16x32_bf16 v[68:71], a[84:87], v[132:135], v[68:71]
    v_mfma_f32_16x16x32_bf16 v[72:75], a[84:87], v[136:139], v[120:123]
    v_mfma_f32_16x16x32_bf16 v[72:75], a[88:91], v[168:171], v[72:75]
    v_mfma_f32_16x16x32_bf16 v[72:75], a[92:95], v[200:203], v[72:75]
    v_mfma_f32_16x16x32_bf16 v[72:75], a[96:99], v[232:235], v[72:75]
    v_exp_f32 v64, v64
    v_mfma_f32_16x16x32_bf16 v[76:79], a[96:99], a[60:63], v[124:127]
    v_exp_f32 v65, v65
    v_mfma_f32_16x16x32_bf16 v[76:79], a[92:95], a[56:59], v[76:79]
    v_exp_f32 v66, v66
    v_mfma_f32_16x16x32_bf16 v[76:79], a[88:91], a[52:55], v[76:79]
    v_exp_f32 v67, v67
    v_mfma_f32_16x16x32_bf16 v[76:79], a[84:87], a[48:51], v[76:79]
    ds_read_b64_tr_b16 a[84:85], v6 offset:0
    ds_read_b64_tr_b16 a[86:87], v6 offset:512
    v_mfma_f32_16x16x32_bf16 v[80:83], a[100:103], v[128:131], v[112:115]
    s_waitcnt lgkmcnt(2)
    v_cvt_pk_bf16_f32 v96, v64, v65
    v_cvt_pk_bf16_f32 v97, v66, v67
    v_mfma_f32_16x16x32_bf16 v[80:83], a[104:107], v[160:163], v[80:83]
    v_exp_f32 v68, v68
    v_mfma_f32_16x16x32_bf16 v[80:83], a[108:111], v[192:195], v[80:83]
    v_exp_f32 v69, v69
    v_mfma_f32_16x16x32_bf16 v[80:83], a[112:115], v[224:227], v[80:83]
    v_exp_f32 v70, v70
    v_mfma_f32_16x16x32_bf16 v[84:87], a[112:115], v[228:231], v[116:119]
    v_exp_f32 v71, v71
    v_mfma_f32_16x16x32_bf16 v[84:87], a[108:111], v[196:199], v[84:87]
    ds_read_b64_tr_b16 a[88:89], v7 offset:0
    ds_read_b64_tr_b16 a[90:91], v7 offset:512
    v_mfma_f32_16x16x32_bf16 v[84:87], a[104:107], v[164:167], v[84:87]
    v_cvt_pk_bf16_f32 v100, v68, v69
    v_cvt_pk_bf16_f32 v101, v70, v71
    v_mfma_f32_16x16x32_bf16 v[84:87], a[100:103], v[132:135], v[84:87]
    v_exp_f32 v80, v80
    v_mfma_f32_16x16x32_bf16 v[88:91], a[100:103], v[136:139], v[120:123]
    v_exp_f32 v81, v81
    v_mfma_f32_16x16x32_bf16 v[88:91], a[104:107], v[168:171], v[88:91]
    v_exp_f32 v82, v82
    v_mfma_f32_16x16x32_bf16 v[88:91], a[108:111], v[200:203], v[88:91]
    v_exp_f32 v83, v83
    v_mfma_f32_16x16x32_bf16 v[88:91], a[112:115], v[232:235], v[88:91]
    v_cvt_pk_bf16_f32 v98, v80, v81
    v_cvt_pk_bf16_f32 v99, v82, v83
    v_mfma_f32_16x16x32_bf16 v[92:95], a[112:115], a[60:63], v[124:127]
    v_exp_f32 v84, v84
    v_mfma_f32_16x16x32_bf16 v[92:95], a[108:111], a[56:59], v[92:95]
    v_exp_f32 v85, v85
    v_mfma_f32_16x16x32_bf16 v[92:95], a[104:107], a[52:55], v[92:95]
    v_exp_f32 v86, v86
    v_mfma_f32_16x16x32_bf16 v[92:95], a[100:103], a[48:51], v[92:95]
    v_exp_f32 v87, v87
    v_mfma_f32_16x16x32_bf16 a[64:67], a[80:83], v[96:99], a[64:67]
    v_cvt_pk_bf16_f32 v102, v84, v85
    v_cvt_pk_bf16_f32 v103, v86, v87
    v_exp_f32 v72, v72
    v_exp_f32 v73, v73
    v_mfma_f32_16x16x32_bf16 a[68:71], a[80:83], v[100:103], a[68:71]
    v_exp_f32 v74, v74
    v_exp_f32 v75, v75
    v_exp_f32 v88, v88
    v_exp_f32 v89, v89
    v_exp_f32 v90, v90
    v_exp_f32 v91, v91
    v_cvt_pk_bf16_f32 v104, v72, v73
    v_cvt_pk_bf16_f32 v105, v74, v75
    v_cvt_pk_bf16_f32 v106, v88, v89
    v_cvt_pk_bf16_f32 v107, v90, v91
    v_exp_f32 v76, v76
    v_exp_f32 v77, v77
    v_mfma_f32_16x16x32_bf16 a[72:75], a[80:83], v[104:107], a[72:75]
    s_waitcnt lgkmcnt(0)
    v_exp_f32 v78, v78
    v_exp_f32 v79, v79
    v_exp_f32 v92, v92
    v_exp_f32 v93, v93
    v_exp_f32 v94, v94
    v_exp_f32 v95, v95
    v_cvt_pk_bf16_f32 v108, v76, v77
    v_cvt_pk_bf16_f32 v109, v78, v79
    v_cvt_pk_bf16_f32 v110, v92, v93
    v_cvt_pk_bf16_f32 v111, v94, v95
    ds_read_b64_tr_b16 a[92:93], v8 offset:0
    ds_read_b64_tr_b16 a[94:95], v8 offset:512
    v_mfma_f32_16x16x32_bf16 a[76:79], a[80:83], v[108:111], a[76:79]
    ds_read_b64_tr_b16 a[96:97], v9 offset:0
    ds_read_b64_tr_b16 a[98:99], v9 offset:512
    v_mfma_f32_16x16x32_bf16 a[224:227], a[84:87], v[108:111], a[224:227]
    ds_read_b64_tr_b16 a[100:101], v6 offset:1024
    ds_read_b64_tr_b16 a[102:103], v6 offset:1536
    v_mfma_f32_16x16x32_bf16 a[32:35], a[84:87], v[104:107], a[32:35]
    ds_read_b64_tr_b16 a[104:105], v7 offset:1024
    ds_read_b64_tr_b16 a[106:107], v7 offset:1536
    v_mfma_f32_16x16x32_bf16 a[16:19], a[84:87], v[100:103], a[16:19]
    ds_read_b64_tr_b16 a[108:109], v8 offset:1024
    ds_read_b64_tr_b16 a[110:111], v8 offset:1536
    v_mfma_f32_16x16x32_bf16 a[0:3], a[84:87], v[96:99], a[0:3]
    ds_read_b64_tr_b16 a[112:113], v9 offset:1024
    ds_read_b64_tr_b16 a[114:115], v9 offset:1536
    v_mfma_f32_16x16x32_bf16 v[144:147], a[88:91], v[96:99], v[144:147]
    ds_read_b128 a[84:87], v4 offset:49152
    v_mfma_f32_16x16x32_bf16 v[148:151], a[88:91], v[100:103], v[148:151]
    v_mfma_f32_16x16x32_bf16 v[152:155], a[88:91], v[104:107], v[152:155]
    v_mfma_f32_16x16x32_bf16 a[228:231], a[88:91], v[108:111], a[228:231]
    s_waitcnt lgkmcnt(11)
    ds_read_b128 a[88:91], v5 offset:49152
    v_mfma_f32_16x16x32_bf16 a[232:235], a[92:95], v[108:111], a[232:235]
    v_mfma_f32_16x16x32_bf16 a[36:39], a[92:95], v[104:107], a[36:39]
    v_mfma_f32_16x16x32_bf16 a[20:23], a[92:95], v[100:103], a[20:23]
    s_waitcnt lgkmcnt(6)
    v_mfma_f32_16x16x32_bf16 a[4:7], a[92:95], v[96:99], a[4:7]
    ds_read_b128 a[92:95], v50 offset:49152
    v_mfma_f32_16x16x32_bf16 v[176:179], a[96:99], v[96:99], v[176:179]
    v_mfma_f32_16x16x32_bf16 v[180:183], a[96:99], v[100:103], v[180:183]
    v_mfma_f32_16x16x32_bf16 v[184:187], a[96:99], v[104:107], v[184:187]
    v_mfma_f32_16x16x32_bf16 a[236:239], a[96:99], v[108:111], a[236:239]
    ds_read_b128 a[96:99], v51 offset:49152
    v_mfma_f32_16x16x32_bf16 a[240:243], a[100:103], v[108:111], a[240:243]
    v_mfma_f32_16x16x32_bf16 a[40:43], a[100:103], v[104:107], a[40:43]
    v_mfma_f32_16x16x32_bf16 a[24:27], a[100:103], v[100:103], a[24:27]
    v_mfma_f32_16x16x32_bf16 a[8:11], a[100:103], v[96:99], a[8:11]
    ds_read_b128 a[100:103], v4 offset:49664
    v_mfma_f32_16x16x32_bf16 v[208:211], a[104:107], v[96:99], v[208:211]
    v_mfma_f32_16x16x32_bf16 v[212:215], a[104:107], v[100:103], v[212:215]
    v_mfma_f32_16x16x32_bf16 v[216:219], a[104:107], v[104:107], v[216:219]
    s_waitcnt lgkmcnt(2)
    v_mfma_f32_16x16x32_bf16 a[244:247], a[104:107], v[108:111], a[244:247]
    ds_read_b128 a[104:107], v5 offset:49664
    v_mfma_f32_16x16x32_bf16 a[248:251], a[108:111], v[108:111], a[248:251]
    v_mfma_f32_16x16x32_bf16 a[44:47], a[108:111], v[104:107], a[44:47]
    v_mfma_f32_16x16x32_bf16 a[28:31], a[108:111], v[100:103], a[28:31]
    v_mfma_f32_16x16x32_bf16 a[12:15], a[108:111], v[96:99], a[12:15]
    ds_read_b128 a[108:111], v50 offset:49664
    v_mfma_f32_16x16x32_bf16 v[240:243], a[112:115], v[96:99], v[240:243]
    v_mfma_f32_16x16x32_bf16 v[244:247], a[112:115], v[100:103], v[244:247]
    v_mfma_f32_16x16x32_bf16 v[248:251], a[112:115], v[104:107], v[248:251]
    v_mfma_f32_16x16x32_bf16 a[252:255], a[112:115], v[108:111], a[252:255]
    ds_read_b128 a[112:115], v51 offset:49664
    v_mfma_f32_16x16x32_bf16 v[64:67], a[84:87], v[128:131], v[112:115]
    v_mfma_f32_16x16x32_bf16 v[64:67], a[88:91], v[160:163], v[64:67]
    s_waitcnt lgkmcnt(2)
    v_mfma_f32_16x16x32_bf16 v[64:67], a[92:95], v[192:195], v[64:67]
    v_mfma_f32_16x16x32_bf16 v[64:67], a[96:99], v[224:227], v[64:67]
    v_mfma_f32_16x16x32_bf16 v[68:71], a[96:99], v[228:231], v[116:119]
    v_mfma_f32_16x16x32_bf16 v[68:71], a[92:95], v[196:199], v[68:71]
    v_mfma_f32_16x16x32_bf16 v[68:71], a[88:91], v[164:167], v[68:71]
    v_mfma_f32_16x16x32_bf16 v[68:71], a[84:87], v[132:135], v[68:71]
    v_mfma_f32_16x16x32_bf16 v[72:75], a[84:87], v[136:139], v[120:123]
    ds_read_b64_tr_b16 a[84:85], v10 offset:0
    ds_read_b64_tr_b16 a[86:87], v10 offset:512
    v_mfma_f32_16x16x32_bf16 v[72:75], a[88:91], v[168:171], v[72:75]
    ds_read_b64_tr_b16 a[88:89], v11 offset:0
    ds_read_b64_tr_b16 a[90:91], v11 offset:512
    v_mfma_f32_16x16x32_bf16 v[72:75], a[92:95], v[200:203], v[72:75]
    v_exp_f32 v64, v64
    v_mfma_f32_16x16x32_bf16 v[72:75], a[96:99], v[232:235], v[72:75]
    v_exp_f32 v65, v65
    v_mfma_f32_16x16x32_bf16 v[80:83], a[100:103], v[128:131], v[112:115]
    s_waitcnt lgkmcnt(4)
    v_exp_f32 v66, v66
    v_mfma_f32_16x16x32_bf16 v[80:83], a[104:107], v[160:163], v[80:83]
    v_exp_f32 v67, v67
    v_mfma_f32_16x16x32_bf16 v[80:83], a[108:111], v[192:195], v[80:83]
    v_cvt_pk_bf16_f32 v96, v64, v65
    v_cvt_pk_bf16_f32 v97, v66, v67
    v_mfma_f32_16x16x32_bf16 v[80:83], a[112:115], v[224:227], v[80:83]
    v_exp_f32 v68, v68
    v_mfma_f32_16x16x32_bf16 v[84:87], a[112:115], v[228:231], v[116:119]
    v_exp_f32 v69, v69
    v_mfma_f32_16x16x32_bf16 v[84:87], a[108:111], v[196:199], v[84:87]
    v_exp_f32 v70, v70
    v_mfma_f32_16x16x32_bf16 v[84:87], a[104:107], v[164:167], v[84:87]
    v_exp_f32 v71, v71
    v_mfma_f32_16x16x32_bf16 v[84:87], a[100:103], v[132:135], v[84:87]
    v_exp_f32 v80, v80
    v_mfma_f32_16x16x32_bf16 v[88:91], a[100:103], v[136:139], v[120:123]
    v_exp_f32 v81, v81
    v_mfma_f32_16x16x32_bf16 v[88:91], a[104:107], v[168:171], v[88:91]
    v_exp_f32 v82, v82
    v_mfma_f32_16x16x32_bf16 v[88:91], a[108:111], v[200:203], v[88:91]
    v_exp_f32 v83, v83
    v_mfma_f32_16x16x32_bf16 v[88:91], a[112:115], v[232:235], v[88:91]
    v_cvt_pk_bf16_f32 v98, v80, v81
    v_cvt_pk_bf16_f32 v99, v82, v83
    v_exp_f32 v84, v84
    v_exp_f32 v85, v85
    v_mfma_f32_16x16x32_bf16 a[64:67], a[80:83], v[96:99], a[64:67]
    v_exp_f32 v86, v86
    v_exp_f32 v87, v87
    v_cvt_pk_bf16_f32 v100, v68, v69
    v_cvt_pk_bf16_f32 v101, v70, v71
    v_cvt_pk_bf16_f32 v102, v84, v85
    v_cvt_pk_bf16_f32 v103, v86, v87
    v_exp_f32 v72, v72
    v_exp_f32 v73, v73
    v_mfma_f32_16x16x32_bf16 a[68:71], a[80:83], v[100:103], a[68:71]
    s_waitcnt lgkmcnt(0)
    v_exp_f32 v74, v74
    v_exp_f32 v75, v75
    v_exp_f32 v88, v88
    v_exp_f32 v89, v89
    v_exp_f32 v90, v90
    v_exp_f32 v91, v91
    ds_read_b64_tr_b16 a[92:93], v12 offset:0
    ds_read_b64_tr_b16 a[94:95], v12 offset:512
    v_cvt_pk_bf16_f32 v104, v72, v73
    v_cvt_pk_bf16_f32 v105, v74, v75
    v_cvt_pk_bf16_f32 v106, v88, v89
    v_cvt_pk_bf16_f32 v107, v90, v91
    ds_read_b64_tr_b16 a[96:97], v13 offset:0
    ds_read_b64_tr_b16 a[98:99], v13 offset:512
    v_mfma_f32_16x16x32_bf16 a[72:75], a[80:83], v[104:107], a[72:75]
    ds_read_b64_tr_b16 a[100:101], v10 offset:1024
    ds_read_b64_tr_b16 a[102:103], v10 offset:1536
    v_mfma_f32_16x16x32_bf16 a[32:35], a[84:87], v[104:107], a[32:35]
    ds_read_b64_tr_b16 a[104:105], v11 offset:1024
    ds_read_b64_tr_b16 a[106:107], v11 offset:1536
    v_mfma_f32_16x16x32_bf16 a[16:19], a[84:87], v[100:103], a[16:19]
    ds_read_b64_tr_b16 a[108:109], v12 offset:1024
    ds_read_b64_tr_b16 a[110:111], v12 offset:1536
    v_mfma_f32_16x16x32_bf16 a[0:3], a[84:87], v[96:99], a[0:3]
    ds_read_b64_tr_b16 a[112:113], v13 offset:1024
    ds_read_b64_tr_b16 a[114:115], v13 offset:1536
    v_mfma_f32_16x16x32_bf16 v[144:147], a[88:91], v[96:99], v[144:147]
    v_mfma_f32_16x16x32_bf16 v[148:151], a[88:91], v[100:103], v[148:151]
    v_mfma_f32_16x16x32_bf16 v[152:155], a[88:91], v[104:107], v[152:155]
    s_waitcnt lgkmcnt(10)
    v_mfma_f32_16x16x32_bf16 a[36:39], a[92:95], v[104:107], a[36:39]
    v_mfma_f32_16x16x32_bf16 a[20:23], a[92:95], v[100:103], a[20:23]
    s_waitcnt lgkmcnt(8)
    v_mfma_f32_16x16x32_bf16 a[4:7], a[92:95], v[96:99], a[4:7]
    v_mfma_f32_16x16x32_bf16 v[176:179], a[96:99], v[96:99], v[176:179]
    v_mfma_f32_16x16x32_bf16 v[180:183], a[96:99], v[100:103], v[180:183]
    s_waitcnt lgkmcnt(2)
    v_mfma_f32_16x16x32_bf16 v[184:187], a[96:99], v[104:107], v[184:187]
    v_mfma_f32_16x16x32_bf16 a[40:43], a[100:103], v[104:107], a[40:43]
    v_mfma_f32_16x16x32_bf16 a[24:27], a[100:103], v[100:103], a[24:27]
    v_mfma_f32_16x16x32_bf16 a[8:11], a[100:103], v[96:99], a[8:11]
    v_mfma_f32_16x16x32_bf16 v[208:211], a[104:107], v[96:99], v[208:211]
    v_mfma_f32_16x16x32_bf16 v[212:215], a[104:107], v[100:103], v[212:215]
    v_mfma_f32_16x16x32_bf16 v[216:219], a[104:107], v[104:107], v[216:219]
    v_mfma_f32_16x16x32_bf16 a[44:47], a[108:111], v[104:107], a[44:47]
    v_mfma_f32_16x16x32_bf16 a[28:31], a[108:111], v[100:103], a[28:31]
    s_waitcnt lgkmcnt(0)
    v_mfma_f32_16x16x32_bf16 a[12:15], a[108:111], v[96:99], a[12:15]
    v_mfma_f32_16x16x32_bf16 v[240:243], a[112:115], v[96:99], v[240:243]
    v_mfma_f32_16x16x32_bf16 v[244:247], a[112:115], v[100:103], v[244:247]
    v_mfma_f32_16x16x32_bf16 v[248:251], a[112:115], v[104:107], v[248:251]
    s_waitcnt lgkmcnt(0)
    s_barrier
    s_add_u32 s52, s52, 16384
    s_cmp_lt_u32 s52, 131072
    s_nop 7
    s_cbranch_scc1 L_att
    v_accvgpr_read_b32 v124, a64
    v_rcp_f32 v60, v124
    v_accvgpr_read_b32 v112, a0
    v_accvgpr_read_b32 v113, a1
    v_accvgpr_read_b32 v114, a2
    v_accvgpr_read_b32 v115, a3
    v_pk_mul_f32 v[112:113], v[112:113], v[60:61] op_sel_hi:[1,0]
    v_pk_mul_f32 v[114:115], v[114:115], v[60:61] op_sel_hi:[1,0]
    v_cvt_pk_bf16_f32 v112, v112, v113
    v_pk_mul_f32 v[144:145], v[144:145], v[60:61] op_sel_hi:[1,0]
    v_pk_mul_f32 v[146:147], v[146:147], v[60:61] op_sel_hi:[1,0]
    v_cvt_pk_bf16_f32 v113, v114, v115
    v_cvt_pk_bf16_f32 v114, v144, v145
    v_cvt_pk_bf16_f32 v115, v146, v147
    buffer_store_dwordx4 v[112:115], v24, s[28:31], s54 offen offset:0 sc1
    v_accvgpr_read_b32 v125, a68
    v_rcp_f32 v62, v125
    v_accvgpr_read_b32 v116, a16
    v_accvgpr_read_b32 v117, a17
    v_accvgpr_read_b32 v118, a18
    v_accvgpr_read_b32 v119, a19
    v_pk_mul_f32 v[116:117], v[116:117], v[62:63] op_sel_hi:[1,0]
    v_pk_mul_f32 v[118:119], v[118:119], v[62:63] op_sel_hi:[1,0]
    v_cvt_pk_bf16_f32 v116, v116, v117
    v_pk_mul_f32 v[148:149], v[148:149], v[62:63] op_sel_hi:[1,0]
    v_pk_mul_f32 v[150:151], v[150:151], v[62:63] op_sel_hi:[1,0]
    v_cvt_pk_bf16_f32 v117, v118, v119
    v_cvt_pk_bf16_f32 v118, v148, v149
    v_cvt_pk_bf16_f32 v119, v150, v151
    buffer_store_dwordx4 v[116:119], v24, s[28:31], s54 offen offset:1024 sc1
    v_accvgpr_read_b32 v126, a72
    v_rcp_f32 v30, v126
    v_accvgpr_read_b32 v120, a32
    v_accvgpr_read_b32 v121, a33
    v_accvgpr_read_b32 v122, a34
    v_accvgpr_read_b32 v123, a35
    v_pk_mul_f32 v[120:121], v[120:121], v[30:31] op_sel_hi:[1,0]
    v_pk_mul_f32 v[122:123], v[122:123], v[30:31] op_sel_hi:[1,0]
    v_cvt_pk_bf16_f32 v120, v120, v121
    v_pk_mul_f32 v[152:153], v[152:153], v[30:31] op_sel_hi:[1,0]
    v_pk_mul_f32 v[154:155], v[154:155], v[30:31] op_sel_hi:[1,0]
    v_cvt_pk_bf16_f32 v121, v122, v123
    v_cvt_pk_bf16_f32 v122, v152, v153
    v_cvt_pk_bf16_f32 v123, v154, v155
    buffer_store_dwordx4 v[120:123], v24, s[28:31], s54 offen offset:2048 sc1
    v_accvgpr_read_b32 v96, a4
    v_accvgpr_read_b32 v97, a5
    v_accvgpr_read_b32 v98, a6
    v_accvgpr_read_b32 v99, a7
    v_pk_mul_f32 v[96:97], v[96:97], v[60:61] op_sel_hi:[1,0]
    v_pk_mul_f32 v[98:99], v[98:99], v[60:61] op_sel_hi:[1,0]
    v_cvt_pk_bf16_f32 v96, v96, v97
    v_pk_mul_f32 v[176:177], v[176:177], v[60:61] op_sel_hi:[1,0]
    v_pk_mul_f32 v[178:179], v[178:179], v[60:61] op_sel_hi:[1,0]
    v_cvt_pk_bf16_f32 v97, v98, v99
    v_cvt_pk_bf16_f32 v98, v176, v177
    v_cvt_pk_bf16_f32 v99, v178, v179
    buffer_store_dwordx4 v[96:99], v24, s[28:31], s55 offen offset:0 sc1
    v_accvgpr_read_b32 v108, a20
    v_accvgpr_read_b32 v109, a21
    v_accvgpr_read_b32 v110, a22
    v_accvgpr_read_b32 v111, a23
    v_pk_mul_f32 v[108:109], v[108:109], v[62:63] op_sel_hi:[1,0]
    v_pk_mul_f32 v[110:111], v[110:111], v[62:63] op_sel_hi:[1,0]
    v_cvt_pk_bf16_f32 v108, v108, v109
    v_pk_mul_f32 v[180:181], v[180:181], v[62:63] op_sel_hi:[1,0]
    v_pk_mul_f32 v[182:183], v[182:183], v[62:63] op_sel_hi:[1,0]
    v_cvt_pk_bf16_f32 v109, v110, v111
    v_cvt_pk_bf16_f32 v110, v180, v181
    v_cvt_pk_bf16_f32 v111, v182, v183
    buffer_store_dwordx4 v[108:111], v24, s[28:31], s55 offen offset:1024 sc1
    v_accvgpr_read_b32 v52, a36
    v_accvgpr_read_b32 v53, a37
    v_accvgpr_read_b32 v54, a38
    v_accvgpr_read_b32 v55, a39
    v_pk_mul_f32 v[52:53], v[52:53], v[30:31] op_sel_hi:[1,0]
    v_pk_mul_f32 v[54:55], v[54:55], v[30:31] op_sel_hi:[1,0]
    v_cvt_pk_bf16_f32 v52, v52, v53
    v_pk_mul_f32 v[184:185], v[184:185], v[30:31] op_sel_hi:[1,0]
    v_pk_mul_f32 v[186:187], v[186:187], v[30:31] op_sel_hi:[1,0]
    v_cvt_pk_bf16_f32 v53, v54, v55
    v_cvt_pk_bf16_f32 v54, v184, v185
    v_cvt_pk_bf16_f32 v55, v186, v187
    buffer_store_dwordx4 v[52:55], v24, s[28:31], s55 offen offset:2048 sc1
    v_accvgpr_read_b32 v56, a8
    v_accvgpr_read_b32 v57, a9
    v_accvgpr_read_b32 v58, a10
    v_accvgpr_read_b32 v59, a11
    v_pk_mul_f32 v[56:57], v[56:57], v[60:61] op_sel_hi:[1,0]
    v_pk_mul_f32 v[58:59], v[58:59], v[60:61] op_sel_hi:[1,0]
    v_cvt_pk_bf16_f32 v56, v56, v57
    v_pk_mul_f32 v[208:209], v[208:209], v[60:61] op_sel_hi:[1,0]
    v_pk_mul_f32 v[210:211], v[210:211], v[60:61] op_sel_hi:[1,0]
    v_cvt_pk_bf16_f32 v57, v58, v59
    v_cvt_pk_bf16_f32 v58, v208, v209
    v_cvt_pk_bf16_f32 v59, v210, v211
    buffer_store_dwordx4 v[56:59], v24, s[28:31], s55 offen offset:3072 sc1
    ds_write_b128 v22, a[224:227] offset:0
    ds_write_b128 v22, a[228:231] offset:1024
    ds_write_b128 v22, a[232:235] offset:2048
    ds_write_b128 v22, a[236:239] offset:3072
    ds_write_b128 v22, a[240:243] offset:4096
    ds_write_b128 v22, a[244:247] offset:5120
    ds_write_b128 v22, a[248:251] offset:6144
    ds_write_b128 v22, a[252:255] offset:7168
    v_accvgpr_read_b32 v112, a24
    v_accvgpr_read_b32 v113, a25
    v_accvgpr_read_b32 v114, a26
    v_accvgpr_read_b32 v115, a27
    v_pk_mul_f32 v[112:113], v[112:113], v[62:63] op_sel_hi:[1,0]
    v_pk_mul_f32 v[114:115], v[114:115], v[62:63] op_sel_hi:[1,0]
    v_cvt_pk_bf16_f32 v112, v112, v113
    v_pk_mul_f32 v[212:213], v[212:213], v[62:63] op_sel_hi:[1,0]
    v_pk_mul_f32 v[214:215], v[214:215], v[62:63] op_sel_hi:[1,0]
    v_cvt_pk_bf16_f32 v113, v114, v115
    v_cvt_pk_bf16_f32 v114, v212, v213
    v_cvt_pk_bf16_f32 v115, v214, v215
    buffer_store_dwordx4 v[112:115], v24, s[28:31], s56 offen offset:0 sc1
    v_accvgpr_read_b32 v116, a40
    v_accvgpr_read_b32 v117, a41
    v_accvgpr_read_b32 v118, a42
    v_accvgpr_read_b32 v119, a43
    v_pk_mul_f32 v[116:117], v[116:117], v[30:31] op_sel_hi:[1,0]
    v_pk_mul_f32 v[118:119], v[118:119], v[30:31] op_sel_hi:[1,0]
    v_cvt_pk_bf16_f32 v116, v116, v117
    v_pk_mul_f32 v[216:217], v[216:217], v[30:31] op_sel_hi:[1,0]
    v_pk_mul_f32 v[218:219], v[218:219], v[30:31] op_sel_hi:[1,0]
    v_cvt_pk_bf16_f32 v117, v118, v119
    v_cvt_pk_bf16_f32 v118, v216, v217
    v_cvt_pk_bf16_f32 v119, v218, v219
    buffer_store_dwordx4 v[116:119], v24, s[28:31], s56 offen offset:1024 sc1
    v_accvgpr_read_b32 v120, a12
    v_accvgpr_read_b32 v121, a13
    v_accvgpr_read_b32 v122, a14
    v_accvgpr_read_b32 v123, a15
    v_pk_mul_f32 v[120:121], v[120:121], v[60:61] op_sel_hi:[1,0]
    v_pk_mul_f32 v[122:123], v[122:123], v[60:61] op_sel_hi:[1,0]
    v_cvt_pk_bf16_f32 v120, v120, v121
    v_pk_mul_f32 v[240:241], v[240:241], v[60:61] op_sel_hi:[1,0]
    v_pk_mul_f32 v[242:243], v[242:243], v[60:61] op_sel_hi:[1,0]
    v_cvt_pk_bf16_f32 v121, v122, v123
    v_cvt_pk_bf16_f32 v122, v240, v241
    v_cvt_pk_bf16_f32 v123, v242, v243
    buffer_store_dwordx4 v[120:123], v24, s[28:31], s56 offen offset:3072 sc1
    v_accvgpr_read_b32 v96, a28
    v_accvgpr_read_b32 v97, a29
    v_accvgpr_read_b32 v98, a30
    v_accvgpr_read_b32 v99, a31
    v_pk_mul_f32 v[96:97], v[96:97], v[62:63] op_sel_hi:[1,0]
    v_pk_mul_f32 v[98:99], v[98:99], v[62:63] op_sel_hi:[1,0]
    v_cvt_pk_bf16_f32 v96, v96, v97
    v_pk_mul_f32 v[244:245], v[244:245], v[62:63] op_sel_hi:[1,0]
    v_pk_mul_f32 v[246:247], v[246:247], v[62:63] op_sel_hi:[1,0]
    v_cvt_pk_bf16_f32 v97, v98, v99
    v_cvt_pk_bf16_f32 v98, v244, v245
    v_cvt_pk_bf16_f32 v99, v246, v247
    buffer_store_dwordx4 v[96:99], v24, s[28:31], s57 offen offset:0 sc1
    v_accvgpr_read_b32 v127, a76
    v_lshlrev_b32 v104, 3, v1
    v_mov_b32 v100, 0
    v_mov_b32 v101, v127
    v_accvgpr_read_b32 v108, a44
    v_accvgpr_read_b32 v109, a45
    v_accvgpr_read_b32 v110, a46
    v_accvgpr_read_b32 v111, a47
    v_pk_mul_f32 v[108:109], v[108:109], v[30:31] op_sel_hi:[1,0]
    v_pk_mul_f32 v[110:111], v[110:111], v[30:31] op_sel_hi:[1,0]
    v_cvt_pk_bf16_f32 v108, v108, v109
    v_pk_mul_f32 v[248:249], v[248:249], v[30:31] op_sel_hi:[1,0]
    v_pk_mul_f32 v[250:251], v[250:251], v[30:31] op_sel_hi:[1,0]
    v_cvt_pk_bf16_f32 v109, v110, v111
    v_cvt_pk_bf16_f32 v110, v248, v249
    v_cvt_pk_bf16_f32 v111, v250, v251
    v_xor_b32 v29, 0x2000, v23
    buffer_store_dwordx4 v[108:111], v24, s[28:31], s57 offen offset:1024 sc1
    s_add_u32 s46, s44, 131072
    v_add_u32 v104, s46, v104
    ds_write_b64 v104, v[100:101] offset:0
    v_and_b32 v104, 0xffffffbf, v104
    s_lshl_b32 s47, s41, 6
    v_or_b32 v104, s47, v104
    v_xor_b32 v105, 0x1000, v104
    v_xor_b32 v106, 0x2000, v104
    v_xor_b32 v107, 0x3000, v104
    s_waitcnt lgkmcnt(0)
    s_barrier
    ds_read_b32 v101, v104 offset:4
    ds_read_b64 v[102:103], v105 offset:0
    ds_read_b128 v[64:67], v23 offset:0
    ds_read_b128 v[80:83], v29 offset:0
    ds_read_b128 v[68:71], v23 offset:1024
    ds_read_b128 v[84:87], v29 offset:1024
    ds_read_b128 v[72:75], v23 offset:4096
    ds_read_b128 v[88:91], v29 offset:4096
    ds_read_b128 v[76:79], v23 offset:5120
    ds_read_b128 v[92:95], v29 offset:5120
    ds_read_b32 v106, v106 offset:0
    ds_read_b32 v107, v107 offset:0
    s_waitcnt lgkmcnt(10)
    v_add_f32 v104, v101, v103
    v_rcp_f32 v104, v104
    s_waitcnt lgkmcnt(6)
    v_pk_add_f32 v[64:65], v[64:65], v[80:81]
    v_pk_add_f32 v[66:67], v[66:67], v[82:83]
    v_pk_mul_f32 v[64:65], v[64:65], v[104:105] op_sel_hi:[1,0]
    v_pk_add_f32 v[68:69], v[68:69], v[84:85]
    v_pk_add_f32 v[70:71], v[70:71], v[86:87]
    v_pk_mul_f32 v[66:67], v[66:67], v[104:105] op_sel_hi:[1,0]
    v_cvt_pk_bf16_f32 v64, v64, v65
    v_pk_mul_f32 v[68:69], v[68:69], v[104:105] op_sel_hi:[1,0]
    v_pk_mul_f32 v[70:71], v[70:71], v[104:105] op_sel_hi:[1,0]
    v_cvt_pk_bf16_f32 v65, v66, v67
    v_cvt_pk_bf16_f32 v66, v68, v69
    v_cvt_pk_bf16_f32 v67, v70, v71
    buffer_store_dwordx4 v[64:67], v24, s[28:31], s54 offen offset:3072 sc1
    s_waitcnt lgkmcnt(0)
    v_pk_add_f32 v[72:73], v[72:73], v[88:89]
    v_pk_add_f32 v[74:75], v[74:75], v[90:91]
    v_pk_mul_f32 v[72:73], v[72:73], v[104:105] op_sel_hi:[1,0]
    v_pk_add_f32 v[76:77], v[76:77], v[92:93]
    v_pk_add_f32 v[78:79], v[78:79], v[94:95]
    v_pk_mul_f32 v[74:75], v[74:75], v[104:105] op_sel_hi:[1,0]
    v_cvt_pk_bf16_f32 v72, v72, v73
    v_pk_mul_f32 v[76:77], v[76:77], v[104:105] op_sel_hi:[1,0]
    v_pk_mul_f32 v[78:79], v[78:79], v[104:105] op_sel_hi:[1,0]
    v_cvt_pk_bf16_f32 v73, v74, v75
    v_cvt_pk_bf16_f32 v74, v76, v77
    v_cvt_pk_bf16_f32 v75, v78, v79
    buffer_store_dwordx4 v[72:75], v24, s[28:31], s56 offen offset:2048 sc1
    v_or3_b32 v100, v100, v102, v106
    v_or_b32 v100, v100, v107
    v_cmp_ne_u32 vcc, 0, v100
    s_waitcnt vmcnt(0) lgkmcnt(0)
    s_nop 4
    s_branch L_done
.section .rodata,"a"
.p2align 6
.amdhsa_kernel standalone__gqa_block_cached__near_ridge_kernel
  .amdhsa_next_free_vgpr 512
  .amdhsa_next_free_sgpr 102
  .amdhsa_accum_offset 256
  .amdhsa_group_segment_fixed_size 0
  .amdhsa_kernarg_size 64
  .amdhsa_user_sgpr_count 2
  .amdhsa_user_sgpr_kernarg_segment_ptr 1
  .amdhsa_system_sgpr_workgroup_id_x 1
.end_amdhsa_kernel
```
